```python
import torch

def _softmax(x, axis=-1):
    return torch.softmax(x, dim=axis)
def _gelu(x):
    return torch.nn.functional.gelu(x, approximate="tanh")
def _silu(x):
    return torch.nn.functional.silu(x)
def _sigmoid(x):
    return torch.sigmoid(x)
def _layernorm(x, axis=-1, eps=1e-5):
    m = x.mean(dim=axis, keepdim=True)
    v = x.var(dim=axis, keepdim=True, unbiased=False)
    return (x - m) / torch.sqrt(v + eps)
def _scatter_add(tgt, idx, src, axis=0):
    return tgt.clone().index_add_(axis, idx, src)
def _segment_sum(src, seg, n):
    out = torch.zeros((n,) + src.shape[1:], dtype=src.dtype)
    return out.index_add_(0, seg, src)
def _pad(x, pw):
    flat = tuple(v for pair in reversed(pw) for v in pair)
    return torch.nn.functional.pad(x, flat)

kernel_name = 'sequential_preLN__sliding_block__glu_gated_bilinear__prompt'

def setup_inputs():

    _w = (lambda a: (lambda t: t.to(torch.bfloat16) if t.is_floating_point() else t)(torch.as_tensor(a)))
    def _A_setup():
        B, S, D = 1, 2048, 576
        return {
            "x": _w((lambda *s: torch.randn(*s, dtype=torch.bfloat16) * 0.05)(B, S, D)),
            "wqkv": _w((lambda *s: torch.randn(*s, dtype=torch.bfloat16) * 0.05)(D, 3 * D)),
            "wo": _w((lambda *s: torch.randn(*s, dtype=torch.bfloat16) * 0.05)(D, D)),
        }
    _A_in = _A_setup()

    def _B_setup():
        B, S, D, F = 1, 2048, 576, 4608
        return {
            "x": _w((lambda *s: torch.randn(*s, dtype=torch.bfloat16) * 0.05)(B, S, D)),
            "w_gate": _w((lambda *s: torch.randn(*s, dtype=torch.bfloat16) * 0.8)(D, F) * (D ** -0.5)),
            "w_up": _w((lambda *s: torch.randn(*s, dtype=torch.bfloat16) * 0.8)(D, F) * (D ** -0.5)),
            "w_down": _w((lambda *s: torch.randn(*s, dtype=torch.bfloat16) * 0.8)(F, D) * (F ** -0.5)),
        }
    _B_in = _B_setup()

    return {
        "A_x": _A_in["x"],
        "A_wqkv": _A_in["wqkv"],
        "A_wo": _A_in["wo"],
        "B_x": _B_in["x"],
        "B_w_gate": _B_in["w_gate"],
        "B_w_up": _B_in["w_up"],
        "B_w_down": _B_in["w_down"],
    }

def reference(A_x, A_wqkv, A_wo, B_x, B_w_gate, B_w_up, B_w_down):
    def _A_ref(x, wqkv, wo):
        B, S, D = x.shape
        H = 32; Dh = D // H; W = 256
        qkv = (lambda x, *d: x.permute(*d))((x @ wqkv).reshape(B, S, 3, H, Dh), 2, 0, 3, 1, 4)
        q, k, v = qkv[0], qkv[1], qkv[2]
        scores = torch.einsum("bhqd,bhkd->bhqk", q, k) * (Dh ** -0.5)
        idx = torch.arange(S)
        mask = (idx[:, None] - idx[None, :] >= 0) & (idx[:, None] - idx[None, :] < W)
        scores = torch.where(mask[None, None], scores, -1e9)
        p = _softmax(scores, axis=-1)
        o = torch.einsum("bhqk,bhkd->bhqd", p, v)
        return (lambda x, *d: x.permute(*d))(o, 0, 2, 1, 3).reshape(B, S, D) @ wo

    def _B_ref(x, w_gate, w_up, w_down):
        g = torch.einsum("bsd,df->bsf", x, w_gate)
        u = torch.einsum("bsd,df->bsf", x, w_up)
        h = g * u
        return torch.einsum("bsf,fd->bsd", h, w_down)

    x = A_x
    h = x + _A_ref(_layernorm(x, axis=-1), A_wqkv, A_wo)
    h2 = h + _B_ref(_layernorm(h, axis=-1), B_w_gate, B_w_up, B_w_down)
    return h2
```

```asm
; @launch grid=(256,1,1) block=(512,1,1) lds=163840
.amdgcn_target "amdgcn-amd-amdhsa--gfx950"
.text
.globl sequential_preLN__sliding_block__glu_gated_bilinear__prompt_kernel
.p2align 12
.p2align 8
.type sequential_preLN__sliding_block__glu_gated_bilinear__prompt_kernel,@function
sequential_preLN__sliding_block__glu_gated_bilinear__prompt_kernel:
    s_cmp_ge_u32 s2, 256
    s_cbranch_scc1 sequential_preLN__sliding_block__glu_gated_bilinear__prompt_kernel_end
    s_load_dwordx4 s[4:7], s[0:1], 0
    s_load_dwordx4 s[8:11], s[0:1], 64
    v_lshrrev_b32 v1, 6, v0
    v_and_b32 v2, 63, v0
    v_readfirstlane_b32 s36, v1
    s_cmp_ge_u32 s2, 224
    s_cbranch_scc1 sequential_preLN__sliding_block__glu_gated_bilinear__prompt_kernel_pf
    s_and_b32 s37, s2, 3
    s_lshl_b32 s37, s37, 2
    s_bfe_u32 s42, s2, 0x20003
    s_or_b32 s37, s37, s42
    s_bfe_u32 s38, s2, 0x10002
    s_mul_i32 s38, s38, 7
    s_lshr_b32 s42, s2, 5
    s_add_u32 s38, s38, s42
    s_and_b32 s39, s36, 1
    s_bfe_u32 s40, s36, 0x10001
    v_lshrrev_b32 v70, 5, v2
    s_cmp_eq_u32 s36, 0
    s_cbranch_scc1 sequential_preLN__sliding_block__glu_gated_bilinear__prompt_kernel_cons1
    s_cmp_lt_u32 s36, 4
    s_cbranch_scc0 sequential_preLN__sliding_block__glu_gated_bilinear__prompt_kernel_prod2
    s_cmp_ge_u32 s38, 9
    s_cselect_b32 s46, 3, 0
    s_add_u32 s46, s46, s36
    s_mov_b64 exec, 0
    s_call_b64 s[98:99], pfd_1
    s_branch sequential_preLN__sliding_block__glu_gated_bilinear__prompt_kernel_cons1
pf_ret:
    s_waitcnt lgkmcnt(0)
    s_setpc_b64 s[98:99]
pfd_1:
    s_cmp_eq_u32 s46, 1
    s_cbranch_scc1 pg_2
    s_cmp_eq_u32 s46, 2
    s_cbranch_scc1 pg_3
    s_cmp_eq_u32 s46, 3
    s_cbranch_scc1 pg_en
    s_cmp_eq_u32 s46, 4
    s_cbranch_scc1 pg_k1
    s_cmp_eq_u32 s46, 5
    s_cbranch_scc1 pg_4
    s_branch pg_en
sequential_preLN__sliding_block__glu_gated_bilinear__prompt_kernel_prod2:
    s_load_dwordx2 s[60:61], s[0:1], 32
    s_load_dwordx2 s[64:65], s[0:1], 40
    s_load_dwordx2 s[68:69], s[0:1], 48
    s_and_b32 s36, s36, 3
    s_lshl_b32 s41, s38, 8
    s_lshl_b32 s42, s40, 7
    s_add_u32 s41, s41, s42
    s_mul_i32 s42, s39, 110592
    s_add_u32 s41, s41, s42
    s_lshl_b32 s43, s36, 12
    s_lshl_b32 s44, s37, 2
    s_add_u32 s44, s44, s36
    s_mul_i32 s44, s44, 36864
    s_bfe_u32 s52, s2, 0x20003
    s_mul_i32 s52, s52, 2
    s_lshr_b32 s42, s2, 5
    s_mul_i32 s42, s42, 1
    s_add_u32 s52, s52, s42
    s_mul_i32 s42, s52, 7282
    s_lshr_b32 s42, s42, 16
    s_mul_i32 s42, s42, 9
    s_sub_u32 s52, s52, s42
    s_lshl_b32 s52, s52, 7
    v_and_b32 v68, 3, v2
    v_lshlrev_b32 v68, 4, v68
    v_bfe_u32 v69, v2, 2, 3
    v_lshl_add_u32 v68, v70, 6, v68
    v_mul_u32_u24 v3, 3456, v69
    v_add_u32 v3, v3, v68
    v_lshrrev_b32 v68, 3, v2
    v_and_b32 v69, 7, v2
    v_lshrrev_b32 v71, 1, v68
    v_xor_b32 v69, v69, v71
    v_mul_u32_u24 v68, 1152, v68
    v_lshl_add_u32 v4, v69, 4, v68
    v_xor_b32 v69, 4, v69
    v_lshl_add_u32 v5, v69, 4, v68
    s_waitcnt lgkmcnt(0)
    s_mov_b32 s16, s4
    s_mov_b32 s17, s5
    s_mov_b32 s18, 0x240000
    s_mov_b32 s19, 0x00020000
    s_mov_b32 s20, s6
    s_mov_b32 s21, s7
    s_mov_b32 s22, 0x1e6000
    s_mov_b32 s23, 0x00020000
    s_cmp_ge_u32 s2, 8
    s_cbranch_scc1 sequential_preLN__sliding_block__glu_gated_bilinear__prompt_kernel_nz3
    s_add_u32 s32, s10, 0xd00000
    s_addc_u32 s33, s11, 0
    s_mov_b32 s34, 0x8000
    s_mov_b32 s35, 0x00020000
    v_mov_b32 v20, 0
    v_mov_b32 v21, 0
    v_mov_b32 v22, 0
    v_mov_b32 v23, 0
    v_lshrrev_b32 v1, 3, v2
    v_mul_u32_u24 v1, 128, v1
    v_and_b32 v24, 7, v2
    v_lshl_add_u32 v1, v24, 4, v1
    s_lshl_b32 s46, s2, 2
    s_add_u32 s46, s46, s36
    s_mul_i32 s46, s46, 1024
    buffer_store_dwordx4 v[20:23], v1, s[32:35], s46 offen sc1
sequential_preLN__sliding_block__glu_gated_bilinear__prompt_kernel_nz3:
    s_mul_i32 s53, s52, 1728
    s_add_u32 s54, s44, s52
    s_add_u32 s55, s41, s53
    s_add_u32 m0, s43, 0
    s_add_u32 s46, s54, 0
    buffer_load_dwordx4 v4, s[16:19], s46 offen lds
    s_add_u32 m0, s43, 16384
    s_add_u32 s46, s55, 0
    buffer_load_dwordx4 v3, s[20:23], s46 offen lds
    s_add_u32 m0, s43, 1024
    s_add_u32 s46, s54, 9216
    buffer_load_dwordx4 v5, s[16:19], s46 offen lds
    s_add_u32 m0, s43, 17408
    s_add_u32 s46, s55, 27648
    buffer_load_dwordx4 v3, s[20:23], s46 offen lds
    s_add_u32 m0, s43, 2048
    s_add_u32 s46, s54, 18432
    buffer_load_dwordx4 v4, s[16:19], s46 offen lds
    s_add_u32 m0, s43, 18432
    s_add_u32 s46, s55, 55296
    buffer_load_dwordx4 v3, s[20:23], s46 offen lds
    s_add_u32 m0, s43, 3072
    s_add_u32 s46, s54, 27648
    buffer_load_dwordx4 v5, s[16:19], s46 offen lds
    s_add_u32 m0, s43, 19456
    s_add_u32 s46, s55, 82944
    buffer_load_dwordx4 v3, s[20:23], s46 offen lds
    s_add_u32 s52, s52, 128
    s_cmp_eq_u32 s52, 1152
    s_cselect_b32 s52, 0, s52
    s_mul_i32 s53, s52, 1728
    s_add_u32 s54, s44, s52
    s_add_u32 s55, s41, s53
    s_add_u32 m0, s43, 32768
    s_add_u32 s46, s54, 0
    buffer_load_dwordx4 v4, s[16:19], s46 offen lds
    s_add_u32 m0, s43, 49152
    s_add_u32 s46, s55, 0
    buffer_load_dwordx4 v3, s[20:23], s46 offen lds
    s_add_u32 m0, s43, 33792
    s_add_u32 s46, s54, 9216
    buffer_load_dwordx4 v5, s[16:19], s46 offen lds
    s_add_u32 m0, s43, 50176
    s_add_u32 s46, s55, 27648
    buffer_load_dwordx4 v3, s[20:23], s46 offen lds
    s_add_u32 m0, s43, 34816
    s_add_u32 s46, s54, 18432
    buffer_load_dwordx4 v4, s[16:19], s46 offen lds
    s_add_u32 m0, s43, 51200
    s_add_u32 s46, s55, 55296
    buffer_load_dwordx4 v3, s[20:23], s46 offen lds
    s_add_u32 m0, s43, 35840
    s_add_u32 s46, s54, 27648
    buffer_load_dwordx4 v5, s[16:19], s46 offen lds
    s_add_u32 m0, s43, 52224
    s_add_u32 s46, s55, 82944
    buffer_load_dwordx4 v3, s[20:23], s46 offen lds
    v_and_b32 v0, 255, v0
    s_lshr_b32 s46, s2, 5
    s_sub_u32 s47, s46, 1
    s_cmp_eq_u32 s46, 0
    s_cselect_b32 s47, 8, s47
    s_bfe_u32 s48, s2, 0x20003
    s_lshl_b32 s47, s47, 2
    s_add_u32 s47, s47, s48
    s_lshl_b32 s47, s47, 2
    s_add_u32 s47, s47, s36
    s_mul_i32 s47, s47, 13824
    s_lshl_b32 s49, s38, 8
    s_add_u32 s47, s47, s49
    v_lshrrev_b32 v24, 1, v2
    v_mul_u32_u24 v24, 3456, v24
    v_and_b32 v25, 1, v2
    v_lshl_add_u32 v24, v25, 7, v24
    s_mov_b64 exec, 0xff
    buffer_load_dword v17, v24, s[20:23], s47 offen
    s_lshl_b32 s48, s48, 1
    s_sub_u32 s49, s48, 1
    s_cmp_eq_u32 s48, 0
    s_cselect_b32 s49, 8, s49
    s_lshl_b32 s49, s49, 7
    s_mul_i32 s47, s37, 147456
    s_add_u32 s49, s49, s47
    s_lshl_b32 s46, s46, 2
    s_add_u32 s46, s46, s36
    s_mul_i32 s46, s46, 5
    v_add_u32 v24, s46, v2
    v_min_u32 v24, 127, v24
    v_mul_u32_u24 v24, 1152, v24
    s_mov_b64 exec, 31
    buffer_load_dword v17, v24, s[16:19], s49 offen
    s_mov_b64 exec, -1
    s_mov_b32 s32, s10
    s_mov_b32 s33, s11
    s_mov_b32 s34, 0x10000000
    s_mov_b32 s35, 0x00020000
    v_mov_b32 v12, -1
    v_mov_b32 v13, -1
    v_mov_b32 v14, -1
    v_mov_b32 v15, -1
    v_lshlrev_b32 v1, 4, v2
    s_mul_i32 s59, s2, 9216
    s_and_b32 s46, s36, 1
    s_mul_i32 s46, s46, 4096
    s_add_u32 s59, s59, s46
    s_lshr_b32 s46, s36, 1
    s_mul_i32 s46, s46, 2359296
    s_add_u32 s59, s59, s46
    s_add_u32 s59, s59, 0x800000
    s_and_b32 s47, s2, 31
    s_lshr_b32 s48, s2, 5
    s_lshl_b32 s49, s48, 10
    s_sub_u32 s50, s47, 5
    s_lshl_b32 s50, s50, 13
    s_add_u32 s50, s50, s49
    s_add_u32 s50, s50, 0x2800000
    s_lshl_b32 s51, s48, 2
    s_add_u32 s51, s51, s47
    s_lshl_b32 s51, s51, 10
    s_add_u32 s51, s51, 0xc81c00
    s_cmp_lt_u32 s47, 5
    s_cselect_b32 s50, s51, s50
    s_add_u32 s49, s49, 0xc80000
    s_cmp_eq_u32 s47, 0
    s_cselect_b32 s50, s49, s50
    s_cmp_lt_u32 s47, 17
    s_cselect_b32 s50, s50, s59
    s_cmp_eq_u32 s36, 0
    s_cselect_b32 s50, s50, s59
    s_add_u32 s51, s59, 4096
    s_bitcmp1_b32 s36, 0
    s_cselect_b32 s50, s51, s50
    buffer_store_dwordx4 v[12:15], v1, s[32:35], s59 offen offset:0 sc1
    buffer_store_dwordx4 v[12:15], v1, s[32:35], s59 offen offset:1024 sc1
    buffer_store_dwordx4 v[12:15], v1, s[32:35], s59 offen offset:2048 sc1
    buffer_store_dwordx4 v[12:15], v1, s[32:35], s59 offen offset:3072 sc1
    buffer_store_dwordx4 v[12:15], v1, s[32:35], s50 offen sc1
    s_mov_b32 s72, s8
    s_mov_b32 s73, s9
    s_mov_b32 s74, 0x100
    s_mov_b32 s75, 0x00020000
    v_and_b32 v21, 7, v2
    v_lshlrev_b32 v21, 2, v21
    s_mov_b32 s62, 0x510000
    s_mov_b32 s63, 0x00020000
    s_mov_b32 s66, 0x510000
    s_mov_b32 s67, 0x00020000
    s_and_b32 s46, s36, 1
    s_lshl_b32 s46, s46, 1
    s_lshr_b32 s47, s36, 1
    s_or_b32 s46, s46, s47
    s_lshl_b32 s76, s46, 10
    s_mul_i32 s77, s36, 73728
    s_and_b32 s46, s2, 7
    s_mul_i32 s46, s46, 1152
    s_add_u32 s77, s77, s46
    s_bfe_u32 s46, s2, 0x20003
    s_lshl_b32 s46, s46, 8
    s_add_u32 s77, s77, s46
    v_bfe_u32 v24, v2, 2, 3
    v_bfe_u32 v25, v2, 4, 1
    v_lshlrev_b32 v25, 1, v25
    v_and_b32 v26, 3, v2
    v_xor_b32 v25, v25, v26
    v_lshlrev_b32 v25, 4, v25
    v_lshrrev_b32 v26, 5, v2
    v_lshl_add_u32 v25, v26, 6, v25
    v_mul_u32_u24 v16, 9216, v24
    v_add_u32 v16, v16, v25
    s_mov_b32 s70, 0x510000
    s_mov_b32 s71, 0x00020000
    s_mov_b32 s82, 0x510000
    s_mov_b32 s83, 0x00020000
    s_bitcmp1_b32 s36, 0
    s_cselect_b32 s80, s64, s60
    s_cselect_b32 s81, s65, s61
    s_lshr_b32 s46, s2, 3
    s_lshl_b32 s46, s46, 2
    s_add_u32 s46, s46, s36
    s_and_b32 s57, s2, 7
    s_mul_i32 s57, s57, 1152
    s_mul_i32 s58, s57, 576
    s_mul_i32 s47, s46, 36
    v_add_u32 v24, s47, v2
    v_lshrrev_b32 v25, 3, v24
    v_lshlrev_b32 v24, 7, v24
    v_lshl_add_u32 v9, v25, 7, v24
    s_lshr_b32 s46, s46, 1
    s_and_b32 s47, s46, 31
    v_lshrrev_b32 v24, 2, v2
    v_mul_u32_u24 v24, 9216, v24
    v_and_b32 v25, 3, v2
    v_lshl_add_u32 v24, v25, 8, v24
    v_add_u32 v24, 128, v24
    v_lshrrev_b32 v25, 3, v2
    v_mul_u32_u24 v25, 9216, v25
    v_and_b32 v26, 7, v2
    v_lshl_add_u32 v25, v26, 7, v25
    s_mul_i32 s48, s47, 110592
    s_mul_i32 s49, s47, 55296
    s_add_u32 s49, s49, 3538944
    s_cmp_lt_u32 s46, 32
    s_cselect_b32 s48, s48, s49
    s_cselect_b64 vcc, -1, 0
    v_cndmask_b32 v8, v25, v24, vcc
    s_add_u32 s57, s57, s48
    s_mul_i32 s56, s46, 55296
    s_and_b32 s47, s2, 7
    s_mul_i32 s47, s47, 1152
    s_add_u32 s56, s56, s47
    v_subrev_u32 v11, 128, v24
    s_waitcnt vmcnt(15)
    s_barrier
    s_lshl_b32 s46, s36, 5
    s_add_u32 s46, s46, s2
    s_cmp_ge_u32 s46, 8
    s_cbranch_scc1 sequential_preLN__sliding_block__glu_gated_bilinear__prompt_kernel_zp4
    s_lshl_b32 s46, s2, 2
    v_mov_b32 v20, 1
    s_mov_b64 exec, 1
    buffer_store_dword v20, off, s[72:75], s46 sc1
    s_mov_b64 exec, -1
sequential_preLN__sliding_block__glu_gated_bilinear__prompt_kernel_zp4:
    s_add_u32 s52, s52, 128
    s_cmp_eq_u32 s52, 1152
    s_cselect_b32 s52, 0, s52
    s_mul_i32 s53, s52, 1728
    s_add_u32 s54, s44, s52
    s_add_u32 s55, s41, s53
    s_add_u32 m0, s43, 65536
    s_add_u32 s46, s54, 0
    buffer_load_dwordx4 v4, s[16:19], s46 offen lds
    s_add_u32 m0, s43, 81920
    s_add_u32 s46, s55, 0
    buffer_load_dwordx4 v3, s[20:23], s46 offen lds
    s_add_u32 m0, s43, 66560
    s_add_u32 s46, s54, 9216
    buffer_load_dwordx4 v5, s[16:19], s46 offen lds
    s_add_u32 m0, s43, 82944
    s_add_u32 s46, s55, 27648
    buffer_load_dwordx4 v3, s[20:23], s46 offen lds
    s_add_u32 m0, s43, 67584
    s_add_u32 s46, s54, 18432
    buffer_load_dwordx4 v4, s[16:19], s46 offen lds
    s_add_u32 m0, s43, 83968
    s_add_u32 s46, s55, 55296
    buffer_load_dwordx4 v3, s[20:23], s46 offen lds
    s_add_u32 m0, s43, 68608
    s_add_u32 s46, s54, 27648
    buffer_load_dwordx4 v5, s[16:19], s46 offen lds
    s_add_u32 m0, s43, 84992
    s_add_u32 s46, s55, 82944
    buffer_load_dwordx4 v3, s[20:23], s46 offen lds
    s_waitcnt vmcnt(15)
    s_barrier
    s_add_u32 s52, s52, 128
    s_cmp_eq_u32 s52, 1152
    s_cselect_b32 s52, 0, s52
    s_mul_i32 s53, s52, 1728
    s_add_u32 s54, s44, s52
    s_add_u32 s55, s41, s53
    s_add_u32 m0, s43, 98304
    s_add_u32 s46, s54, 0
    buffer_load_dwordx4 v4, s[16:19], s46 offen lds
    s_add_u32 m0, s43, 114688
    s_add_u32 s46, s55, 0
    buffer_load_dwordx4 v3, s[20:23], s46 offen lds
    s_add_u32 m0, s43, 99328
    s_add_u32 s46, s54, 9216
    buffer_load_dwordx4 v5, s[16:19], s46 offen lds
    s_add_u32 m0, s43, 115712
    s_add_u32 s46, s55, 27648
    buffer_load_dwordx4 v3, s[20:23], s46 offen lds
    s_add_u32 m0, s43, 100352
    s_add_u32 s46, s54, 18432
    buffer_load_dwordx4 v4, s[16:19], s46 offen lds
    s_add_u32 m0, s43, 116736
    s_add_u32 s46, s55, 55296
    buffer_load_dwordx4 v3, s[20:23], s46 offen lds
    s_add_u32 m0, s43, 101376
    s_add_u32 s46, s54, 27648
    buffer_load_dwordx4 v5, s[16:19], s46 offen lds
    s_add_u32 m0, s43, 117760
    s_add_u32 s46, s55, 82944
    buffer_load_dwordx4 v3, s[20:23], s46 offen lds
    s_add_u32 s52, s52, 128
    s_cmp_eq_u32 s52, 1152
    s_cselect_b32 s52, 0, s52
    s_mul_i32 s53, s52, 1728
    s_add_u32 s54, s44, s52
    s_add_u32 s55, s41, s53
    s_add_u32 m0, s43, 131072
    s_add_u32 s46, s54, 0
    buffer_load_dwordx4 v4, s[16:19], s46 offen lds
    s_add_u32 m0, s43, 147456
    s_add_u32 s46, s55, 0
    buffer_load_dwordx4 v3, s[20:23], s46 offen lds
    s_add_u32 m0, s43, 132096
    s_add_u32 s46, s54, 9216
    buffer_load_dwordx4 v5, s[16:19], s46 offen lds
    s_add_u32 m0, s43, 148480
    s_add_u32 s46, s55, 27648
    buffer_load_dwordx4 v3, s[20:23], s46 offen lds
    s_add_u32 m0, s43, 133120
    s_add_u32 s46, s54, 18432
    buffer_load_dwordx4 v4, s[16:19], s46 offen lds
    s_add_u32 m0, s43, 149504
    s_add_u32 s46, s55, 55296
    buffer_load_dwordx4 v3, s[20:23], s46 offen lds
    s_add_u32 m0, s43, 134144
    s_add_u32 s46, s54, 27648
    buffer_load_dwordx4 v5, s[16:19], s46 offen lds
    s_add_u32 m0, s43, 150528
    s_add_u32 s46, s55, 82944
    buffer_load_dwordx4 v3, s[20:23], s46 offen lds
    s_mov_b64 exec, 0xffffff
    buffer_load_dword v17, v11, s[80:83], s56 offen
    s_mov_b64 exec, -1
    s_waitcnt vmcnt(17)
    s_barrier
    s_cmp_lg_u32 s36, 0
    s_cbranch_scc1 sequential_preLN__sliding_block__glu_gated_bilinear__prompt_kernel_zl5
    buffer_load_dword v20, v21, s[72:75], 0 offen sc1
sequential_preLN__sliding_block__glu_gated_bilinear__prompt_kernel_zl5:
    s_add_u32 s52, s52, 128
    s_cmp_eq_u32 s52, 1152
    s_cselect_b32 s52, 0, s52
    s_mul_i32 s53, s52, 1728
    s_add_u32 s54, s44, s52
    s_add_u32 s55, s41, s53
    s_add_u32 m0, s43, 0
    s_add_u32 s46, s54, 0
    buffer_load_dwordx4 v4, s[16:19], s46 offen lds
    s_add_u32 m0, s43, 16384
    s_add_u32 s46, s55, 0
    buffer_load_dwordx4 v3, s[20:23], s46 offen lds
    s_add_u32 m0, s43, 1024
    s_add_u32 s46, s54, 9216
    buffer_load_dwordx4 v5, s[16:19], s46 offen lds
    s_add_u32 m0, s43, 17408
    s_add_u32 s46, s55, 27648
    buffer_load_dwordx4 v3, s[20:23], s46 offen lds
    s_add_u32 m0, s43, 2048
    s_add_u32 s46, s54, 18432
    buffer_load_dwordx4 v4, s[16:19], s46 offen lds
    s_add_u32 m0, s43, 18432
    s_add_u32 s46, s55, 55296
    buffer_load_dwordx4 v3, s[20:23], s46 offen lds
    s_add_u32 m0, s43, 3072
    s_add_u32 s46, s54, 27648
    buffer_load_dwordx4 v5, s[16:19], s46 offen lds
    s_add_u32 m0, s43, 19456
    s_add_u32 s46, s55, 82944
    buffer_load_dwordx4 v3, s[20:23], s46 offen lds
    s_waitcnt vmcnt(17)
    s_barrier
    s_add_u32 s52, s52, 128
    s_cmp_eq_u32 s52, 1152
    s_cselect_b32 s52, 0, s52
    s_mul_i32 s53, s52, 1728
    s_add_u32 s54, s44, s52
    s_add_u32 s55, s41, s53
    s_add_u32 m0, s43, 32768
    s_add_u32 s46, s54, 0
    buffer_load_dwordx4 v4, s[16:19], s46 offen lds
    s_add_u32 m0, s43, 49152
    s_add_u32 s46, s55, 0
    buffer_load_dwordx4 v3, s[20:23], s46 offen lds
    s_add_u32 m0, s43, 33792
    s_add_u32 s46, s54, 9216
    buffer_load_dwordx4 v5, s[16:19], s46 offen lds
    s_add_u32 m0, s43, 50176
    s_add_u32 s46, s55, 27648
    buffer_load_dwordx4 v3, s[20:23], s46 offen lds
    s_add_u32 m0, s43, 34816
    s_add_u32 s46, s54, 18432
    buffer_load_dwordx4 v4, s[16:19], s46 offen lds
    s_add_u32 m0, s43, 51200
    s_add_u32 s46, s55, 55296
    buffer_load_dwordx4 v3, s[20:23], s46 offen lds
    s_add_u32 m0, s43, 35840
    s_add_u32 s46, s54, 27648
    buffer_load_dwordx4 v5, s[16:19], s46 offen lds
    s_add_u32 m0, s43, 52224
    s_add_u32 s46, s55, 82944
    buffer_load_dwordx4 v3, s[20:23], s46 offen lds
    s_waitcnt vmcnt(17)
    s_barrier
    s_add_u32 s52, s52, 128
    s_cmp_eq_u32 s52, 1152
    s_cselect_b32 s52, 0, s52
    s_mul_i32 s53, s52, 1728
    s_add_u32 s54, s44, s52
    s_add_u32 s55, s41, s53
    s_add_u32 m0, s43, 65536
    s_add_u32 s46, s54, 0
    buffer_load_dwordx4 v4, s[16:19], s46 offen lds
    s_add_u32 m0, s43, 81920
    s_add_u32 s46, s55, 0
    buffer_load_dwordx4 v3, s[20:23], s46 offen lds
    s_add_u32 m0, s43, 66560
    s_add_u32 s46, s54, 9216
    buffer_load_dwordx4 v5, s[16:19], s46 offen lds
    s_add_u32 m0, s43, 82944
    s_add_u32 s46, s55, 27648
    buffer_load_dwordx4 v3, s[20:23], s46 offen lds
    s_add_u32 m0, s43, 67584
    s_add_u32 s46, s54, 18432
    buffer_load_dwordx4 v4, s[16:19], s46 offen lds
    s_add_u32 m0, s43, 83968
    s_add_u32 s46, s55, 55296
    buffer_load_dwordx4 v3, s[20:23], s46 offen lds
    s_add_u32 m0, s43, 68608
    s_add_u32 s46, s54, 27648
    buffer_load_dwordx4 v5, s[16:19], s46 offen lds
    s_add_u32 m0, s43, 84992
    s_add_u32 s46, s55, 82944
    buffer_load_dwordx4 v3, s[20:23], s46 offen lds
    s_waitcnt vmcnt(16)
    s_cmp_lg_u32 s36, 0
    s_cbranch_scc1 sequential_preLN__sliding_block__glu_gated_bilinear__prompt_kernel_z06
    s_mov_b32 s46, 4096
sequential_preLN__sliding_block__glu_gated_bilinear__prompt_kernel_z0l7:
    v_cmp_eq_u32 vcc, 0, v20
    s_cbranch_vccz sequential_preLN__sliding_block__glu_gated_bilinear__prompt_kernel_z06
    s_sleep 2
    buffer_load_dword v20, v21, s[72:75], 0 offen sc1
    s_waitcnt vmcnt(0)
    s_sub_u32 s46, s46, 1
    s_cbranch_scc0 sequential_preLN__sliding_block__glu_gated_bilinear__prompt_kernel_z0l7
sequential_preLN__sliding_block__glu_gated_bilinear__prompt_kernel_z06:
    s_barrier
    s_add_u32 s52, s52, 128
    s_cmp_eq_u32 s52, 1152
    s_cselect_b32 s52, 0, s52
    s_mul_i32 s53, s52, 1728
    s_add_u32 s54, s44, s52
    s_add_u32 s55, s41, s53
    s_add_u32 m0, s43, 98304
    s_add_u32 s46, s54, 0
    buffer_load_dwordx4 v4, s[16:19], s46 offen lds
    s_add_u32 m0, s43, 114688
    s_add_u32 s46, s55, 0
    buffer_load_dwordx4 v3, s[20:23], s46 offen lds
    s_add_u32 m0, s43, 99328
    s_add_u32 s46, s54, 9216
    buffer_load_dwordx4 v5, s[16:19], s46 offen lds
    s_add_u32 m0, s43, 115712
    s_add_u32 s46, s55, 27648
    buffer_load_dwordx4 v3, s[20:23], s46 offen lds
    s_add_u32 m0, s43, 100352
    s_add_u32 s46, s54, 18432
    buffer_load_dwordx4 v4, s[16:19], s46 offen lds
    s_add_u32 m0, s43, 116736
    s_add_u32 s46, s55, 55296
    buffer_load_dwordx4 v3, s[20:23], s46 offen lds
    s_add_u32 m0, s43, 101376
    s_add_u32 s46, s54, 27648
    buffer_load_dwordx4 v5, s[16:19], s46 offen lds
    s_add_u32 m0, s43, 117760
    s_add_u32 s46, s55, 82944
    buffer_load_dwordx4 v3, s[20:23], s46 offen lds
    s_cmp_lg_u32 s36, 0
    s_cbranch_scc1 sequential_preLN__sliding_block__glu_gated_bilinear__prompt_kernel_fd8
    s_lshr_b32 s46, s2, 3
    s_mul_i32 s46, s46, 128
    s_and_b32 s47, s2, 7
    s_lshl_b32 s47, s47, 2
    s_add_u32 s46, s46, s47
    s_add_u32 s46, s46, 0xd00040
    v_mov_b32 v20, 1
    s_mov_b64 exec, 1
    buffer_store_dword v20, off, s[32:35], s46 sc1
    s_mov_b64 exec, -1
sequential_preLN__sliding_block__glu_gated_bilinear__prompt_kernel_fd8:
    s_waitcnt vmcnt(16)
    s_barrier
    s_mov_b64 exec, 0
    s_waitcnt lgkmcnt(0)
    s_call_b64 s[98:99], pfd_2
    s_branch pfc_2
pfd_2:
    s_cmp_eq_u32 s36, 0
    s_cbranch_scc1 pg_a
    s_cmp_eq_u32 s36, 1
    s_cbranch_scc1 pg_b
    s_cmp_eq_u32 s36, 2
    s_cbranch_scc1 pg_c
    s_branch pg_d
pfc_2:
    s_mov_b64 exec, -1
    s_waitcnt vmcnt(8)
    s_barrier
    s_add_u32 s46, s77, 0
    s_add_u32 m0, s76, 0
    s_nop 0
    buffer_load_dwordx4 v16, s[60:63], s46 offen lds
    s_add_u32 s46, s77, 0
    s_add_u32 m0, s76, 8192
    s_nop 0
    buffer_load_dwordx4 v16, s[64:67], s46 offen lds
    s_add_u32 s46, s77, 294912
    s_add_u32 m0, s76, 4096
    s_nop 0
    buffer_load_dwordx4 v16, s[60:63], s46 offen lds
    s_add_u32 s46, s77, 294912
    s_add_u32 m0, s76, 12288
    s_nop 0
    buffer_load_dwordx4 v16, s[64:67], s46 offen lds
    s_add_u32 s46, s77, 589824
    s_add_u32 m0, s76, 16384
    s_nop 0
    buffer_load_dwordx4 v16, s[60:63], s46 offen lds
    s_add_u32 s46, s77, 589824
    s_add_u32 m0, s76, 24576
    s_nop 0
    buffer_load_dwordx4 v16, s[64:67], s46 offen lds
    s_add_u32 s46, s77, 884736
    s_add_u32 m0, s76, 20480
    s_nop 0
    buffer_load_dwordx4 v16, s[60:63], s46 offen lds
    s_add_u32 s46, s77, 884736
    s_add_u32 m0, s76, 28672
    s_nop 0
    buffer_load_dwordx4 v16, s[64:67], s46 offen lds
    s_waitcnt vmcnt(8)
    s_barrier
    s_add_u32 s46, s77, 1179648
    s_add_u32 m0, s76, 32768
    s_nop 0
    buffer_load_dwordx4 v16, s[60:63], s46 offen lds
    s_add_u32 s46, s77, 1179648
    s_add_u32 m0, s76, 40960
    s_nop 0
    buffer_load_dwordx4 v16, s[64:67], s46 offen lds
    s_add_u32 s46, s77, 1474560
    s_add_u32 m0, s76, 36864
    s_nop 0
    buffer_load_dwordx4 v16, s[60:63], s46 offen lds
    s_add_u32 s46, s77, 1474560
    s_add_u32 m0, s76, 45056
    s_nop 0
    buffer_load_dwordx4 v16, s[64:67], s46 offen lds
    s_add_u32 s46, s77, 1769472
    s_add_u32 m0, s76, 49152
    s_nop 0
    buffer_load_dwordx4 v16, s[60:63], s46 offen lds
    s_add_u32 s46, s77, 1769472
    s_add_u32 m0, s76, 57344
    s_nop 0
    buffer_load_dwordx4 v16, s[64:67], s46 offen lds
    s_add_u32 s46, s77, 2064384
    s_add_u32 m0, s76, 53248
    s_nop 0
    buffer_load_dwordx4 v16, s[60:63], s46 offen lds
    s_add_u32 s46, s77, 2064384
    s_add_u32 m0, s76, 61440
    s_nop 0
    buffer_load_dwordx4 v16, s[64:67], s46 offen lds
    s_barrier
    s_mov_b64 exec, 0
    s_waitcnt lgkmcnt(0)
    s_call_b64 s[98:99], pfd_3
    s_branch pfc_3
pfd_3:
    s_cmp_eq_u32 s36, 0
    s_cbranch_scc1 pg_e
    s_cmp_eq_u32 s36, 1
    s_cbranch_scc1 pf_ret
    s_cmp_eq_u32 s36, 2
    s_cbranch_scc1 pf_ret
    s_branch pf_ret
pfc_3:
    s_mov_b64 exec, -1
    s_barrier
    s_add_u32 s46, s77, 2359296
pg_1:
    s_cbranch_execz pf_ret
    s_add_u32 m0, s76, 65536
    s_nop 0
    buffer_load_dwordx4 v16, s[60:63], s46 offen lds
    s_add_u32 s46, s77, 2359296
    s_add_u32 m0, s76, 73728
    s_nop 0
    buffer_load_dwordx4 v16, s[64:67], s46 offen lds
    s_add_u32 s46, s77, 2654208
    s_add_u32 m0, s76, 69632
    s_nop 0
    buffer_load_dwordx4 v16, s[60:63], s46 offen lds
    s_add_u32 s46, s77, 2654208
    s_add_u32 m0, s76, 77824
    s_nop 0
    buffer_load_dwordx4 v16, s[64:67], s46 offen lds
    s_add_u32 s46, s77, 2949120
    s_add_u32 m0, s76, 81920
    s_nop 0
    buffer_load_dwordx4 v16, s[60:63], s46 offen lds
    s_add_u32 s46, s77, 2949120
    s_add_u32 m0, s76, 90112
    s_nop 0
    buffer_load_dwordx4 v16, s[64:67], s46 offen lds
    s_add_u32 s46, s77, 3244032
    s_add_u32 m0, s76, 86016
    s_nop 0
    buffer_load_dwordx4 v16, s[60:63], s46 offen lds
    s_add_u32 s46, s77, 3244032
    s_add_u32 m0, s76, 94208
    s_nop 0
    buffer_load_dwordx4 v16, s[64:67], s46 offen lds
    s_add_u32 s36, s36, 4
    s_branch sequential_preLN__sliding_block__glu_gated_bilinear__prompt_kernel_entry
sequential_preLN__sliding_block__glu_gated_bilinear__prompt_kernel_cons1:
    s_mov_b64 exec, -1
    v_bfe_u32 v68, v2, 2, 2
    v_lshlrev_b32 v68, 6, v68
    v_bfe_u32 v69, v2, 4, 1
    v_lshl_add_u32 v68, v69, 5, v68
    v_and_b32 v69, 3, v2
    v_lshl_add_u32 v68, v69, 3, v68
    v_lshl_add_u32 v68, v70, 10, v68
    s_lshl_b32 s42, s40, 13
    s_lshl_b32 s45, s39, 9
    s_add_u32 s42, s42, s45
    s_add_u32 s42, s42, 16384
    v_add_u32 v10, s42, v68
    v_xor_b32 v11, 512, v10
    v_add_u32 v12, 0x10000, v10
    v_add_u32 v13, 0x10000, v11
    v_add_u32 v14, 0x20000, v10
    v_add_u32 v15, 0x20000, v11
    v_and_b32 v68, 31, v2
    v_bfe_u32 v69, v2, 1, 3
    v_xor_b32 v69, v69, v70
    v_lshlrev_b32 v69, 4, v69
    v_lshl_add_u32 v69, v68, 7, v69
    s_lshl_b32 s42, s39, 13
    s_lshl_b32 s45, s40, 12
    s_add_u32 s42, s42, s45
    v_add_u32 v16, s42, v69
    v_xor_b32 v17, 4096, v16
    v_xor_b32 v18, 32, v16
    v_xor_b32 v19, 4128, v16
    v_xor_b32 v20, 64, v16
    v_xor_b32 v21, 4160, v16
    v_xor_b32 v22, 96, v16
    v_xor_b32 v23, 4192, v16
    v_add_u32 v24, 0x10000, v16
    v_add_u32 v25, 0x10000, v17
    v_add_u32 v26, 0x10000, v18
    v_add_u32 v27, 0x10000, v19
    v_add_u32 v28, 0x10000, v20
    v_add_u32 v29, 0x10000, v21
    v_add_u32 v30, 0x10000, v22
    v_add_u32 v31, 0x10000, v23
    v_add_u32 v32, 0x20000, v16
    v_add_u32 v33, 0x20000, v17
    v_add_u32 v34, 0x20000, v18
    v_add_u32 v35, 0x20000, v19
    v_add_u32 v36, 0x20000, v20
    v_add_u32 v37, 0x20000, v21
    v_add_u32 v38, 0x20000, v22
    v_add_u32 v39, 0x20000, v23
    v_lshlrev_b32 v6, 3, v68
    v_lshl_add_u32 v6, v70, 8, v6
    v_mul_u32_u24 v7, 9216, v70
    v_lshl_add_u32 v7, v68, 4, v7
    s_mov_b32 s46, 0x10100101
    s_mov_b32 s47, 0x10100101
    v_mov_b32 v69, 0x3f803f80
    v_cndmask_b32 v40, 0, v69, s[46:47]
    v_cndmask_b32 v41, 0, v69, s[46:47]
    v_cndmask_b32 v42, 0, v69, s[46:47]
    v_cndmask_b32 v43, 0, v69, s[46:47]
    v_mov_b32 v56, 0
    v_mov_b32 v57, 0
    v_mov_b32 v58, 0
    v_mov_b32 v59, 0
    s_lshl_b32 s48, s37, 2
    s_lshl_b32 s42, s39, 1
    s_add_u32 s48, s48, s42
    s_add_u32 s48, s48, s40
    s_lshl_b32 s49, s38, 2
    s_lshl_b32 s42, s40, 1
    s_add_u32 s49, s49, s42
    s_add_u32 s49, s49, s39
    s_waitcnt lgkmcnt(0)
    s_add_u32 s24, s10, 0x0
    s_addc_u32 s25, s11, 0
    s_mov_b32 s26, 0x480000
    s_mov_b32 s27, 0x00020000
    s_add_u32 s28, s10, 0x500000
    s_addc_u32 s29, s11, 0
    s_mov_b32 s30, 0x240000
    s_mov_b32 s31, 0x00020000
    s_mov_b32 s32, s10
    s_mov_b32 s33, s11
    s_mov_b32 s34, 0x10000000
    s_mov_b32 s35, 0x00020000
    s_mul_i32 s51, s37, 14
    s_add_u32 s51, s51, s38
    s_cmp_ge_u32 s38, 9
    s_cbranch_scc1 sequential_preLN__sliding_block__glu_gated_bilinear__prompt_kernel_v9
    s_mov_b64 exec, 0
    s_waitcnt lgkmcnt(0)
    s_call_b64 s[98:99], pfd_4
    s_branch pfc_4
pfd_4:
    s_cmp_eq_u32 s36, 0
    s_cbranch_scc1 pg_7
    s_cmp_eq_u32 s36, 1
    s_cbranch_scc1 pg_8
    s_cmp_eq_u32 s36, 2
    s_cbranch_scc1 pg_9
    s_branch pg_1
pfc_4:
    s_mov_b64 exec, -1
    s_barrier
    ds_read_b128 v[136:139], v16 offset:0
    ds_read_b64_tr_b16 v[144:145], v10 offset:0
    ds_read_b64_tr_b16 v[146:147], v10 offset:256
    ds_read_b128 v[140:143], v17 offset:0
    ds_read_b64_tr_b16 v[148:149], v11 offset:0
    ds_read_b64_tr_b16 v[150:151], v11 offset:256
    ds_read_b128 v[152:155], v18 offset:0
    ds_read_b64_tr_b16 v[160:161], v10 offset:2048
    ds_read_b64_tr_b16 v[162:163], v10 offset:2304
    ds_read_b128 v[156:159], v19 offset:0
    ds_read_b64_tr_b16 v[164:165], v11 offset:2048
    ds_read_b64_tr_b16 v[166:167], v11 offset:2304
    s_waitcnt lgkmcnt(6)
    v_mfma_f32_32x32x16_bf16 v[72:87], v[144:147], v[136:139], 0
    ds_read_b128 v[168:171], v20 offset:0
    ds_read_b64_tr_b16 v[176:177], v10 offset:4096
    v_lshlrev_b32 v60, 16, v136
    v_and_b32 v61, 0xffff0000, v136
    v_lshlrev_b32 v62, 16, v137
    v_mfma_f32_32x32x16_bf16 v[104:119], v[148:151], v[136:139], 0
    ds_read_b64_tr_b16 v[178:179], v10 offset:4352
    ds_read_b128 v[172:175], v21 offset:0
    v_and_b32 v63, 0xffff0000, v137
    v_lshlrev_b32 v64, 16, v138
    v_and_b32 v65, 0xffff0000, v138
    v_mfma_f32_32x32x16_bf16 v[88:103], v[144:147], v[140:143], 0
    ds_read_b64_tr_b16 v[180:181], v11 offset:4096
    ds_read_b64_tr_b16 v[182:183], v11 offset:4352
    v_lshlrev_b32 v66, 16, v139
    v_and_b32 v67, 0xffff0000, v139
    v_fmac_f32 v56, v60, v60
    v_mfma_f32_32x32x16_bf16 v[120:135], v[148:151], v[140:143], 0
    v_fmac_f32 v57, v61, v61
    v_fmac_f32 v58, v62, v62
    v_fmac_f32 v59, v63, v63
    v_fmac_f32 v56, v64, v64
    v_fmac_f32 v57, v65, v65
    v_mfma_f32_16x16x32_bf16 v[48:51], v[40:43], v[136:139], 0
    v_fmac_f32 v58, v66, v66
    v_mfma_f32_16x16x32_bf16 v[52:55], v[40:43], v[144:147], 0
    v_fmac_f32 v59, v67, v67
    s_waitcnt lgkmcnt(6)
    v_mfma_f32_32x32x16_bf16 v[72:87], v[160:163], v[152:155], v[72:87]
    ds_read_b128 v[136:139], v22 offset:0
    ds_read_b64_tr_b16 v[144:145], v10 offset:6144
    v_lshlrev_b32 v60, 16, v152
    v_and_b32 v61, 0xffff0000, v152
    v_lshlrev_b32 v62, 16, v153
    v_mfma_f32_32x32x16_bf16 v[104:119], v[164:167], v[152:155], v[104:119]
    ds_read_b64_tr_b16 v[146:147], v10 offset:6400
    ds_read_b128 v[140:143], v23 offset:0
    v_and_b32 v63, 0xffff0000, v153
    v_lshlrev_b32 v64, 16, v154
    v_and_b32 v65, 0xffff0000, v154
    v_mfma_f32_32x32x16_bf16 v[88:103], v[160:163], v[156:159], v[88:103]
    ds_read_b64_tr_b16 v[148:149], v11 offset:6144
    ds_read_b64_tr_b16 v[150:151], v11 offset:6400
    v_lshlrev_b32 v66, 16, v155
    v_and_b32 v67, 0xffff0000, v155
    v_fmac_f32 v56, v60, v60
    v_mfma_f32_32x32x16_bf16 v[120:135], v[164:167], v[156:159], v[120:135]
    v_fmac_f32 v57, v61, v61
    v_fmac_f32 v58, v62, v62
    v_fmac_f32 v59, v63, v63
    v_fmac_f32 v56, v64, v64
    v_fmac_f32 v57, v65, v65
    v_mfma_f32_16x16x32_bf16 v[48:51], v[40:43], v[152:155], v[48:51]
    v_fmac_f32 v58, v66, v66
    v_mfma_f32_16x16x32_bf16 v[52:55], v[40:43], v[160:163], v[52:55]
    v_fmac_f32 v59, v67, v67
    s_barrier
    s_waitcnt lgkmcnt(6)
    v_mfma_f32_32x32x16_bf16 v[72:87], v[176:179], v[168:171], v[72:87]
    ds_read_b128 v[152:155], v16 offset:32768
    ds_read_b64_tr_b16 v[160:161], v10 offset:32768
    v_lshlrev_b32 v60, 16, v168
    v_and_b32 v61, 0xffff0000, v168
    v_lshlrev_b32 v62, 16, v169
    v_mfma_f32_32x32x16_bf16 v[104:119], v[180:183], v[168:171], v[104:119]
    ds_read_b64_tr_b16 v[162:163], v10 offset:33024
    ds_read_b128 v[156:159], v17 offset:32768
    v_and_b32 v63, 0xffff0000, v169
    v_lshlrev_b32 v64, 16, v170
    v_and_b32 v65, 0xffff0000, v170
    v_mfma_f32_32x32x16_bf16 v[88:103], v[176:179], v[172:175], v[88:103]
    ds_read_b64_tr_b16 v[164:165], v11 offset:32768
    ds_read_b64_tr_b16 v[166:167], v11 offset:33024
    v_lshlrev_b32 v66, 16, v171
    v_and_b32 v67, 0xffff0000, v171
    v_fmac_f32 v56, v60, v60
    v_mfma_f32_32x32x16_bf16 v[120:135], v[180:183], v[172:175], v[120:135]
    v_fmac_f32 v57, v61, v61
    v_fmac_f32 v58, v62, v62
    v_fmac_f32 v59, v63, v63
    v_fmac_f32 v56, v64, v64
    v_fmac_f32 v57, v65, v65
    v_mfma_f32_16x16x32_bf16 v[48:51], v[40:43], v[168:171], v[48:51]
    v_fmac_f32 v58, v66, v66
    v_mfma_f32_16x16x32_bf16 v[52:55], v[40:43], v[176:179], v[52:55]
    v_fmac_f32 v59, v67, v67
    s_waitcnt lgkmcnt(6)
    v_mfma_f32_32x32x16_bf16 v[72:87], v[144:147], v[136:139], v[72:87]
    ds_read_b128 v[168:171], v18 offset:32768
    ds_read_b64_tr_b16 v[176:177], v10 offset:34816
    v_lshlrev_b32 v60, 16, v136
    v_and_b32 v61, 0xffff0000, v136
    v_lshlrev_b32 v62, 16, v137
    v_mfma_f32_32x32x16_bf16 v[104:119], v[148:151], v[136:139], v[104:119]
    ds_read_b64_tr_b16 v[178:179], v10 offset:35072
    ds_read_b128 v[172:175], v19 offset:32768
    v_and_b32 v63, 0xffff0000, v137
    v_lshlrev_b32 v64, 16, v138
    v_and_b32 v65, 0xffff0000, v138
    v_mfma_f32_32x32x16_bf16 v[88:103], v[144:147], v[140:143], v[88:103]
    ds_read_b64_tr_b16 v[180:181], v11 offset:34816
    ds_read_b64_tr_b16 v[182:183], v11 offset:35072
    v_lshlrev_b32 v66, 16, v139
    v_and_b32 v67, 0xffff0000, v139
    v_fmac_f32 v56, v60, v60
    v_mfma_f32_32x32x16_bf16 v[120:135], v[148:151], v[140:143], v[120:135]
    v_fmac_f32 v57, v61, v61
    v_fmac_f32 v58, v62, v62
    v_fmac_f32 v59, v63, v63
    v_fmac_f32 v56, v64, v64
    v_fmac_f32 v57, v65, v65
    v_mfma_f32_16x16x32_bf16 v[48:51], v[40:43], v[136:139], v[48:51]
    v_fmac_f32 v58, v66, v66
    v_mfma_f32_16x16x32_bf16 v[52:55], v[40:43], v[144:147], v[52:55]
    v_fmac_f32 v59, v67, v67
    s_waitcnt lgkmcnt(6)
    v_mfma_f32_32x32x16_bf16 v[72:87], v[160:163], v[152:155], v[72:87]
    ds_read_b128 v[136:139], v20 offset:32768
    ds_read_b64_tr_b16 v[144:145], v10 offset:36864
    v_lshlrev_b32 v60, 16, v152
    v_and_b32 v61, 0xffff0000, v152
    v_lshlrev_b32 v62, 16, v153
    v_mfma_f32_32x32x16_bf16 v[104:119], v[164:167], v[152:155], v[104:119]
    ds_read_b64_tr_b16 v[146:147], v10 offset:37120
    ds_read_b128 v[140:143], v21 offset:32768
    v_and_b32 v63, 0xffff0000, v153
    v_lshlrev_b32 v64, 16, v154
    v_and_b32 v65, 0xffff0000, v154
    v_mfma_f32_32x32x16_bf16 v[88:103], v[160:163], v[156:159], v[88:103]
    ds_read_b64_tr_b16 v[148:149], v11 offset:36864
    ds_read_b64_tr_b16 v[150:151], v11 offset:37120
    v_lshlrev_b32 v66, 16, v155
    v_and_b32 v67, 0xffff0000, v155
    v_fmac_f32 v56, v60, v60
    v_mfma_f32_32x32x16_bf16 v[120:135], v[164:167], v[156:159], v[120:135]
    v_fmac_f32 v57, v61, v61
    v_fmac_f32 v58, v62, v62
    v_fmac_f32 v59, v63, v63
    v_fmac_f32 v56, v64, v64
    v_fmac_f32 v57, v65, v65
    v_mfma_f32_16x16x32_bf16 v[48:51], v[40:43], v[152:155], v[48:51]
    v_fmac_f32 v58, v66, v66
    v_mfma_f32_16x16x32_bf16 v[52:55], v[40:43], v[160:163], v[52:55]
    v_fmac_f32 v59, v67, v67
    s_waitcnt lgkmcnt(6)
    v_mfma_f32_32x32x16_bf16 v[72:87], v[176:179], v[168:171], v[72:87]
    ds_read_b128 v[152:155], v22 offset:32768
    ds_read_b64_tr_b16 v[160:161], v10 offset:38912
    v_lshlrev_b32 v60, 16, v168
    v_and_b32 v61, 0xffff0000, v168
    v_lshlrev_b32 v62, 16, v169
    v_mfma_f32_32x32x16_bf16 v[104:119], v[180:183], v[168:171], v[104:119]
    ds_read_b64_tr_b16 v[162:163], v10 offset:39168
    ds_read_b128 v[156:159], v23 offset:32768
    v_and_b32 v63, 0xffff0000, v169
    v_lshlrev_b32 v64, 16, v170
    v_and_b32 v65, 0xffff0000, v170
    v_mfma_f32_32x32x16_bf16 v[88:103], v[176:179], v[172:175], v[88:103]
    ds_read_b64_tr_b16 v[164:165], v11 offset:38912
    ds_read_b64_tr_b16 v[166:167], v11 offset:39168
    v_lshlrev_b32 v66, 16, v171
    v_and_b32 v67, 0xffff0000, v171
    v_fmac_f32 v56, v60, v60
    v_mfma_f32_32x32x16_bf16 v[120:135], v[180:183], v[172:175], v[120:135]
    v_fmac_f32 v57, v61, v61
    v_fmac_f32 v58, v62, v62
    v_fmac_f32 v59, v63, v63
    v_fmac_f32 v56, v64, v64
    v_fmac_f32 v57, v65, v65
    v_mfma_f32_16x16x32_bf16 v[48:51], v[40:43], v[168:171], v[48:51]
    v_fmac_f32 v58, v66, v66
    v_mfma_f32_16x16x32_bf16 v[52:55], v[40:43], v[176:179], v[52:55]
    v_fmac_f32 v59, v67, v67
    s_barrier
    s_waitcnt lgkmcnt(6)
    v_mfma_f32_32x32x16_bf16 v[72:87], v[144:147], v[136:139], v[72:87]
    ds_read_b128 v[168:171], v24 offset:0
    ds_read_b64_tr_b16 v[176:177], v12 offset:0
    v_lshlrev_b32 v60, 16, v136
    v_and_b32 v61, 0xffff0000, v136
    v_lshlrev_b32 v62, 16, v137
    v_mfma_f32_32x32x16_bf16 v[104:119], v[148:151], v[136:139], v[104:119]
    ds_read_b64_tr_b16 v[178:179], v12 offset:256
    ds_read_b128 v[172:175], v25 offset:0
    v_and_b32 v63, 0xffff0000, v137
    v_lshlrev_b32 v64, 16, v138
    v_and_b32 v65, 0xffff0000, v138
    v_mfma_f32_32x32x16_bf16 v[88:103], v[144:147], v[140:143], v[88:103]
    ds_read_b64_tr_b16 v[180:181], v13 offset:0
    ds_read_b64_tr_b16 v[182:183], v13 offset:256
    v_lshlrev_b32 v66, 16, v139
    v_and_b32 v67, 0xffff0000, v139
    v_fmac_f32 v56, v60, v60
    v_mfma_f32_32x32x16_bf16 v[120:135], v[148:151], v[140:143], v[120:135]
    v_fmac_f32 v57, v61, v61
    v_fmac_f32 v58, v62, v62
    v_fmac_f32 v59, v63, v63
    v_fmac_f32 v56, v64, v64
    v_fmac_f32 v57, v65, v65
    v_mfma_f32_16x16x32_bf16 v[48:51], v[40:43], v[136:139], v[48:51]
    v_fmac_f32 v58, v66, v66
    v_mfma_f32_16x16x32_bf16 v[52:55], v[40:43], v[144:147], v[52:55]
    v_fmac_f32 v59, v67, v67
    s_waitcnt lgkmcnt(6)
    v_mfma_f32_32x32x16_bf16 v[72:87], v[160:163], v[152:155], v[72:87]
    ds_read_b128 v[136:139], v26 offset:0
    ds_read_b64_tr_b16 v[144:145], v12 offset:2048
    v_lshlrev_b32 v60, 16, v152
    v_and_b32 v61, 0xffff0000, v152
    v_lshlrev_b32 v62, 16, v153
    v_mfma_f32_32x32x16_bf16 v[104:119], v[164:167], v[152:155], v[104:119]
    ds_read_b64_tr_b16 v[146:147], v12 offset:2304
    ds_read_b128 v[140:143], v27 offset:0
    v_and_b32 v63, 0xffff0000, v153
    v_lshlrev_b32 v64, 16, v154
    v_and_b32 v65, 0xffff0000, v154
    v_mfma_f32_32x32x16_bf16 v[88:103], v[160:163], v[156:159], v[88:103]
    ds_read_b64_tr_b16 v[148:149], v13 offset:2048
    ds_read_b64_tr_b16 v[150:151], v13 offset:2304
    v_lshlrev_b32 v66, 16, v155
    v_and_b32 v67, 0xffff0000, v155
    v_fmac_f32 v56, v60, v60
    v_mfma_f32_32x32x16_bf16 v[120:135], v[164:167], v[156:159], v[120:135]
    v_fmac_f32 v57, v61, v61
    v_fmac_f32 v58, v62, v62
    v_fmac_f32 v59, v63, v63
    v_fmac_f32 v56, v64, v64
    v_fmac_f32 v57, v65, v65
    v_mfma_f32_16x16x32_bf16 v[48:51], v[40:43], v[152:155], v[48:51]
    v_fmac_f32 v58, v66, v66
    v_mfma_f32_16x16x32_bf16 v[52:55], v[40:43], v[160:163], v[52:55]
    v_fmac_f32 v59, v67, v67
    s_waitcnt lgkmcnt(6)
    v_mfma_f32_32x32x16_bf16 v[72:87], v[176:179], v[168:171], v[72:87]
    ds_read_b128 v[152:155], v28 offset:0
    ds_read_b64_tr_b16 v[160:161], v12 offset:4096
    v_lshlrev_b32 v60, 16, v168
    v_and_b32 v61, 0xffff0000, v168
    v_lshlrev_b32 v62, 16, v169
    v_mfma_f32_32x32x16_bf16 v[104:119], v[180:183], v[168:171], v[104:119]
    ds_read_b64_tr_b16 v[162:163], v12 offset:4352
    ds_read_b128 v[156:159], v29 offset:0
    v_and_b32 v63, 0xffff0000, v169
    v_lshlrev_b32 v64, 16, v170
    v_and_b32 v65, 0xffff0000, v170
    v_mfma_f32_32x32x16_bf16 v[88:103], v[176:179], v[172:175], v[88:103]
    ds_read_b64_tr_b16 v[164:165], v13 offset:4096
    ds_read_b64_tr_b16 v[166:167], v13 offset:4352
    v_lshlrev_b32 v66, 16, v171
    v_and_b32 v67, 0xffff0000, v171
    v_fmac_f32 v56, v60, v60
    v_mfma_f32_32x32x16_bf16 v[120:135], v[180:183], v[172:175], v[120:135]
    v_fmac_f32 v57, v61, v61
    v_fmac_f32 v58, v62, v62
    v_fmac_f32 v59, v63, v63
    v_fmac_f32 v56, v64, v64
    v_fmac_f32 v57, v65, v65
    v_mfma_f32_16x16x32_bf16 v[48:51], v[40:43], v[168:171], v[48:51]
    v_fmac_f32 v58, v66, v66
    v_mfma_f32_16x16x32_bf16 v[52:55], v[40:43], v[176:179], v[52:55]
    v_fmac_f32 v59, v67, v67
    s_waitcnt lgkmcnt(6)
    v_mfma_f32_32x32x16_bf16 v[72:87], v[144:147], v[136:139], v[72:87]
    ds_read_b128 v[168:171], v30 offset:0
    ds_read_b64_tr_b16 v[176:177], v12 offset:6144
    v_lshlrev_b32 v60, 16, v136
    v_and_b32 v61, 0xffff0000, v136
    v_lshlrev_b32 v62, 16, v137
    v_mfma_f32_32x32x16_bf16 v[104:119], v[148:151], v[136:139], v[104:119]
    ds_read_b64_tr_b16 v[178:179], v12 offset:6400
    ds_read_b128 v[172:175], v31 offset:0
    v_and_b32 v63, 0xffff0000, v137
    v_lshlrev_b32 v64, 16, v138
    v_and_b32 v65, 0xffff0000, v138
    v_mfma_f32_32x32x16_bf16 v[88:103], v[144:147], v[140:143], v[88:103]
    ds_read_b64_tr_b16 v[180:181], v13 offset:6144
    ds_read_b64_tr_b16 v[182:183], v13 offset:6400
    v_lshlrev_b32 v66, 16, v139
    v_and_b32 v67, 0xffff0000, v139
    v_fmac_f32 v56, v60, v60
    v_mfma_f32_32x32x16_bf16 v[120:135], v[148:151], v[140:143], v[120:135]
    v_fmac_f32 v57, v61, v61
    v_fmac_f32 v58, v62, v62
    v_fmac_f32 v59, v63, v63
    v_fmac_f32 v56, v64, v64
    v_fmac_f32 v57, v65, v65
    v_mfma_f32_16x16x32_bf16 v[48:51], v[40:43], v[136:139], v[48:51]
    v_fmac_f32 v58, v66, v66
    v_mfma_f32_16x16x32_bf16 v[52:55], v[40:43], v[144:147], v[52:55]
    v_fmac_f32 v59, v67, v67
    s_barrier
    s_waitcnt lgkmcnt(6)
    v_mfma_f32_32x32x16_bf16 v[72:87], v[160:163], v[152:155], v[72:87]
    ds_read_b128 v[136:139], v24 offset:32768
    ds_read_b64_tr_b16 v[144:145], v12 offset:32768
    v_lshlrev_b32 v60, 16, v152
    v_and_b32 v61, 0xffff0000, v152
    v_lshlrev_b32 v62, 16, v153
    v_mfma_f32_32x32x16_bf16 v[104:119], v[164:167], v[152:155], v[104:119]
    ds_read_b64_tr_b16 v[146:147], v12 offset:33024
    ds_read_b128 v[140:143], v25 offset:32768
    v_and_b32 v63, 0xffff0000, v153
    v_lshlrev_b32 v64, 16, v154
    v_and_b32 v65, 0xffff0000, v154
    v_mfma_f32_32x32x16_bf16 v[88:103], v[160:163], v[156:159], v[88:103]
    ds_read_b64_tr_b16 v[148:149], v13 offset:32768
    ds_read_b64_tr_b16 v[150:151], v13 offset:33024
    v_lshlrev_b32 v66, 16, v155
    v_and_b32 v67, 0xffff0000, v155
    v_fmac_f32 v56, v60, v60
    v_mfma_f32_32x32x16_bf16 v[120:135], v[164:167], v[156:159], v[120:135]
    v_fmac_f32 v57, v61, v61
    v_fmac_f32 v58, v62, v62
    v_fmac_f32 v59, v63, v63
    v_fmac_f32 v56, v64, v64
    v_fmac_f32 v57, v65, v65
    v_mfma_f32_16x16x32_bf16 v[48:51], v[40:43], v[152:155], v[48:51]
    v_fmac_f32 v58, v66, v66
    v_mfma_f32_16x16x32_bf16 v[52:55], v[40:43], v[160:163], v[52:55]
    v_fmac_f32 v59, v67, v67
    s_waitcnt lgkmcnt(6)
    v_mfma_f32_32x32x16_bf16 v[72:87], v[176:179], v[168:171], v[72:87]
    ds_read_b128 v[152:155], v26 offset:32768
    ds_read_b64_tr_b16 v[160:161], v12 offset:34816
    v_lshlrev_b32 v60, 16, v168
    v_and_b32 v61, 0xffff0000, v168
    v_lshlrev_b32 v62, 16, v169
    v_mfma_f32_32x32x16_bf16 v[104:119], v[180:183], v[168:171], v[104:119]
    ds_read_b64_tr_b16 v[162:163], v12 offset:35072
    ds_read_b128 v[156:159], v27 offset:32768
    v_and_b32 v63, 0xffff0000, v169
    v_lshlrev_b32 v64, 16, v170
    v_and_b32 v65, 0xffff0000, v170
    v_mfma_f32_32x32x16_bf16 v[88:103], v[176:179], v[172:175], v[88:103]
    ds_read_b64_tr_b16 v[164:165], v13 offset:34816
    ds_read_b64_tr_b16 v[166:167], v13 offset:35072
    v_lshlrev_b32 v66, 16, v171
    v_and_b32 v67, 0xffff0000, v171
    v_fmac_f32 v56, v60, v60
    v_mfma_f32_32x32x16_bf16 v[120:135], v[180:183], v[172:175], v[120:135]
    v_fmac_f32 v57, v61, v61
    v_fmac_f32 v58, v62, v62
    v_fmac_f32 v59, v63, v63
    v_fmac_f32 v56, v64, v64
    v_fmac_f32 v57, v65, v65
    v_mfma_f32_16x16x32_bf16 v[48:51], v[40:43], v[168:171], v[48:51]
    v_fmac_f32 v58, v66, v66
    v_mfma_f32_16x16x32_bf16 v[52:55], v[40:43], v[176:179], v[52:55]
    v_fmac_f32 v59, v67, v67
    s_waitcnt lgkmcnt(6)
    v_mfma_f32_32x32x16_bf16 v[72:87], v[144:147], v[136:139], v[72:87]
    ds_read_b128 v[168:171], v28 offset:32768
    ds_read_b64_tr_b16 v[176:177], v12 offset:36864
    v_lshlrev_b32 v60, 16, v136
    v_and_b32 v61, 0xffff0000, v136
    v_lshlrev_b32 v62, 16, v137
    v_mfma_f32_32x32x16_bf16 v[104:119], v[148:151], v[136:139], v[104:119]
    ds_read_b64_tr_b16 v[178:179], v12 offset:37120
    ds_read_b128 v[172:175], v29 offset:32768
    v_and_b32 v63, 0xffff0000, v137
    v_lshlrev_b32 v64, 16, v138
    v_and_b32 v65, 0xffff0000, v138
    v_mfma_f32_32x32x16_bf16 v[88:103], v[144:147], v[140:143], v[88:103]
    ds_read_b64_tr_b16 v[180:181], v13 offset:36864
    ds_read_b64_tr_b16 v[182:183], v13 offset:37120
    v_lshlrev_b32 v66, 16, v139
    v_and_b32 v67, 0xffff0000, v139
    v_fmac_f32 v56, v60, v60
    v_mfma_f32_32x32x16_bf16 v[120:135], v[148:151], v[140:143], v[120:135]
    v_fmac_f32 v57, v61, v61
    v_fmac_f32 v58, v62, v62
    v_fmac_f32 v59, v63, v63
    v_fmac_f32 v56, v64, v64
    v_fmac_f32 v57, v65, v65
    v_mfma_f32_16x16x32_bf16 v[48:51], v[40:43], v[136:139], v[48:51]
    v_fmac_f32 v58, v66, v66
    v_mfma_f32_16x16x32_bf16 v[52:55], v[40:43], v[144:147], v[52:55]
    v_fmac_f32 v59, v67, v67
    s_waitcnt lgkmcnt(6)
    v_mfma_f32_32x32x16_bf16 v[72:87], v[160:163], v[152:155], v[72:87]
    ds_read_b128 v[136:139], v30 offset:32768
    ds_read_b64_tr_b16 v[144:145], v12 offset:38912
    v_lshlrev_b32 v60, 16, v152
    v_and_b32 v61, 0xffff0000, v152
    v_lshlrev_b32 v62, 16, v153
    v_mfma_f32_32x32x16_bf16 v[104:119], v[164:167], v[152:155], v[104:119]
    ds_read_b64_tr_b16 v[146:147], v12 offset:39168
    ds_read_b128 v[140:143], v31 offset:32768
    v_and_b32 v63, 0xffff0000, v153
    v_lshlrev_b32 v64, 16, v154
    v_and_b32 v65, 0xffff0000, v154
    v_mfma_f32_32x32x16_bf16 v[88:103], v[160:163], v[156:159], v[88:103]
    ds_read_b64_tr_b16 v[148:149], v13 offset:38912
    ds_read_b64_tr_b16 v[150:151], v13 offset:39168
    v_lshlrev_b32 v66, 16, v155
    v_and_b32 v67, 0xffff0000, v155
    v_fmac_f32 v56, v60, v60
    v_mfma_f32_32x32x16_bf16 v[120:135], v[164:167], v[156:159], v[120:135]
    v_fmac_f32 v57, v61, v61
    v_fmac_f32 v58, v62, v62
    v_fmac_f32 v59, v63, v63
    v_fmac_f32 v56, v64, v64
    v_fmac_f32 v57, v65, v65
    v_mfma_f32_16x16x32_bf16 v[48:51], v[40:43], v[152:155], v[48:51]
    v_fmac_f32 v58, v66, v66
    v_mfma_f32_16x16x32_bf16 v[52:55], v[40:43], v[160:163], v[52:55]
    v_fmac_f32 v59, v67, v67
    s_barrier
    s_waitcnt lgkmcnt(6)
    v_mfma_f32_32x32x16_bf16 v[72:87], v[176:179], v[168:171], v[72:87]
    ds_read_b128 v[152:155], v32 offset:0
    ds_read_b64_tr_b16 v[160:161], v14 offset:0
    v_lshlrev_b32 v60, 16, v168
    v_and_b32 v61, 0xffff0000, v168
    v_lshlrev_b32 v62, 16, v169
    v_mfma_f32_32x32x16_bf16 v[104:119], v[180:183], v[168:171], v[104:119]
    ds_read_b64_tr_b16 v[162:163], v14 offset:256
    ds_read_b128 v[156:159], v33 offset:0
    v_and_b32 v63, 0xffff0000, v169
    v_lshlrev_b32 v64, 16, v170
    v_and_b32 v65, 0xffff0000, v170
    v_mfma_f32_32x32x16_bf16 v[88:103], v[176:179], v[172:175], v[88:103]
    ds_read_b64_tr_b16 v[164:165], v15 offset:0
    ds_read_b64_tr_b16 v[166:167], v15 offset:256
    v_lshlrev_b32 v66, 16, v171
    v_and_b32 v67, 0xffff0000, v171
    v_fmac_f32 v56, v60, v60
    v_mfma_f32_32x32x16_bf16 v[120:135], v[180:183], v[172:175], v[120:135]
    v_fmac_f32 v57, v61, v61
    v_fmac_f32 v58, v62, v62
    v_fmac_f32 v59, v63, v63
    v_fmac_f32 v56, v64, v64
    v_fmac_f32 v57, v65, v65
    v_mfma_f32_16x16x32_bf16 v[48:51], v[40:43], v[168:171], v[48:51]
    v_fmac_f32 v58, v66, v66
    v_mfma_f32_16x16x32_bf16 v[52:55], v[40:43], v[176:179], v[52:55]
    v_fmac_f32 v59, v67, v67
    s_waitcnt lgkmcnt(6)
    v_mfma_f32_32x32x16_bf16 v[72:87], v[144:147], v[136:139], v[72:87]
    ds_read_b128 v[168:171], v34 offset:0
    ds_read_b64_tr_b16 v[176:177], v14 offset:2048
    v_lshlrev_b32 v60, 16, v136
    v_and_b32 v61, 0xffff0000, v136
    v_lshlrev_b32 v62, 16, v137
    v_mfma_f32_32x32x16_bf16 v[104:119], v[148:151], v[136:139], v[104:119]
    ds_read_b64_tr_b16 v[178:179], v14 offset:2304
    ds_read_b128 v[172:175], v35 offset:0
    v_and_b32 v63, 0xffff0000, v137
    v_lshlrev_b32 v64, 16, v138
    v_and_b32 v65, 0xffff0000, v138
    v_mfma_f32_32x32x16_bf16 v[88:103], v[144:147], v[140:143], v[88:103]
    ds_read_b64_tr_b16 v[180:181], v15 offset:2048
    ds_read_b64_tr_b16 v[182:183], v15 offset:2304
    v_lshlrev_b32 v66, 16, v139
    v_and_b32 v67, 0xffff0000, v139
    v_fmac_f32 v56, v60, v60
    v_mfma_f32_32x32x16_bf16 v[120:135], v[148:151], v[140:143], v[120:135]
    v_fmac_f32 v57, v61, v61
    v_fmac_f32 v58, v62, v62
    v_fmac_f32 v59, v63, v63
    v_fmac_f32 v56, v64, v64
    v_fmac_f32 v57, v65, v65
    v_mfma_f32_16x16x32_bf16 v[48:51], v[40:43], v[136:139], v[48:51]
    v_fmac_f32 v58, v66, v66
    v_mfma_f32_16x16x32_bf16 v[52:55], v[40:43], v[144:147], v[52:55]
    v_fmac_f32 v59, v67, v67
    s_waitcnt lgkmcnt(6)
    v_mfma_f32_32x32x16_bf16 v[72:87], v[160:163], v[152:155], v[72:87]
    ds_read_b128 v[136:139], v36 offset:0
    ds_read_b64_tr_b16 v[144:145], v14 offset:4096
    v_lshlrev_b32 v60, 16, v152
    v_and_b32 v61, 0xffff0000, v152
    v_lshlrev_b32 v62, 16, v153
    v_mfma_f32_32x32x16_bf16 v[104:119], v[164:167], v[152:155], v[104:119]
    ds_read_b64_tr_b16 v[146:147], v14 offset:4352
    ds_read_b128 v[140:143], v37 offset:0
    v_and_b32 v63, 0xffff0000, v153
    v_lshlrev_b32 v64, 16, v154
    v_and_b32 v65, 0xffff0000, v154
    v_mfma_f32_32x32x16_bf16 v[88:103], v[160:163], v[156:159], v[88:103]
    ds_read_b64_tr_b16 v[148:149], v15 offset:4096
    ds_read_b64_tr_b16 v[150:151], v15 offset:4352
    v_lshlrev_b32 v66, 16, v155
    v_and_b32 v67, 0xffff0000, v155
    v_fmac_f32 v56, v60, v60
    v_mfma_f32_32x32x16_bf16 v[120:135], v[164:167], v[156:159], v[120:135]
    v_fmac_f32 v57, v61, v61
    v_fmac_f32 v58, v62, v62
    v_fmac_f32 v59, v63, v63
    v_fmac_f32 v56, v64, v64
    v_fmac_f32 v57, v65, v65
    v_mfma_f32_16x16x32_bf16 v[48:51], v[40:43], v[152:155], v[48:51]
    v_fmac_f32 v58, v66, v66
    v_mfma_f32_16x16x32_bf16 v[52:55], v[40:43], v[160:163], v[52:55]
    v_fmac_f32 v59, v67, v67
    s_waitcnt lgkmcnt(6)
    v_mfma_f32_32x32x16_bf16 v[72:87], v[176:179], v[168:171], v[72:87]
    ds_read_b128 v[152:155], v38 offset:0
    ds_read_b64_tr_b16 v[160:161], v14 offset:6144
pg_2:
    s_cbranch_execz pf_ret
    v_lshlrev_b32 v60, 16, v168
    v_and_b32 v61, 0xffff0000, v168
    v_lshlrev_b32 v62, 16, v169
    v_mfma_f32_32x32x16_bf16 v[104:119], v[180:183], v[168:171], v[104:119]
    ds_read_b64_tr_b16 v[162:163], v14 offset:6400
    ds_read_b128 v[156:159], v39 offset:0
    v_and_b32 v63, 0xffff0000, v169
    v_lshlrev_b32 v64, 16, v170
    v_and_b32 v65, 0xffff0000, v170
    v_mfma_f32_32x32x16_bf16 v[88:103], v[176:179], v[172:175], v[88:103]
    ds_read_b64_tr_b16 v[164:165], v15 offset:6144
    ds_read_b64_tr_b16 v[166:167], v15 offset:6400
    v_lshlrev_b32 v66, 16, v171
    v_and_b32 v67, 0xffff0000, v171
    v_fmac_f32 v56, v60, v60
    v_mfma_f32_32x32x16_bf16 v[120:135], v[180:183], v[172:175], v[120:135]
    v_fmac_f32 v57, v61, v61
    v_fmac_f32 v58, v62, v62
    v_fmac_f32 v59, v63, v63
    v_fmac_f32 v56, v64, v64
    v_fmac_f32 v57, v65, v65
    v_mfma_f32_16x16x32_bf16 v[48:51], v[40:43], v[168:171], v[48:51]
    v_fmac_f32 v58, v66, v66
    v_mfma_f32_16x16x32_bf16 v[52:55], v[40:43], v[176:179], v[52:55]
    v_fmac_f32 v59, v67, v67
    s_barrier
    s_waitcnt lgkmcnt(6)
    v_mfma_f32_32x32x16_bf16 v[72:87], v[144:147], v[136:139], v[72:87]
    ds_read_b128 v[168:171], v16 offset:0
    ds_read_b64_tr_b16 v[176:177], v10 offset:0
    v_lshlrev_b32 v60, 16, v136
    v_and_b32 v61, 0xffff0000, v136
    v_lshlrev_b32 v62, 16, v137
    v_mfma_f32_32x32x16_bf16 v[104:119], v[148:151], v[136:139], v[104:119]
    ds_read_b64_tr_b16 v[178:179], v10 offset:256
    ds_read_b128 v[172:175], v17 offset:0
    v_and_b32 v63, 0xffff0000, v137
    v_lshlrev_b32 v64, 16, v138
    v_and_b32 v65, 0xffff0000, v138
    v_mfma_f32_32x32x16_bf16 v[88:103], v[144:147], v[140:143], v[88:103]
    ds_read_b64_tr_b16 v[180:181], v11 offset:0
    ds_read_b64_tr_b16 v[182:183], v11 offset:256
    v_lshlrev_b32 v66, 16, v139
    v_and_b32 v67, 0xffff0000, v139
    v_fmac_f32 v56, v60, v60
    v_mfma_f32_32x32x16_bf16 v[120:135], v[148:151], v[140:143], v[120:135]
    v_fmac_f32 v57, v61, v61
    v_fmac_f32 v58, v62, v62
    v_fmac_f32 v59, v63, v63
    v_fmac_f32 v56, v64, v64
    v_fmac_f32 v57, v65, v65
    v_mfma_f32_16x16x32_bf16 v[48:51], v[40:43], v[136:139], v[48:51]
    v_fmac_f32 v58, v66, v66
    v_mfma_f32_16x16x32_bf16 v[52:55], v[40:43], v[144:147], v[52:55]
    v_fmac_f32 v59, v67, v67
    s_waitcnt lgkmcnt(6)
    v_mfma_f32_32x32x16_bf16 v[72:87], v[160:163], v[152:155], v[72:87]
    ds_read_b128 v[136:139], v18 offset:0
    ds_read_b64_tr_b16 v[144:145], v10 offset:2048
    v_lshlrev_b32 v60, 16, v152
    v_and_b32 v61, 0xffff0000, v152
    v_lshlrev_b32 v62, 16, v153
    v_mfma_f32_32x32x16_bf16 v[104:119], v[164:167], v[152:155], v[104:119]
    ds_read_b64_tr_b16 v[146:147], v10 offset:2304
    ds_read_b128 v[140:143], v19 offset:0
    v_and_b32 v63, 0xffff0000, v153
    v_lshlrev_b32 v64, 16, v154
    v_and_b32 v65, 0xffff0000, v154
    v_mfma_f32_32x32x16_bf16 v[88:103], v[160:163], v[156:159], v[88:103]
    ds_read_b64_tr_b16 v[148:149], v11 offset:2048
    ds_read_b64_tr_b16 v[150:151], v11 offset:2304
    v_lshlrev_b32 v66, 16, v155
    v_and_b32 v67, 0xffff0000, v155
    v_fmac_f32 v56, v60, v60
    v_mfma_f32_32x32x16_bf16 v[120:135], v[164:167], v[156:159], v[120:135]
    v_fmac_f32 v57, v61, v61
    v_fmac_f32 v58, v62, v62
    v_fmac_f32 v59, v63, v63
    v_fmac_f32 v56, v64, v64
    v_fmac_f32 v57, v65, v65
    v_mfma_f32_16x16x32_bf16 v[48:51], v[40:43], v[152:155], v[48:51]
    v_fmac_f32 v58, v66, v66
    v_mfma_f32_16x16x32_bf16 v[52:55], v[40:43], v[160:163], v[52:55]
    v_fmac_f32 v59, v67, v67
    s_waitcnt lgkmcnt(6)
    v_mfma_f32_32x32x16_bf16 v[72:87], v[176:179], v[168:171], v[72:87]
    ds_read_b128 v[152:155], v20 offset:0
    ds_read_b64_tr_b16 v[160:161], v10 offset:4096
    v_lshlrev_b32 v60, 16, v168
    v_and_b32 v61, 0xffff0000, v168
    v_lshlrev_b32 v62, 16, v169
    v_mfma_f32_32x32x16_bf16 v[104:119], v[180:183], v[168:171], v[104:119]
    ds_read_b64_tr_b16 v[162:163], v10 offset:4352
    ds_read_b128 v[156:159], v21 offset:0
    v_and_b32 v63, 0xffff0000, v169
    v_lshlrev_b32 v64, 16, v170
    v_and_b32 v65, 0xffff0000, v170
    v_mfma_f32_32x32x16_bf16 v[88:103], v[176:179], v[172:175], v[88:103]
    ds_read_b64_tr_b16 v[164:165], v11 offset:4096
    ds_read_b64_tr_b16 v[166:167], v11 offset:4352
    v_lshlrev_b32 v66, 16, v171
    v_and_b32 v67, 0xffff0000, v171
    v_fmac_f32 v56, v60, v60
    v_mfma_f32_32x32x16_bf16 v[120:135], v[180:183], v[172:175], v[120:135]
    v_fmac_f32 v57, v61, v61
    v_fmac_f32 v58, v62, v62
    v_fmac_f32 v59, v63, v63
    v_fmac_f32 v56, v64, v64
    v_fmac_f32 v57, v65, v65
    v_mfma_f32_16x16x32_bf16 v[48:51], v[40:43], v[168:171], v[48:51]
    v_fmac_f32 v58, v66, v66
    v_mfma_f32_16x16x32_bf16 v[52:55], v[40:43], v[176:179], v[52:55]
    v_fmac_f32 v59, v67, v67
    s_waitcnt lgkmcnt(6)
    v_mfma_f32_32x32x16_bf16 v[72:87], v[144:147], v[136:139], v[72:87]
    ds_read_b128 v[168:171], v22 offset:0
    ds_read_b64_tr_b16 v[176:177], v10 offset:6144
    v_lshlrev_b32 v60, 16, v136
    v_and_b32 v61, 0xffff0000, v136
    v_lshlrev_b32 v62, 16, v137
    v_mfma_f32_32x32x16_bf16 v[104:119], v[148:151], v[136:139], v[104:119]
    ds_read_b64_tr_b16 v[178:179], v10 offset:6400
    ds_read_b128 v[172:175], v23 offset:0
    v_and_b32 v63, 0xffff0000, v137
    v_lshlrev_b32 v64, 16, v138
    v_and_b32 v65, 0xffff0000, v138
    v_mfma_f32_32x32x16_bf16 v[88:103], v[144:147], v[140:143], v[88:103]
    ds_read_b64_tr_b16 v[180:181], v11 offset:6144
    ds_read_b64_tr_b16 v[182:183], v11 offset:6400
    v_lshlrev_b32 v66, 16, v139
    v_and_b32 v67, 0xffff0000, v139
    v_fmac_f32 v56, v60, v60
    v_mfma_f32_32x32x16_bf16 v[120:135], v[148:151], v[140:143], v[120:135]
    v_fmac_f32 v57, v61, v61
    v_fmac_f32 v58, v62, v62
    v_fmac_f32 v59, v63, v63
    v_fmac_f32 v56, v64, v64
    v_fmac_f32 v57, v65, v65
    v_mfma_f32_16x16x32_bf16 v[48:51], v[40:43], v[136:139], v[48:51]
    v_fmac_f32 v58, v66, v66
    v_mfma_f32_16x16x32_bf16 v[52:55], v[40:43], v[144:147], v[52:55]
    v_fmac_f32 v59, v67, v67
    s_barrier
    s_waitcnt lgkmcnt(6)
    v_mfma_f32_32x32x16_bf16 v[72:87], v[160:163], v[152:155], v[72:87]
    ds_read_b128 v[136:139], v16 offset:32768
    ds_read_b64_tr_b16 v[144:145], v10 offset:32768
    v_lshlrev_b32 v60, 16, v152
    v_and_b32 v61, 0xffff0000, v152
    v_lshlrev_b32 v62, 16, v153
    v_mfma_f32_32x32x16_bf16 v[104:119], v[164:167], v[152:155], v[104:119]
    ds_read_b64_tr_b16 v[146:147], v10 offset:33024
    ds_read_b128 v[140:143], v17 offset:32768
    v_and_b32 v63, 0xffff0000, v153
    v_lshlrev_b32 v64, 16, v154
    v_and_b32 v65, 0xffff0000, v154
    v_mfma_f32_32x32x16_bf16 v[88:103], v[160:163], v[156:159], v[88:103]
    ds_read_b64_tr_b16 v[148:149], v11 offset:32768
    ds_read_b64_tr_b16 v[150:151], v11 offset:33024
    v_lshlrev_b32 v66, 16, v155
    v_and_b32 v67, 0xffff0000, v155
    v_fmac_f32 v56, v60, v60
    v_mfma_f32_32x32x16_bf16 v[120:135], v[164:167], v[156:159], v[120:135]
    v_fmac_f32 v57, v61, v61
    v_fmac_f32 v58, v62, v62
    v_fmac_f32 v59, v63, v63
    v_fmac_f32 v56, v64, v64
    v_fmac_f32 v57, v65, v65
    v_mfma_f32_16x16x32_bf16 v[48:51], v[40:43], v[152:155], v[48:51]
    v_fmac_f32 v58, v66, v66
    v_mfma_f32_16x16x32_bf16 v[52:55], v[40:43], v[160:163], v[52:55]
    v_fmac_f32 v59, v67, v67
    s_waitcnt lgkmcnt(6)
    v_mfma_f32_32x32x16_bf16 v[72:87], v[176:179], v[168:171], v[72:87]
    ds_read_b128 v[152:155], v18 offset:32768
    ds_read_b64_tr_b16 v[160:161], v10 offset:34816
    v_lshlrev_b32 v60, 16, v168
    v_and_b32 v61, 0xffff0000, v168
    v_lshlrev_b32 v62, 16, v169
    v_mfma_f32_32x32x16_bf16 v[104:119], v[180:183], v[168:171], v[104:119]
    ds_read_b64_tr_b16 v[162:163], v10 offset:35072
    ds_read_b128 v[156:159], v19 offset:32768
    v_and_b32 v63, 0xffff0000, v169
    v_lshlrev_b32 v64, 16, v170
    v_and_b32 v65, 0xffff0000, v170
    v_mfma_f32_32x32x16_bf16 v[88:103], v[176:179], v[172:175], v[88:103]
    ds_read_b64_tr_b16 v[164:165], v11 offset:34816
    ds_read_b64_tr_b16 v[166:167], v11 offset:35072
    v_lshlrev_b32 v66, 16, v171
    v_and_b32 v67, 0xffff0000, v171
    v_fmac_f32 v56, v60, v60
    v_mfma_f32_32x32x16_bf16 v[120:135], v[180:183], v[172:175], v[120:135]
    v_fmac_f32 v57, v61, v61
    v_fmac_f32 v58, v62, v62
    v_fmac_f32 v59, v63, v63
    v_fmac_f32 v56, v64, v64
    v_fmac_f32 v57, v65, v65
    v_mfma_f32_16x16x32_bf16 v[48:51], v[40:43], v[168:171], v[48:51]
    v_fmac_f32 v58, v66, v66
    v_mfma_f32_16x16x32_bf16 v[52:55], v[40:43], v[176:179], v[52:55]
    v_fmac_f32 v59, v67, v67
    s_waitcnt lgkmcnt(6)
    v_mfma_f32_32x32x16_bf16 v[72:87], v[144:147], v[136:139], v[72:87]
    ds_read_b128 v[168:171], v20 offset:32768
    ds_read_b64_tr_b16 v[176:177], v10 offset:36864
    v_lshlrev_b32 v60, 16, v136
    v_and_b32 v61, 0xffff0000, v136
    v_lshlrev_b32 v62, 16, v137
    v_mfma_f32_32x32x16_bf16 v[104:119], v[148:151], v[136:139], v[104:119]
    ds_read_b64_tr_b16 v[178:179], v10 offset:37120
    ds_read_b128 v[172:175], v21 offset:32768
    v_and_b32 v63, 0xffff0000, v137
    v_lshlrev_b32 v64, 16, v138
    v_and_b32 v65, 0xffff0000, v138
    v_mfma_f32_32x32x16_bf16 v[88:103], v[144:147], v[140:143], v[88:103]
    ds_read_b64_tr_b16 v[180:181], v11 offset:36864
    ds_read_b64_tr_b16 v[182:183], v11 offset:37120
    v_lshlrev_b32 v66, 16, v139
    v_and_b32 v67, 0xffff0000, v139
    v_fmac_f32 v56, v60, v60
    v_mfma_f32_32x32x16_bf16 v[120:135], v[148:151], v[140:143], v[120:135]
    v_fmac_f32 v57, v61, v61
    v_fmac_f32 v58, v62, v62
    v_fmac_f32 v59, v63, v63
    v_fmac_f32 v56, v64, v64
    v_fmac_f32 v57, v65, v65
    v_mfma_f32_16x16x32_bf16 v[48:51], v[40:43], v[136:139], v[48:51]
    v_fmac_f32 v58, v66, v66
    v_mfma_f32_16x16x32_bf16 v[52:55], v[40:43], v[144:147], v[52:55]
    v_fmac_f32 v59, v67, v67
    s_waitcnt lgkmcnt(6)
    v_mfma_f32_32x32x16_bf16 v[72:87], v[160:163], v[152:155], v[72:87]
    ds_read_b128 v[136:139], v22 offset:32768
    ds_read_b64_tr_b16 v[144:145], v10 offset:38912
    v_lshlrev_b32 v60, 16, v152
    v_and_b32 v61, 0xffff0000, v152
    v_lshlrev_b32 v62, 16, v153
    v_mfma_f32_32x32x16_bf16 v[104:119], v[164:167], v[152:155], v[104:119]
    ds_read_b64_tr_b16 v[146:147], v10 offset:39168
    ds_read_b128 v[140:143], v23 offset:32768
    v_and_b32 v63, 0xffff0000, v153
    v_lshlrev_b32 v64, 16, v154
    v_and_b32 v65, 0xffff0000, v154
    v_mfma_f32_32x32x16_bf16 v[88:103], v[160:163], v[156:159], v[88:103]
    ds_read_b64_tr_b16 v[148:149], v11 offset:38912
    ds_read_b64_tr_b16 v[150:151], v11 offset:39168
    v_lshlrev_b32 v66, 16, v155
    v_and_b32 v67, 0xffff0000, v155
    v_fmac_f32 v56, v60, v60
    v_mfma_f32_32x32x16_bf16 v[120:135], v[164:167], v[156:159], v[120:135]
    v_fmac_f32 v57, v61, v61
    v_fmac_f32 v58, v62, v62
    v_fmac_f32 v59, v63, v63
    v_fmac_f32 v56, v64, v64
    v_fmac_f32 v57, v65, v65
    v_mfma_f32_16x16x32_bf16 v[48:51], v[40:43], v[152:155], v[48:51]
    v_fmac_f32 v58, v66, v66
    v_mfma_f32_16x16x32_bf16 v[52:55], v[40:43], v[160:163], v[52:55]
    v_fmac_f32 v59, v67, v67
    s_barrier
    s_waitcnt lgkmcnt(6)
    v_mfma_f32_32x32x16_bf16 v[72:87], v[176:179], v[168:171], v[72:87]
    ds_read_b128 v[152:155], v24 offset:0
    ds_read_b64_tr_b16 v[160:161], v12 offset:0
    v_lshlrev_b32 v60, 16, v168
    v_and_b32 v61, 0xffff0000, v168
    v_lshlrev_b32 v62, 16, v169
    v_mfma_f32_32x32x16_bf16 v[104:119], v[180:183], v[168:171], v[104:119]
    ds_read_b64_tr_b16 v[162:163], v12 offset:256
    ds_read_b128 v[156:159], v25 offset:0
    v_and_b32 v63, 0xffff0000, v169
    v_lshlrev_b32 v64, 16, v170
    v_and_b32 v65, 0xffff0000, v170
    v_mfma_f32_32x32x16_bf16 v[88:103], v[176:179], v[172:175], v[88:103]
    ds_read_b64_tr_b16 v[164:165], v13 offset:0
    ds_read_b64_tr_b16 v[166:167], v13 offset:256
    v_lshlrev_b32 v66, 16, v171
    v_and_b32 v67, 0xffff0000, v171
    v_fmac_f32 v56, v60, v60
    v_mfma_f32_32x32x16_bf16 v[120:135], v[180:183], v[172:175], v[120:135]
    v_fmac_f32 v57, v61, v61
    v_fmac_f32 v58, v62, v62
    v_fmac_f32 v59, v63, v63
    v_fmac_f32 v56, v64, v64
    v_fmac_f32 v57, v65, v65
    v_mfma_f32_16x16x32_bf16 v[48:51], v[40:43], v[168:171], v[48:51]
    v_fmac_f32 v58, v66, v66
    v_mfma_f32_16x16x32_bf16 v[52:55], v[40:43], v[176:179], v[52:55]
    v_fmac_f32 v59, v67, v67
    s_waitcnt lgkmcnt(6)
    v_mfma_f32_32x32x16_bf16 v[72:87], v[144:147], v[136:139], v[72:87]
    ds_read_b128 v[168:171], v26 offset:0
    ds_read_b64_tr_b16 v[176:177], v12 offset:2048
    v_lshlrev_b32 v60, 16, v136
    v_and_b32 v61, 0xffff0000, v136
    v_lshlrev_b32 v62, 16, v137
    v_mfma_f32_32x32x16_bf16 v[104:119], v[148:151], v[136:139], v[104:119]
    ds_read_b64_tr_b16 v[178:179], v12 offset:2304
    ds_read_b128 v[172:175], v27 offset:0
    v_and_b32 v63, 0xffff0000, v137
    v_lshlrev_b32 v64, 16, v138
    v_and_b32 v65, 0xffff0000, v138
    v_mfma_f32_32x32x16_bf16 v[88:103], v[144:147], v[140:143], v[88:103]
    ds_read_b64_tr_b16 v[180:181], v13 offset:2048
    ds_read_b64_tr_b16 v[182:183], v13 offset:2304
    v_lshlrev_b32 v66, 16, v139
    v_and_b32 v67, 0xffff0000, v139
    v_fmac_f32 v56, v60, v60
    v_mfma_f32_32x32x16_bf16 v[120:135], v[148:151], v[140:143], v[120:135]
    v_fmac_f32 v57, v61, v61
    v_fmac_f32 v58, v62, v62
    v_fmac_f32 v59, v63, v63
    v_fmac_f32 v56, v64, v64
    v_fmac_f32 v57, v65, v65
    v_mfma_f32_16x16x32_bf16 v[48:51], v[40:43], v[136:139], v[48:51]
    v_fmac_f32 v58, v66, v66
    v_mfma_f32_16x16x32_bf16 v[52:55], v[40:43], v[144:147], v[52:55]
    v_fmac_f32 v59, v67, v67
    s_waitcnt lgkmcnt(6)
    v_mfma_f32_32x32x16_bf16 v[72:87], v[160:163], v[152:155], v[72:87]
    ds_read_b128 v[136:139], v28 offset:0
    ds_read_b64_tr_b16 v[144:145], v12 offset:4096
    v_lshlrev_b32 v60, 16, v152
    v_and_b32 v61, 0xffff0000, v152
    v_lshlrev_b32 v62, 16, v153
    v_mfma_f32_32x32x16_bf16 v[104:119], v[164:167], v[152:155], v[104:119]
    ds_read_b64_tr_b16 v[146:147], v12 offset:4352
    ds_read_b128 v[140:143], v29 offset:0
    v_and_b32 v63, 0xffff0000, v153
    v_lshlrev_b32 v64, 16, v154
    v_and_b32 v65, 0xffff0000, v154
    v_mfma_f32_32x32x16_bf16 v[88:103], v[160:163], v[156:159], v[88:103]
    ds_read_b64_tr_b16 v[148:149], v13 offset:4096
    ds_read_b64_tr_b16 v[150:151], v13 offset:4352
    v_lshlrev_b32 v66, 16, v155
    v_and_b32 v67, 0xffff0000, v155
    v_fmac_f32 v56, v60, v60
    v_mfma_f32_32x32x16_bf16 v[120:135], v[164:167], v[156:159], v[120:135]
    v_fmac_f32 v57, v61, v61
    v_fmac_f32 v58, v62, v62
    v_fmac_f32 v59, v63, v63
    v_fmac_f32 v56, v64, v64
    v_fmac_f32 v57, v65, v65
    v_mfma_f32_16x16x32_bf16 v[48:51], v[40:43], v[152:155], v[48:51]
    v_fmac_f32 v58, v66, v66
    v_mfma_f32_16x16x32_bf16 v[52:55], v[40:43], v[160:163], v[52:55]
    v_fmac_f32 v59, v67, v67
    s_waitcnt lgkmcnt(6)
    v_mfma_f32_32x32x16_bf16 v[72:87], v[176:179], v[168:171], v[72:87]
    ds_read_b128 v[152:155], v30 offset:0
    ds_read_b64_tr_b16 v[160:161], v12 offset:6144
    v_lshlrev_b32 v60, 16, v168
    v_and_b32 v61, 0xffff0000, v168
    v_lshlrev_b32 v62, 16, v169
    v_mfma_f32_32x32x16_bf16 v[104:119], v[180:183], v[168:171], v[104:119]
    ds_read_b64_tr_b16 v[162:163], v12 offset:6400
    ds_read_b128 v[156:159], v31 offset:0
    v_and_b32 v63, 0xffff0000, v169
    v_lshlrev_b32 v64, 16, v170
    v_and_b32 v65, 0xffff0000, v170
    v_mfma_f32_32x32x16_bf16 v[88:103], v[176:179], v[172:175], v[88:103]
    ds_read_b64_tr_b16 v[164:165], v13 offset:6144
    ds_read_b64_tr_b16 v[166:167], v13 offset:6400
    v_lshlrev_b32 v66, 16, v171
    v_and_b32 v67, 0xffff0000, v171
    v_fmac_f32 v56, v60, v60
    v_mfma_f32_32x32x16_bf16 v[120:135], v[180:183], v[172:175], v[120:135]
    v_fmac_f32 v57, v61, v61
    v_fmac_f32 v58, v62, v62
    v_fmac_f32 v59, v63, v63
    v_fmac_f32 v56, v64, v64
    v_fmac_f32 v57, v65, v65
    v_mfma_f32_16x16x32_bf16 v[48:51], v[40:43], v[168:171], v[48:51]
    v_fmac_f32 v58, v66, v66
    v_mfma_f32_16x16x32_bf16 v[52:55], v[40:43], v[176:179], v[52:55]
    v_fmac_f32 v59, v67, v67
    s_barrier
    s_waitcnt lgkmcnt(6)
    v_mfma_f32_32x32x16_bf16 v[72:87], v[144:147], v[136:139], v[72:87]
    ds_read_b128 v[168:171], v24 offset:32768
    ds_read_b64_tr_b16 v[176:177], v12 offset:32768
    v_lshlrev_b32 v60, 16, v136
    v_and_b32 v61, 0xffff0000, v136
    v_lshlrev_b32 v62, 16, v137
    v_mfma_f32_32x32x16_bf16 v[104:119], v[148:151], v[136:139], v[104:119]
    ds_read_b64_tr_b16 v[178:179], v12 offset:33024
    ds_read_b128 v[172:175], v25 offset:32768
    v_and_b32 v63, 0xffff0000, v137
    v_lshlrev_b32 v64, 16, v138
    v_and_b32 v65, 0xffff0000, v138
    v_mfma_f32_32x32x16_bf16 v[88:103], v[144:147], v[140:143], v[88:103]
    ds_read_b64_tr_b16 v[180:181], v13 offset:32768
    ds_read_b64_tr_b16 v[182:183], v13 offset:33024
    v_lshlrev_b32 v66, 16, v139
    v_and_b32 v67, 0xffff0000, v139
    v_fmac_f32 v56, v60, v60
    v_mfma_f32_32x32x16_bf16 v[120:135], v[148:151], v[140:143], v[120:135]
    v_fmac_f32 v57, v61, v61
    v_fmac_f32 v58, v62, v62
    v_fmac_f32 v59, v63, v63
    v_fmac_f32 v56, v64, v64
    v_fmac_f32 v57, v65, v65
    v_mfma_f32_16x16x32_bf16 v[48:51], v[40:43], v[136:139], v[48:51]
    v_fmac_f32 v58, v66, v66
    v_mfma_f32_16x16x32_bf16 v[52:55], v[40:43], v[144:147], v[52:55]
    v_fmac_f32 v59, v67, v67
    s_waitcnt lgkmcnt(6)
    v_mfma_f32_32x32x16_bf16 v[72:87], v[160:163], v[152:155], v[72:87]
    ds_read_b128 v[136:139], v26 offset:32768
    ds_read_b64_tr_b16 v[144:145], v12 offset:34816
    v_lshlrev_b32 v60, 16, v152
    v_and_b32 v61, 0xffff0000, v152
    v_lshlrev_b32 v62, 16, v153
    v_mfma_f32_32x32x16_bf16 v[104:119], v[164:167], v[152:155], v[104:119]
    ds_read_b64_tr_b16 v[146:147], v12 offset:35072
    ds_read_b128 v[140:143], v27 offset:32768
    v_and_b32 v63, 0xffff0000, v153
    v_lshlrev_b32 v64, 16, v154
    v_and_b32 v65, 0xffff0000, v154
    v_mfma_f32_32x32x16_bf16 v[88:103], v[160:163], v[156:159], v[88:103]
    ds_read_b64_tr_b16 v[148:149], v13 offset:34816
    ds_read_b64_tr_b16 v[150:151], v13 offset:35072
    v_lshlrev_b32 v66, 16, v155
    v_and_b32 v67, 0xffff0000, v155
    v_fmac_f32 v56, v60, v60
    v_mfma_f32_32x32x16_bf16 v[120:135], v[164:167], v[156:159], v[120:135]
    v_fmac_f32 v57, v61, v61
    v_fmac_f32 v58, v62, v62
    v_fmac_f32 v59, v63, v63
    v_fmac_f32 v56, v64, v64
    v_fmac_f32 v57, v65, v65
    v_mfma_f32_16x16x32_bf16 v[48:51], v[40:43], v[152:155], v[48:51]
    v_fmac_f32 v58, v66, v66
    v_mfma_f32_16x16x32_bf16 v[52:55], v[40:43], v[160:163], v[52:55]
    v_fmac_f32 v59, v67, v67
    s_waitcnt lgkmcnt(6)
    v_mfma_f32_32x32x16_bf16 v[72:87], v[176:179], v[168:171], v[72:87]
    ds_read_b128 v[152:155], v28 offset:32768
    ds_read_b64_tr_b16 v[160:161], v12 offset:36864
    v_lshlrev_b32 v60, 16, v168
    v_and_b32 v61, 0xffff0000, v168
    v_lshlrev_b32 v62, 16, v169
    v_mfma_f32_32x32x16_bf16 v[104:119], v[180:183], v[168:171], v[104:119]
    ds_read_b64_tr_b16 v[162:163], v12 offset:37120
    ds_read_b128 v[156:159], v29 offset:32768
    v_and_b32 v63, 0xffff0000, v169
    v_lshlrev_b32 v64, 16, v170
    v_and_b32 v65, 0xffff0000, v170
    v_mfma_f32_32x32x16_bf16 v[88:103], v[176:179], v[172:175], v[88:103]
    ds_read_b64_tr_b16 v[164:165], v13 offset:36864
    ds_read_b64_tr_b16 v[166:167], v13 offset:37120
    v_lshlrev_b32 v66, 16, v171
    v_and_b32 v67, 0xffff0000, v171
    v_fmac_f32 v56, v60, v60
    v_mfma_f32_32x32x16_bf16 v[120:135], v[180:183], v[172:175], v[120:135]
    v_fmac_f32 v57, v61, v61
    v_fmac_f32 v58, v62, v62
    v_fmac_f32 v59, v63, v63
    v_fmac_f32 v56, v64, v64
    v_fmac_f32 v57, v65, v65
    v_mfma_f32_16x16x32_bf16 v[48:51], v[40:43], v[168:171], v[48:51]
    v_fmac_f32 v58, v66, v66
    v_mfma_f32_16x16x32_bf16 v[52:55], v[40:43], v[176:179], v[52:55]
    v_fmac_f32 v59, v67, v67
    s_waitcnt lgkmcnt(6)
    v_mfma_f32_32x32x16_bf16 v[72:87], v[144:147], v[136:139], v[72:87]
    ds_read_b128 v[168:171], v30 offset:32768
    ds_read_b64_tr_b16 v[176:177], v12 offset:38912
    v_lshlrev_b32 v60, 16, v136
    v_and_b32 v61, 0xffff0000, v136
    v_lshlrev_b32 v62, 16, v137
    v_mfma_f32_32x32x16_bf16 v[104:119], v[148:151], v[136:139], v[104:119]
    ds_read_b64_tr_b16 v[178:179], v12 offset:39168
    ds_read_b128 v[172:175], v31 offset:32768
    v_and_b32 v63, 0xffff0000, v137
    v_lshlrev_b32 v64, 16, v138
    v_and_b32 v65, 0xffff0000, v138
    v_mfma_f32_32x32x16_bf16 v[88:103], v[144:147], v[140:143], v[88:103]
    ds_read_b64_tr_b16 v[180:181], v13 offset:38912
    ds_read_b64_tr_b16 v[182:183], v13 offset:39168
    v_lshlrev_b32 v66, 16, v139
    v_and_b32 v67, 0xffff0000, v139
    v_fmac_f32 v56, v60, v60
    v_mfma_f32_32x32x16_bf16 v[120:135], v[148:151], v[140:143], v[120:135]
    v_fmac_f32 v57, v61, v61
    v_fmac_f32 v58, v62, v62
    v_fmac_f32 v59, v63, v63
    v_fmac_f32 v56, v64, v64
    v_fmac_f32 v57, v65, v65
    v_mfma_f32_16x16x32_bf16 v[48:51], v[40:43], v[136:139], v[48:51]
    v_fmac_f32 v58, v66, v66
    v_mfma_f32_16x16x32_bf16 v[52:55], v[40:43], v[144:147], v[52:55]
    v_fmac_f32 v59, v67, v67
    s_waitcnt lgkmcnt(6)
    v_mfma_f32_32x32x16_bf16 v[72:87], v[160:163], v[152:155], v[72:87]
    v_lshlrev_b32 v60, 16, v152
    v_and_b32 v61, 0xffff0000, v152
    v_lshlrev_b32 v62, 16, v153
    v_mfma_f32_32x32x16_bf16 v[104:119], v[164:167], v[152:155], v[104:119]
    v_and_b32 v63, 0xffff0000, v153
    v_lshlrev_b32 v64, 16, v154
    v_and_b32 v65, 0xffff0000, v154
    v_mfma_f32_32x32x16_bf16 v[88:103], v[160:163], v[156:159], v[88:103]
    v_lshlrev_b32 v66, 16, v155
    v_and_b32 v67, 0xffff0000, v155
    v_fmac_f32 v56, v60, v60
    v_mfma_f32_32x32x16_bf16 v[120:135], v[164:167], v[156:159], v[120:135]
    v_fmac_f32 v57, v61, v61
    v_fmac_f32 v58, v62, v62
    v_fmac_f32 v59, v63, v63
    v_fmac_f32 v56, v64, v64
    v_fmac_f32 v57, v65, v65
    v_mfma_f32_16x16x32_bf16 v[48:51], v[40:43], v[152:155], v[48:51]
    v_fmac_f32 v58, v66, v66
    v_mfma_f32_16x16x32_bf16 v[52:55], v[40:43], v[160:163], v[52:55]
    v_fmac_f32 v59, v67, v67
    s_waitcnt lgkmcnt(0)
    v_mfma_f32_16x16x32_bf16 v[48:51], v[40:43], v[168:171], v[48:51]
    v_lshlrev_b32 v60, 16, v168
    v_and_b32 v61, 0xffff0000, v168
    v_mfma_f32_16x16x32_bf16 v[52:55], v[40:43], v[176:179], v[52:55]
    v_lshlrev_b32 v62, 16, v169
    v_and_b32 v63, 0xffff0000, v169
    v_mfma_f32_32x32x16_bf16 v[72:87], v[176:179], v[168:171], v[72:87]
    v_lshlrev_b32 v64, 16, v170
    v_and_b32 v65, 0xffff0000, v170
    v_lshlrev_b32 v66, 16, v171
    v_and_b32 v67, 0xffff0000, v171
    v_fmac_f32 v56, v60, v60
    v_fmac_f32 v57, v61, v61
    v_mfma_f32_32x32x16_bf16 v[104:119], v[180:183], v[168:171], v[104:119]
    v_fmac_f32 v58, v62, v62
    v_fmac_f32 v59, v63, v63
    v_fmac_f32 v56, v64, v64
    v_fmac_f32 v57, v65, v65
    v_fmac_f32 v58, v66, v66
    v_fmac_f32 v59, v67, v67
    v_mfma_f32_32x32x16_bf16 v[88:103], v[176:179], v[172:175], v[88:103]
    v_mfma_f32_32x32x16_bf16 v[120:135], v[180:183], v[172:175], v[120:135]
    v_add_f32 v56, v56, v57
    v_add_f32 v58, v58, v59
    v_add_f32 v56, v56, v58
    v_mov_b32 v57, v56
    s_nop 1
    v_permlane32_swap_b32 v56, v57
    v_mul_f32 v48, 0xbae38e39, v48
    v_add_f32 v56, v56, v57
    v_mov_b32 v57, 0x3727c5ac
    v_fmac_f32 v57, 0x3ae38e39, v56
    v_fma_f32 v57, -v48, v48, v57
    v_max_f32 v57, 0x3727c5ac, v57
    v_rsq_f32 v64, v57
    v_cvt_pk_bf16_f32 v68, v48, v52
    v_lshlrev_b32 v69, 16, v68
    v_and_b32 v71, 0xffff0000, v68
    v_sub_f32 v49, v48, v69
    v_sub_f32 v53, v52, v71
    v_cvt_pk_bf16_f32 v60, v69, v49
    s_mov_b32 s46, 0
    s_mov_b32 s47, -1
    v_cndmask_b32 v71, v71, v53, s[46:47]
    v_cvt_pk_bf16_f32 v136, v71, v71
    s_lshl_b32 s42, s36, 10
    s_add_u32 s42, s42, 159744
    v_lshl_add_u32 v68, v2, 2, s42
    ds_write_b32 v68, v60
    ds_write_b32 v68, v64 offset:256
    ds_write_b32 v68, v136 offset:512
    v_xor_b32 v69, 2048, v68
    v_xor_b32 v71, 1024, v68
    v_mov_b32 v61, 0
    v_mov_b32 v63, 0
    v_mov_b32 v137, 0
    v_mov_b32 v139, 0
    s_cmp_lg_u32 s38, 0
    s_cbranch_scc1 sequential_preLN__sliding_block__glu_gated_bilinear__prompt_kernel_nm10
    s_lshl_b32 s42, s48, 7
    s_add_u32 s42, s42, 0xf00000
    v_and_b32 v54, 31, v2
    v_lshlrev_b32 v54, 2, v54
    v_mul_f32 v55, -1.0, v48
    buffer_store_dword v55, v54, s[32:35], s42 offen sc1
sequential_preLN__sliding_block__glu_gated_bilinear__prompt_kernel_nm10:
    v_mfma_f32_32x32x8_bf16 v[72:87], v[136:137], v[60:61], v[72:87]
    s_waitcnt lgkmcnt(0)
    s_barrier
    ds_read_b32 v62, v69
    ds_read_b32 v138, v71 offset:512
    ds_read_b32 v65, v69 offset:256
    s_cmp_lt_u32 s49, 18
    s_cselect_b32 s50, 0x3eae1a93, 1.0
    v_mul_f32 v64, s50, v64
    s_waitcnt lgkmcnt(0)
    v_mul_f32 v65, s50, v65
    v_mfma_f32_32x32x8_bf16 v[104:119], v[138:139], v[60:61], v[104:119]
    v_mfma_f32_32x32x8_bf16 v[88:103], v[136:137], v[62:63], v[88:103]
    v_mfma_f32_32x32x8_bf16 v[120:135], v[138:139], v[62:63], v[120:135]
    s_xor_b32 s42, s48, 0
    s_mul_i32 s42, s42, 73728
    s_xor_b32 s45, s49, 0
    s_lshl_b32 s45, s45, 11
    s_add_u32 s42, s42, s45
    v_mul_f32 v72, v64, v72
    v_mul_f32 v73, v64, v73
    v_mul_f32 v74, v64, v74
    v_mul_f32 v75, v64, v75
    v_cvt_pk_bf16_f32 v144, v72, v73
    v_cvt_pk_bf16_f32 v145, v74, v75
    buffer_store_dwordx2 v[144:145], v6, s[24:27], s42 offen offset:0 sc1
    v_mul_f32 v76, v64, v76
    v_mul_f32 v77, v64, v77
    v_mul_f32 v78, v64, v78
    v_mul_f32 v79, v64, v79
    v_cvt_pk_bf16_f32 v146, v76, v77
    v_cvt_pk_bf16_f32 v147, v78, v79
    buffer_store_dwordx2 v[146:147], v6, s[24:27], s42 offen offset:512 sc1
    v_mul_f32 v80, v64, v80
    v_mul_f32 v81, v64, v81
    v_mul_f32 v82, v64, v82
    v_mul_f32 v83, v64, v83
    v_cvt_pk_bf16_f32 v148, v80, v81
    v_cvt_pk_bf16_f32 v149, v82, v83
    buffer_store_dwordx2 v[148:149], v6, s[24:27], s42 offen offset:1024 sc1
    v_mul_f32 v84, v64, v84
    v_mul_f32 v85, v64, v85
    v_mul_f32 v86, v64, v86
    v_mul_f32 v87, v64, v87
    v_cvt_pk_bf16_f32 v150, v84, v85
    v_cvt_pk_bf16_f32 v151, v86, v87
    buffer_store_dwordx2 v[150:151], v6, s[24:27], s42 offen offset:1536 sc1
    s_xor_b32 s42, s48, 0
    s_mul_i32 s42, s42, 73728
    s_xor_b32 s45, s49, 1
    s_lshl_b32 s45, s45, 11
    s_add_u32 s42, s42, s45
    v_mul_f32 v104, v64, v104
    v_mul_f32 v105, v64, v105
    v_mul_f32 v106, v64, v106
    v_mul_f32 v107, v64, v107
    v_cvt_pk_bf16_f32 v152, v104, v105
    v_cvt_pk_bf16_f32 v153, v106, v107
    buffer_store_dwordx2 v[152:153], v6, s[24:27], s42 offen offset:0 sc1
    v_mul_f32 v108, v64, v108
    v_mul_f32 v109, v64, v109
    v_mul_f32 v110, v64, v110
    v_mul_f32 v111, v64, v111
    v_cvt_pk_bf16_f32 v154, v108, v109
    v_cvt_pk_bf16_f32 v155, v110, v111
    buffer_store_dwordx2 v[154:155], v6, s[24:27], s42 offen offset:512 sc1
    v_mul_f32 v112, v64, v112
    v_mul_f32 v113, v64, v113
    v_mul_f32 v114, v64, v114
    v_mul_f32 v115, v64, v115
    v_cvt_pk_bf16_f32 v156, v112, v113
    v_cvt_pk_bf16_f32 v157, v114, v115
    buffer_store_dwordx2 v[156:157], v6, s[24:27], s42 offen offset:1024 sc1
    v_mul_f32 v116, v64, v116
    v_mul_f32 v117, v64, v117
    v_mul_f32 v118, v64, v118
    v_mul_f32 v119, v64, v119
    v_cvt_pk_bf16_f32 v158, v116, v117
    v_cvt_pk_bf16_f32 v159, v118, v119
    buffer_store_dwordx2 v[158:159], v6, s[24:27], s42 offen offset:1536 sc1
    s_xor_b32 s42, s48, 1
    s_mul_i32 s42, s42, 73728
    s_xor_b32 s45, s49, 0
    s_lshl_b32 s45, s45, 11
    s_add_u32 s42, s42, s45
    v_mul_f32 v88, v65, v88
    v_mul_f32 v89, v65, v89
    v_mul_f32 v90, v65, v90
    v_mul_f32 v91, v65, v91
    v_cvt_pk_bf16_f32 v160, v88, v89
    v_cvt_pk_bf16_f32 v161, v90, v91
    buffer_store_dwordx2 v[160:161], v6, s[24:27], s42 offen offset:0 sc1
    v_mul_f32 v92, v65, v92
    v_mul_f32 v93, v65, v93
pg_3:
    s_cbranch_execz pf_ret
    v_mul_f32 v94, v65, v94
    v_mul_f32 v95, v65, v95
    v_cvt_pk_bf16_f32 v162, v92, v93
    v_cvt_pk_bf16_f32 v163, v94, v95
    buffer_store_dwordx2 v[162:163], v6, s[24:27], s42 offen offset:512 sc1
    v_mul_f32 v96, v65, v96
    v_mul_f32 v97, v65, v97
    v_mul_f32 v98, v65, v98
    v_mul_f32 v99, v65, v99
    v_cvt_pk_bf16_f32 v164, v96, v97
    v_cvt_pk_bf16_f32 v165, v98, v99
    buffer_store_dwordx2 v[164:165], v6, s[24:27], s42 offen offset:1024 sc1
    v_mul_f32 v100, v65, v100
    v_mul_f32 v101, v65, v101
    v_mul_f32 v102, v65, v102
    v_mul_f32 v103, v65, v103
    v_cvt_pk_bf16_f32 v166, v100, v101
    v_cvt_pk_bf16_f32 v167, v102, v103
    buffer_store_dwordx2 v[166:167], v6, s[24:27], s42 offen offset:1536 sc1
    s_xor_b32 s42, s48, 1
    s_mul_i32 s42, s42, 73728
    s_xor_b32 s45, s49, 1
    s_lshl_b32 s45, s45, 11
    s_add_u32 s42, s42, s45
    v_mul_f32 v120, v65, v120
    v_mul_f32 v121, v65, v121
    v_mul_f32 v122, v65, v122
    v_mul_f32 v123, v65, v123
    v_cvt_pk_bf16_f32 v168, v120, v121
    v_cvt_pk_bf16_f32 v169, v122, v123
    buffer_store_dwordx2 v[168:169], v6, s[24:27], s42 offen offset:0 sc1
    v_mul_f32 v124, v65, v124
    v_mul_f32 v125, v65, v125
    v_mul_f32 v126, v65, v126
    v_mul_f32 v127, v65, v127
    v_cvt_pk_bf16_f32 v170, v124, v125
    v_cvt_pk_bf16_f32 v171, v126, v127
    buffer_store_dwordx2 v[170:171], v6, s[24:27], s42 offen offset:512 sc1
    v_mul_f32 v128, v65, v128
    v_mul_f32 v129, v65, v129
    v_mul_f32 v130, v65, v130
    v_mul_f32 v131, v65, v131
    v_cvt_pk_bf16_f32 v172, v128, v129
    v_cvt_pk_bf16_f32 v173, v130, v131
    buffer_store_dwordx2 v[172:173], v6, s[24:27], s42 offen offset:1024 sc1
    v_mul_f32 v132, v65, v132
    v_mul_f32 v133, v65, v133
    v_mul_f32 v134, v65, v134
    v_mul_f32 v135, v65, v135
    v_cvt_pk_bf16_f32 v174, v132, v133
    v_cvt_pk_bf16_f32 v175, v134, v135
    buffer_store_dwordx2 v[174:175], v6, s[24:27], s42 offen offset:1536 sc1
    s_mul_i32 s46, s51, 128
    s_lshl_b32 s47, s36, 2
    s_add_u32 s46, s46, s47
    s_add_u32 s46, s46, 0xd00000
    v_mov_b32 v1, 1
    s_waitcnt vmcnt(0)
    s_mov_b64 exec, 1
    buffer_store_dword v1, off, s[32:35], s46 sc1
    s_mov_b64 exec, -1
    s_barrier
    s_branch sequential_preLN__sliding_block__glu_gated_bilinear__prompt_kernel_entry
sequential_preLN__sliding_block__glu_gated_bilinear__prompt_kernel_v9:
    s_mov_b64 exec, 0
    s_waitcnt lgkmcnt(0)
    s_call_b64 s[98:99], pfd_5
    s_branch pfc_5
pfd_5:
    s_cmp_eq_u32 s36, 0
    s_cbranch_scc1 pg_7
    s_cmp_eq_u32 s36, 1
    s_cbranch_scc1 pg_8
    s_cmp_eq_u32 s36, 2
    s_cbranch_scc1 pg_9
    s_branch pg_1
pfc_5:
    s_mov_b64 exec, -1
    s_barrier
pg_k1:
    s_cbranch_execz pf_ret
    ds_read_b128 v[136:139], v16 offset:0
    ds_read_b64_tr_b16 v[144:145], v10 offset:0
    ds_read_b64_tr_b16 v[146:147], v10 offset:256
    ds_read_b128 v[140:143], v17 offset:0
    ds_read_b64_tr_b16 v[148:149], v11 offset:0
    ds_read_b64_tr_b16 v[150:151], v11 offset:256
    ds_read_b128 v[152:155], v18 offset:0
    ds_read_b64_tr_b16 v[160:161], v10 offset:2048
    ds_read_b64_tr_b16 v[162:163], v10 offset:2304
    ds_read_b128 v[156:159], v19 offset:0
    ds_read_b64_tr_b16 v[164:165], v11 offset:2048
    ds_read_b64_tr_b16 v[166:167], v11 offset:2304
    s_waitcnt lgkmcnt(6)
    v_mfma_f32_32x32x16_bf16 v[72:87], v[136:139], v[144:147], 0
    ds_read_b128 v[168:171], v20 offset:0
    ds_read_b64_tr_b16 v[176:177], v10 offset:4096
    v_lshlrev_b32 v60, 16, v136
    v_and_b32 v61, 0xffff0000, v136
    v_lshlrev_b32 v62, 16, v137
    v_mfma_f32_32x32x16_bf16 v[104:119], v[136:139], v[148:151], 0
    ds_read_b64_tr_b16 v[178:179], v10 offset:4352
    ds_read_b128 v[172:175], v21 offset:0
    v_and_b32 v63, 0xffff0000, v137
    v_lshlrev_b32 v64, 16, v138
    v_and_b32 v65, 0xffff0000, v138
    v_mfma_f32_32x32x16_bf16 v[88:103], v[140:143], v[144:147], 0
    ds_read_b64_tr_b16 v[180:181], v11 offset:4096
    ds_read_b64_tr_b16 v[182:183], v11 offset:4352
    v_lshlrev_b32 v66, 16, v139
    v_and_b32 v67, 0xffff0000, v139
    v_fmac_f32 v56, v60, v60
    v_mfma_f32_32x32x16_bf16 v[120:135], v[140:143], v[148:151], 0
    v_fmac_f32 v57, v61, v61
    v_fmac_f32 v58, v62, v62
    v_fmac_f32 v59, v63, v63
    v_fmac_f32 v56, v64, v64
    v_fmac_f32 v57, v65, v65
    v_mfma_f32_16x16x32_bf16 v[48:51], v[40:43], v[136:139], 0
    v_fmac_f32 v58, v66, v66
    v_mfma_f32_16x16x32_bf16 v[52:55], v[40:43], v[144:147], 0
    v_fmac_f32 v59, v67, v67
    s_waitcnt lgkmcnt(6)
    v_mfma_f32_32x32x16_bf16 v[72:87], v[152:155], v[160:163], v[72:87]
    ds_read_b128 v[136:139], v22 offset:0
    ds_read_b64_tr_b16 v[144:145], v10 offset:6144
    v_lshlrev_b32 v60, 16, v152
    v_and_b32 v61, 0xffff0000, v152
    v_lshlrev_b32 v62, 16, v153
    v_mfma_f32_32x32x16_bf16 v[104:119], v[152:155], v[164:167], v[104:119]
    ds_read_b64_tr_b16 v[146:147], v10 offset:6400
    ds_read_b128 v[140:143], v23 offset:0
    v_and_b32 v63, 0xffff0000, v153
    v_lshlrev_b32 v64, 16, v154
    v_and_b32 v65, 0xffff0000, v154
    v_mfma_f32_32x32x16_bf16 v[88:103], v[156:159], v[160:163], v[88:103]
    ds_read_b64_tr_b16 v[148:149], v11 offset:6144
    ds_read_b64_tr_b16 v[150:151], v11 offset:6400
    v_lshlrev_b32 v66, 16, v155
    v_and_b32 v67, 0xffff0000, v155
    v_fmac_f32 v56, v60, v60
    v_mfma_f32_32x32x16_bf16 v[120:135], v[156:159], v[164:167], v[120:135]
    v_fmac_f32 v57, v61, v61
    v_fmac_f32 v58, v62, v62
    v_fmac_f32 v59, v63, v63
    v_fmac_f32 v56, v64, v64
    v_fmac_f32 v57, v65, v65
    v_mfma_f32_16x16x32_bf16 v[48:51], v[40:43], v[152:155], v[48:51]
    v_fmac_f32 v58, v66, v66
    v_mfma_f32_16x16x32_bf16 v[52:55], v[40:43], v[160:163], v[52:55]
    v_fmac_f32 v59, v67, v67
    s_barrier
    s_waitcnt lgkmcnt(6)
    v_mfma_f32_32x32x16_bf16 v[72:87], v[168:171], v[176:179], v[72:87]
    ds_read_b128 v[152:155], v16 offset:32768
    ds_read_b64_tr_b16 v[160:161], v10 offset:32768
    v_lshlrev_b32 v60, 16, v168
    v_and_b32 v61, 0xffff0000, v168
    v_lshlrev_b32 v62, 16, v169
    v_mfma_f32_32x32x16_bf16 v[104:119], v[168:171], v[180:183], v[104:119]
    ds_read_b64_tr_b16 v[162:163], v10 offset:33024
    ds_read_b128 v[156:159], v17 offset:32768
    v_and_b32 v63, 0xffff0000, v169
    v_lshlrev_b32 v64, 16, v170
    v_and_b32 v65, 0xffff0000, v170
    v_mfma_f32_32x32x16_bf16 v[88:103], v[172:175], v[176:179], v[88:103]
    ds_read_b64_tr_b16 v[164:165], v11 offset:32768
    ds_read_b64_tr_b16 v[166:167], v11 offset:33024
    v_lshlrev_b32 v66, 16, v171
    v_and_b32 v67, 0xffff0000, v171
    v_fmac_f32 v56, v60, v60
    v_mfma_f32_32x32x16_bf16 v[120:135], v[172:175], v[180:183], v[120:135]
    v_fmac_f32 v57, v61, v61
    v_fmac_f32 v58, v62, v62
    v_fmac_f32 v59, v63, v63
    v_fmac_f32 v56, v64, v64
    v_fmac_f32 v57, v65, v65
    v_mfma_f32_16x16x32_bf16 v[48:51], v[40:43], v[168:171], v[48:51]
    v_fmac_f32 v58, v66, v66
    v_mfma_f32_16x16x32_bf16 v[52:55], v[40:43], v[176:179], v[52:55]
    v_fmac_f32 v59, v67, v67
    s_waitcnt lgkmcnt(6)
    v_mfma_f32_32x32x16_bf16 v[72:87], v[136:139], v[144:147], v[72:87]
    ds_read_b128 v[168:171], v18 offset:32768
    ds_read_b64_tr_b16 v[176:177], v10 offset:34816
    v_lshlrev_b32 v60, 16, v136
    v_and_b32 v61, 0xffff0000, v136
    v_lshlrev_b32 v62, 16, v137
    v_mfma_f32_32x32x16_bf16 v[104:119], v[136:139], v[148:151], v[104:119]
    ds_read_b64_tr_b16 v[178:179], v10 offset:35072
    ds_read_b128 v[172:175], v19 offset:32768
    v_and_b32 v63, 0xffff0000, v137
    v_lshlrev_b32 v64, 16, v138
    v_and_b32 v65, 0xffff0000, v138
    v_mfma_f32_32x32x16_bf16 v[88:103], v[140:143], v[144:147], v[88:103]
    ds_read_b64_tr_b16 v[180:181], v11 offset:34816
    ds_read_b64_tr_b16 v[182:183], v11 offset:35072
    v_lshlrev_b32 v66, 16, v139
    v_and_b32 v67, 0xffff0000, v139
    v_fmac_f32 v56, v60, v60
    v_mfma_f32_32x32x16_bf16 v[120:135], v[140:143], v[148:151], v[120:135]
    v_fmac_f32 v57, v61, v61
    v_fmac_f32 v58, v62, v62
    v_fmac_f32 v59, v63, v63
    v_fmac_f32 v56, v64, v64
    v_fmac_f32 v57, v65, v65
    v_mfma_f32_16x16x32_bf16 v[48:51], v[40:43], v[136:139], v[48:51]
    v_fmac_f32 v58, v66, v66
    v_mfma_f32_16x16x32_bf16 v[52:55], v[40:43], v[144:147], v[52:55]
    v_fmac_f32 v59, v67, v67
    s_waitcnt lgkmcnt(6)
    v_mfma_f32_32x32x16_bf16 v[72:87], v[152:155], v[160:163], v[72:87]
    ds_read_b128 v[136:139], v20 offset:32768
    ds_read_b64_tr_b16 v[144:145], v10 offset:36864
    v_lshlrev_b32 v60, 16, v152
    v_and_b32 v61, 0xffff0000, v152
    v_lshlrev_b32 v62, 16, v153
    v_mfma_f32_32x32x16_bf16 v[104:119], v[152:155], v[164:167], v[104:119]
    ds_read_b64_tr_b16 v[146:147], v10 offset:37120
    ds_read_b128 v[140:143], v21 offset:32768
    v_and_b32 v63, 0xffff0000, v153
    v_lshlrev_b32 v64, 16, v154
    v_and_b32 v65, 0xffff0000, v154
    v_mfma_f32_32x32x16_bf16 v[88:103], v[156:159], v[160:163], v[88:103]
    ds_read_b64_tr_b16 v[148:149], v11 offset:36864
    ds_read_b64_tr_b16 v[150:151], v11 offset:37120
    v_lshlrev_b32 v66, 16, v155
    v_and_b32 v67, 0xffff0000, v155
    v_fmac_f32 v56, v60, v60
    v_mfma_f32_32x32x16_bf16 v[120:135], v[156:159], v[164:167], v[120:135]
    v_fmac_f32 v57, v61, v61
    v_fmac_f32 v58, v62, v62
    v_fmac_f32 v59, v63, v63
    v_fmac_f32 v56, v64, v64
    v_fmac_f32 v57, v65, v65
    v_mfma_f32_16x16x32_bf16 v[48:51], v[40:43], v[152:155], v[48:51]
    v_fmac_f32 v58, v66, v66
    v_mfma_f32_16x16x32_bf16 v[52:55], v[40:43], v[160:163], v[52:55]
    v_fmac_f32 v59, v67, v67
    s_waitcnt lgkmcnt(6)
    v_mfma_f32_32x32x16_bf16 v[72:87], v[168:171], v[176:179], v[72:87]
    ds_read_b128 v[152:155], v22 offset:32768
    ds_read_b64_tr_b16 v[160:161], v10 offset:38912
    v_lshlrev_b32 v60, 16, v168
    v_and_b32 v61, 0xffff0000, v168
    v_lshlrev_b32 v62, 16, v169
    v_mfma_f32_32x32x16_bf16 v[104:119], v[168:171], v[180:183], v[104:119]
    ds_read_b64_tr_b16 v[162:163], v10 offset:39168
    ds_read_b128 v[156:159], v23 offset:32768
    v_and_b32 v63, 0xffff0000, v169
    v_lshlrev_b32 v64, 16, v170
    v_and_b32 v65, 0xffff0000, v170
    v_mfma_f32_32x32x16_bf16 v[88:103], v[172:175], v[176:179], v[88:103]
    ds_read_b64_tr_b16 v[164:165], v11 offset:38912
    ds_read_b64_tr_b16 v[166:167], v11 offset:39168
    v_lshlrev_b32 v66, 16, v171
    v_and_b32 v67, 0xffff0000, v171
    v_fmac_f32 v56, v60, v60
    v_mfma_f32_32x32x16_bf16 v[120:135], v[172:175], v[180:183], v[120:135]
    v_fmac_f32 v57, v61, v61
    v_fmac_f32 v58, v62, v62
    v_fmac_f32 v59, v63, v63
    v_fmac_f32 v56, v64, v64
    v_fmac_f32 v57, v65, v65
    v_mfma_f32_16x16x32_bf16 v[48:51], v[40:43], v[168:171], v[48:51]
    v_fmac_f32 v58, v66, v66
    v_mfma_f32_16x16x32_bf16 v[52:55], v[40:43], v[176:179], v[52:55]
    v_fmac_f32 v59, v67, v67
    s_barrier
    s_waitcnt lgkmcnt(6)
    v_mfma_f32_32x32x16_bf16 v[72:87], v[136:139], v[144:147], v[72:87]
    ds_read_b128 v[168:171], v24 offset:0
    ds_read_b64_tr_b16 v[176:177], v12 offset:0
    v_lshlrev_b32 v60, 16, v136
    v_and_b32 v61, 0xffff0000, v136
    v_lshlrev_b32 v62, 16, v137
    v_mfma_f32_32x32x16_bf16 v[104:119], v[136:139], v[148:151], v[104:119]
    ds_read_b64_tr_b16 v[178:179], v12 offset:256
    ds_read_b128 v[172:175], v25 offset:0
    v_and_b32 v63, 0xffff0000, v137
    v_lshlrev_b32 v64, 16, v138
    v_and_b32 v65, 0xffff0000, v138
    v_mfma_f32_32x32x16_bf16 v[88:103], v[140:143], v[144:147], v[88:103]
    ds_read_b64_tr_b16 v[180:181], v13 offset:0
    ds_read_b64_tr_b16 v[182:183], v13 offset:256
    v_lshlrev_b32 v66, 16, v139
    v_and_b32 v67, 0xffff0000, v139
    v_fmac_f32 v56, v60, v60
    v_mfma_f32_32x32x16_bf16 v[120:135], v[140:143], v[148:151], v[120:135]
    v_fmac_f32 v57, v61, v61
    v_fmac_f32 v58, v62, v62
    v_fmac_f32 v59, v63, v63
    v_fmac_f32 v56, v64, v64
    v_fmac_f32 v57, v65, v65
    v_mfma_f32_16x16x32_bf16 v[48:51], v[40:43], v[136:139], v[48:51]
    v_fmac_f32 v58, v66, v66
    v_mfma_f32_16x16x32_bf16 v[52:55], v[40:43], v[144:147], v[52:55]
    v_fmac_f32 v59, v67, v67
    s_waitcnt lgkmcnt(6)
    v_mfma_f32_32x32x16_bf16 v[72:87], v[152:155], v[160:163], v[72:87]
    ds_read_b128 v[136:139], v26 offset:0
    ds_read_b64_tr_b16 v[144:145], v12 offset:2048
    v_lshlrev_b32 v60, 16, v152
    v_and_b32 v61, 0xffff0000, v152
    v_lshlrev_b32 v62, 16, v153
    v_mfma_f32_32x32x16_bf16 v[104:119], v[152:155], v[164:167], v[104:119]
    ds_read_b64_tr_b16 v[146:147], v12 offset:2304
    ds_read_b128 v[140:143], v27 offset:0
    v_and_b32 v63, 0xffff0000, v153
    v_lshlrev_b32 v64, 16, v154
    v_and_b32 v65, 0xffff0000, v154
    v_mfma_f32_32x32x16_bf16 v[88:103], v[156:159], v[160:163], v[88:103]
    ds_read_b64_tr_b16 v[148:149], v13 offset:2048
    ds_read_b64_tr_b16 v[150:151], v13 offset:2304
    v_lshlrev_b32 v66, 16, v155
    v_and_b32 v67, 0xffff0000, v155
    v_fmac_f32 v56, v60, v60
    v_mfma_f32_32x32x16_bf16 v[120:135], v[156:159], v[164:167], v[120:135]
    v_fmac_f32 v57, v61, v61
    v_fmac_f32 v58, v62, v62
    v_fmac_f32 v59, v63, v63
    v_fmac_f32 v56, v64, v64
    v_fmac_f32 v57, v65, v65
    v_mfma_f32_16x16x32_bf16 v[48:51], v[40:43], v[152:155], v[48:51]
    v_fmac_f32 v58, v66, v66
    v_mfma_f32_16x16x32_bf16 v[52:55], v[40:43], v[160:163], v[52:55]
    v_fmac_f32 v59, v67, v67
    s_waitcnt lgkmcnt(6)
    v_mfma_f32_32x32x16_bf16 v[72:87], v[168:171], v[176:179], v[72:87]
    ds_read_b128 v[152:155], v28 offset:0
    ds_read_b64_tr_b16 v[160:161], v12 offset:4096
    v_lshlrev_b32 v60, 16, v168
    v_and_b32 v61, 0xffff0000, v168
    v_lshlrev_b32 v62, 16, v169
    v_mfma_f32_32x32x16_bf16 v[104:119], v[168:171], v[180:183], v[104:119]
    ds_read_b64_tr_b16 v[162:163], v12 offset:4352
    ds_read_b128 v[156:159], v29 offset:0
    v_and_b32 v63, 0xffff0000, v169
    v_lshlrev_b32 v64, 16, v170
    v_and_b32 v65, 0xffff0000, v170
    v_mfma_f32_32x32x16_bf16 v[88:103], v[172:175], v[176:179], v[88:103]
    ds_read_b64_tr_b16 v[164:165], v13 offset:4096
    ds_read_b64_tr_b16 v[166:167], v13 offset:4352
    v_lshlrev_b32 v66, 16, v171
    v_and_b32 v67, 0xffff0000, v171
    v_fmac_f32 v56, v60, v60
    v_mfma_f32_32x32x16_bf16 v[120:135], v[172:175], v[180:183], v[120:135]
    v_fmac_f32 v57, v61, v61
    v_fmac_f32 v58, v62, v62
    v_fmac_f32 v59, v63, v63
    v_fmac_f32 v56, v64, v64
    v_fmac_f32 v57, v65, v65
    v_mfma_f32_16x16x32_bf16 v[48:51], v[40:43], v[168:171], v[48:51]
    v_fmac_f32 v58, v66, v66
    v_mfma_f32_16x16x32_bf16 v[52:55], v[40:43], v[176:179], v[52:55]
    v_fmac_f32 v59, v67, v67
    s_waitcnt lgkmcnt(6)
    v_mfma_f32_32x32x16_bf16 v[72:87], v[136:139], v[144:147], v[72:87]
    ds_read_b128 v[168:171], v30 offset:0
    ds_read_b64_tr_b16 v[176:177], v12 offset:6144
    v_lshlrev_b32 v60, 16, v136
    v_and_b32 v61, 0xffff0000, v136
    v_lshlrev_b32 v62, 16, v137
    v_mfma_f32_32x32x16_bf16 v[104:119], v[136:139], v[148:151], v[104:119]
    ds_read_b64_tr_b16 v[178:179], v12 offset:6400
    ds_read_b128 v[172:175], v31 offset:0
    v_and_b32 v63, 0xffff0000, v137
    v_lshlrev_b32 v64, 16, v138
    v_and_b32 v65, 0xffff0000, v138
    v_mfma_f32_32x32x16_bf16 v[88:103], v[140:143], v[144:147], v[88:103]
    ds_read_b64_tr_b16 v[180:181], v13 offset:6144
    ds_read_b64_tr_b16 v[182:183], v13 offset:6400
    v_lshlrev_b32 v66, 16, v139
    v_and_b32 v67, 0xffff0000, v139
    v_fmac_f32 v56, v60, v60
    v_mfma_f32_32x32x16_bf16 v[120:135], v[140:143], v[148:151], v[120:135]
    v_fmac_f32 v57, v61, v61
    v_fmac_f32 v58, v62, v62
    v_fmac_f32 v59, v63, v63
    v_fmac_f32 v56, v64, v64
    v_fmac_f32 v57, v65, v65
    v_mfma_f32_16x16x32_bf16 v[48:51], v[40:43], v[136:139], v[48:51]
    v_fmac_f32 v58, v66, v66
    v_mfma_f32_16x16x32_bf16 v[52:55], v[40:43], v[144:147], v[52:55]
    v_fmac_f32 v59, v67, v67
    s_barrier
    s_waitcnt lgkmcnt(6)
    v_mfma_f32_32x32x16_bf16 v[72:87], v[152:155], v[160:163], v[72:87]
    ds_read_b128 v[136:139], v24 offset:32768
    ds_read_b64_tr_b16 v[144:145], v12 offset:32768
    v_lshlrev_b32 v60, 16, v152
    v_and_b32 v61, 0xffff0000, v152
    v_lshlrev_b32 v62, 16, v153
    v_mfma_f32_32x32x16_bf16 v[104:119], v[152:155], v[164:167], v[104:119]
    ds_read_b64_tr_b16 v[146:147], v12 offset:33024
    ds_read_b128 v[140:143], v25 offset:32768
    v_and_b32 v63, 0xffff0000, v153
    v_lshlrev_b32 v64, 16, v154
    v_and_b32 v65, 0xffff0000, v154
    v_mfma_f32_32x32x16_bf16 v[88:103], v[156:159], v[160:163], v[88:103]
    ds_read_b64_tr_b16 v[148:149], v13 offset:32768
    ds_read_b64_tr_b16 v[150:151], v13 offset:33024
    v_lshlrev_b32 v66, 16, v155
    v_and_b32 v67, 0xffff0000, v155
    v_fmac_f32 v56, v60, v60
    v_mfma_f32_32x32x16_bf16 v[120:135], v[156:159], v[164:167], v[120:135]
    v_fmac_f32 v57, v61, v61
    v_fmac_f32 v58, v62, v62
    v_fmac_f32 v59, v63, v63
    v_fmac_f32 v56, v64, v64
    v_fmac_f32 v57, v65, v65
    v_mfma_f32_16x16x32_bf16 v[48:51], v[40:43], v[152:155], v[48:51]
    v_fmac_f32 v58, v66, v66
    v_mfma_f32_16x16x32_bf16 v[52:55], v[40:43], v[160:163], v[52:55]
    v_fmac_f32 v59, v67, v67
    s_waitcnt lgkmcnt(6)
    v_mfma_f32_32x32x16_bf16 v[72:87], v[168:171], v[176:179], v[72:87]
    ds_read_b128 v[152:155], v26 offset:32768
    ds_read_b64_tr_b16 v[160:161], v12 offset:34816
    v_lshlrev_b32 v60, 16, v168
    v_and_b32 v61, 0xffff0000, v168
    v_lshlrev_b32 v62, 16, v169
    v_mfma_f32_32x32x16_bf16 v[104:119], v[168:171], v[180:183], v[104:119]
    ds_read_b64_tr_b16 v[162:163], v12 offset:35072
    ds_read_b128 v[156:159], v27 offset:32768
    v_and_b32 v63, 0xffff0000, v169
    v_lshlrev_b32 v64, 16, v170
    v_and_b32 v65, 0xffff0000, v170
    v_mfma_f32_32x32x16_bf16 v[88:103], v[172:175], v[176:179], v[88:103]
    ds_read_b64_tr_b16 v[164:165], v13 offset:34816
    ds_read_b64_tr_b16 v[166:167], v13 offset:35072
    v_lshlrev_b32 v66, 16, v171
    v_and_b32 v67, 0xffff0000, v171
    v_fmac_f32 v56, v60, v60
    v_mfma_f32_32x32x16_bf16 v[120:135], v[172:175], v[180:183], v[120:135]
    v_fmac_f32 v57, v61, v61
    v_fmac_f32 v58, v62, v62
    v_fmac_f32 v59, v63, v63
    v_fmac_f32 v56, v64, v64
    v_fmac_f32 v57, v65, v65
    v_mfma_f32_16x16x32_bf16 v[48:51], v[40:43], v[168:171], v[48:51]
    v_fmac_f32 v58, v66, v66
    v_mfma_f32_16x16x32_bf16 v[52:55], v[40:43], v[176:179], v[52:55]
    v_fmac_f32 v59, v67, v67
    s_waitcnt lgkmcnt(6)
    v_mfma_f32_32x32x16_bf16 v[72:87], v[136:139], v[144:147], v[72:87]
    ds_read_b128 v[168:171], v28 offset:32768
    ds_read_b64_tr_b16 v[176:177], v12 offset:36864
    v_lshlrev_b32 v60, 16, v136
    v_and_b32 v61, 0xffff0000, v136
    v_lshlrev_b32 v62, 16, v137
    v_mfma_f32_32x32x16_bf16 v[104:119], v[136:139], v[148:151], v[104:119]
    ds_read_b64_tr_b16 v[178:179], v12 offset:37120
    ds_read_b128 v[172:175], v29 offset:32768
    v_and_b32 v63, 0xffff0000, v137
    v_lshlrev_b32 v64, 16, v138
    v_and_b32 v65, 0xffff0000, v138
    v_mfma_f32_32x32x16_bf16 v[88:103], v[140:143], v[144:147], v[88:103]
    ds_read_b64_tr_b16 v[180:181], v13 offset:36864
    ds_read_b64_tr_b16 v[182:183], v13 offset:37120
    v_lshlrev_b32 v66, 16, v139
    v_and_b32 v67, 0xffff0000, v139
    v_fmac_f32 v56, v60, v60
    v_mfma_f32_32x32x16_bf16 v[120:135], v[140:143], v[148:151], v[120:135]
    v_fmac_f32 v57, v61, v61
    v_fmac_f32 v58, v62, v62
    v_fmac_f32 v59, v63, v63
    v_fmac_f32 v56, v64, v64
    v_fmac_f32 v57, v65, v65
    v_mfma_f32_16x16x32_bf16 v[48:51], v[40:43], v[136:139], v[48:51]
    v_fmac_f32 v58, v66, v66
    v_mfma_f32_16x16x32_bf16 v[52:55], v[40:43], v[144:147], v[52:55]
    v_fmac_f32 v59, v67, v67
    s_waitcnt lgkmcnt(6)
    v_mfma_f32_32x32x16_bf16 v[72:87], v[152:155], v[160:163], v[72:87]
    ds_read_b128 v[136:139], v30 offset:32768
    ds_read_b64_tr_b16 v[144:145], v12 offset:38912
    v_lshlrev_b32 v60, 16, v152
    v_and_b32 v61, 0xffff0000, v152
    v_lshlrev_b32 v62, 16, v153
    v_mfma_f32_32x32x16_bf16 v[104:119], v[152:155], v[164:167], v[104:119]
    ds_read_b64_tr_b16 v[146:147], v12 offset:39168
    ds_read_b128 v[140:143], v31 offset:32768
    v_and_b32 v63, 0xffff0000, v153
    v_lshlrev_b32 v64, 16, v154
    v_and_b32 v65, 0xffff0000, v154
    v_mfma_f32_32x32x16_bf16 v[88:103], v[156:159], v[160:163], v[88:103]
    ds_read_b64_tr_b16 v[148:149], v13 offset:38912
    ds_read_b64_tr_b16 v[150:151], v13 offset:39168
    v_lshlrev_b32 v66, 16, v155
    v_and_b32 v67, 0xffff0000, v155
    v_fmac_f32 v56, v60, v60
    v_mfma_f32_32x32x16_bf16 v[120:135], v[156:159], v[164:167], v[120:135]
    v_fmac_f32 v57, v61, v61
    v_fmac_f32 v58, v62, v62
    v_fmac_f32 v59, v63, v63
    v_fmac_f32 v56, v64, v64
    v_fmac_f32 v57, v65, v65
    v_mfma_f32_16x16x32_bf16 v[48:51], v[40:43], v[152:155], v[48:51]
    v_fmac_f32 v58, v66, v66
    v_mfma_f32_16x16x32_bf16 v[52:55], v[40:43], v[160:163], v[52:55]
    v_fmac_f32 v59, v67, v67
    s_barrier
    s_waitcnt lgkmcnt(6)
    v_mfma_f32_32x32x16_bf16 v[72:87], v[168:171], v[176:179], v[72:87]
    ds_read_b128 v[152:155], v32 offset:0
    ds_read_b64_tr_b16 v[160:161], v14 offset:0
    v_lshlrev_b32 v60, 16, v168
    v_and_b32 v61, 0xffff0000, v168
    v_lshlrev_b32 v62, 16, v169
    v_mfma_f32_32x32x16_bf16 v[104:119], v[168:171], v[180:183], v[104:119]
    ds_read_b64_tr_b16 v[162:163], v14 offset:256
    ds_read_b128 v[156:159], v33 offset:0
    v_and_b32 v63, 0xffff0000, v169
    v_lshlrev_b32 v64, 16, v170
    v_and_b32 v65, 0xffff0000, v170
    v_mfma_f32_32x32x16_bf16 v[88:103], v[172:175], v[176:179], v[88:103]
    ds_read_b64_tr_b16 v[164:165], v15 offset:0
    ds_read_b64_tr_b16 v[166:167], v15 offset:256
    v_lshlrev_b32 v66, 16, v171
    v_and_b32 v67, 0xffff0000, v171
    v_fmac_f32 v56, v60, v60
    v_mfma_f32_32x32x16_bf16 v[120:135], v[172:175], v[180:183], v[120:135]
    v_fmac_f32 v57, v61, v61
    v_fmac_f32 v58, v62, v62
    v_fmac_f32 v59, v63, v63
    v_fmac_f32 v56, v64, v64
    v_fmac_f32 v57, v65, v65
    v_mfma_f32_16x16x32_bf16 v[48:51], v[40:43], v[168:171], v[48:51]
    v_fmac_f32 v58, v66, v66
    v_mfma_f32_16x16x32_bf16 v[52:55], v[40:43], v[176:179], v[52:55]
    v_fmac_f32 v59, v67, v67
    s_waitcnt lgkmcnt(6)
    v_mfma_f32_32x32x16_bf16 v[72:87], v[136:139], v[144:147], v[72:87]
    ds_read_b128 v[168:171], v34 offset:0
    ds_read_b64_tr_b16 v[176:177], v14 offset:2048
    v_lshlrev_b32 v60, 16, v136
    v_and_b32 v61, 0xffff0000, v136
    v_lshlrev_b32 v62, 16, v137
    v_mfma_f32_32x32x16_bf16 v[104:119], v[136:139], v[148:151], v[104:119]
    ds_read_b64_tr_b16 v[178:179], v14 offset:2304
    ds_read_b128 v[172:175], v35 offset:0
    v_and_b32 v63, 0xffff0000, v137
    v_lshlrev_b32 v64, 16, v138
    v_and_b32 v65, 0xffff0000, v138
    v_mfma_f32_32x32x16_bf16 v[88:103], v[140:143], v[144:147], v[88:103]
    ds_read_b64_tr_b16 v[180:181], v15 offset:2048
    ds_read_b64_tr_b16 v[182:183], v15 offset:2304
    v_lshlrev_b32 v66, 16, v139
    v_and_b32 v67, 0xffff0000, v139
    v_fmac_f32 v56, v60, v60
    v_mfma_f32_32x32x16_bf16 v[120:135], v[140:143], v[148:151], v[120:135]
    v_fmac_f32 v57, v61, v61
    v_fmac_f32 v58, v62, v62
    v_fmac_f32 v59, v63, v63
    v_fmac_f32 v56, v64, v64
    v_fmac_f32 v57, v65, v65
    v_mfma_f32_16x16x32_bf16 v[48:51], v[40:43], v[136:139], v[48:51]
    v_fmac_f32 v58, v66, v66
    v_mfma_f32_16x16x32_bf16 v[52:55], v[40:43], v[144:147], v[52:55]
    v_fmac_f32 v59, v67, v67
    s_waitcnt lgkmcnt(6)
    v_mfma_f32_32x32x16_bf16 v[72:87], v[152:155], v[160:163], v[72:87]
    ds_read_b128 v[136:139], v36 offset:0
    ds_read_b64_tr_b16 v[144:145], v14 offset:4096
    v_lshlrev_b32 v60, 16, v152
    v_and_b32 v61, 0xffff0000, v152
    v_lshlrev_b32 v62, 16, v153
    v_mfma_f32_32x32x16_bf16 v[104:119], v[152:155], v[164:167], v[104:119]
    ds_read_b64_tr_b16 v[146:147], v14 offset:4352
    ds_read_b128 v[140:143], v37 offset:0
    v_and_b32 v63, 0xffff0000, v153
    v_lshlrev_b32 v64, 16, v154
    v_and_b32 v65, 0xffff0000, v154
    v_mfma_f32_32x32x16_bf16 v[88:103], v[156:159], v[160:163], v[88:103]
    ds_read_b64_tr_b16 v[148:149], v15 offset:4096
    ds_read_b64_tr_b16 v[150:151], v15 offset:4352
    v_lshlrev_b32 v66, 16, v155
    v_and_b32 v67, 0xffff0000, v155
    v_fmac_f32 v56, v60, v60
    v_mfma_f32_32x32x16_bf16 v[120:135], v[156:159], v[164:167], v[120:135]
    v_fmac_f32 v57, v61, v61
    v_fmac_f32 v58, v62, v62
    v_fmac_f32 v59, v63, v63
    v_fmac_f32 v56, v64, v64
    v_fmac_f32 v57, v65, v65
    v_mfma_f32_16x16x32_bf16 v[48:51], v[40:43], v[152:155], v[48:51]
    v_fmac_f32 v58, v66, v66
    v_mfma_f32_16x16x32_bf16 v[52:55], v[40:43], v[160:163], v[52:55]
    v_fmac_f32 v59, v67, v67
    s_waitcnt lgkmcnt(6)
    v_mfma_f32_32x32x16_bf16 v[72:87], v[168:171], v[176:179], v[72:87]
    ds_read_b128 v[152:155], v38 offset:0
    ds_read_b64_tr_b16 v[160:161], v14 offset:6144
    v_lshlrev_b32 v60, 16, v168
    v_and_b32 v61, 0xffff0000, v168
    v_lshlrev_b32 v62, 16, v169
    v_mfma_f32_32x32x16_bf16 v[104:119], v[168:171], v[180:183], v[104:119]
    ds_read_b64_tr_b16 v[162:163], v14 offset:6400
    ds_read_b128 v[156:159], v39 offset:0
    v_and_b32 v63, 0xffff0000, v169
    v_lshlrev_b32 v64, 16, v170
    v_and_b32 v65, 0xffff0000, v170
    v_mfma_f32_32x32x16_bf16 v[88:103], v[172:175], v[176:179], v[88:103]
    ds_read_b64_tr_b16 v[164:165], v15 offset:6144
    ds_read_b64_tr_b16 v[166:167], v15 offset:6400
    v_lshlrev_b32 v66, 16, v171
    v_and_b32 v67, 0xffff0000, v171
    v_fmac_f32 v56, v60, v60
    v_mfma_f32_32x32x16_bf16 v[120:135], v[172:175], v[180:183], v[120:135]
    v_fmac_f32 v57, v61, v61
    v_fmac_f32 v58, v62, v62
    v_fmac_f32 v59, v63, v63
    v_fmac_f32 v56, v64, v64
    v_fmac_f32 v57, v65, v65
    v_mfma_f32_16x16x32_bf16 v[48:51], v[40:43], v[168:171], v[48:51]
    v_fmac_f32 v58, v66, v66
    v_mfma_f32_16x16x32_bf16 v[52:55], v[40:43], v[176:179], v[52:55]
    v_fmac_f32 v59, v67, v67
    s_barrier
    s_waitcnt lgkmcnt(6)
    v_mfma_f32_32x32x16_bf16 v[72:87], v[136:139], v[144:147], v[72:87]
    ds_read_b128 v[168:171], v16 offset:0
    ds_read_b64_tr_b16 v[176:177], v10 offset:0
    v_lshlrev_b32 v60, 16, v136
    v_and_b32 v61, 0xffff0000, v136
    v_lshlrev_b32 v62, 16, v137
    v_mfma_f32_32x32x16_bf16 v[104:119], v[136:139], v[148:151], v[104:119]
    ds_read_b64_tr_b16 v[178:179], v10 offset:256
    ds_read_b128 v[172:175], v17 offset:0
    v_and_b32 v63, 0xffff0000, v137
    v_lshlrev_b32 v64, 16, v138
    v_and_b32 v65, 0xffff0000, v138
    v_mfma_f32_32x32x16_bf16 v[88:103], v[140:143], v[144:147], v[88:103]
    ds_read_b64_tr_b16 v[180:181], v11 offset:0
    ds_read_b64_tr_b16 v[182:183], v11 offset:256
    v_lshlrev_b32 v66, 16, v139
    v_and_b32 v67, 0xffff0000, v139
    v_fmac_f32 v56, v60, v60
    v_mfma_f32_32x32x16_bf16 v[120:135], v[140:143], v[148:151], v[120:135]
    v_fmac_f32 v57, v61, v61
    v_fmac_f32 v58, v62, v62
    v_fmac_f32 v59, v63, v63
    v_fmac_f32 v56, v64, v64
    v_fmac_f32 v57, v65, v65
    v_mfma_f32_16x16x32_bf16 v[48:51], v[40:43], v[136:139], v[48:51]
    v_fmac_f32 v58, v66, v66
    v_mfma_f32_16x16x32_bf16 v[52:55], v[40:43], v[144:147], v[52:55]
    v_fmac_f32 v59, v67, v67
    s_waitcnt lgkmcnt(6)
    v_mfma_f32_32x32x16_bf16 v[72:87], v[152:155], v[160:163], v[72:87]
    ds_read_b128 v[136:139], v18 offset:0
    ds_read_b64_tr_b16 v[144:145], v10 offset:2048
    v_lshlrev_b32 v60, 16, v152
    v_and_b32 v61, 0xffff0000, v152
    v_lshlrev_b32 v62, 16, v153
    v_mfma_f32_32x32x16_bf16 v[104:119], v[152:155], v[164:167], v[104:119]
    ds_read_b64_tr_b16 v[146:147], v10 offset:2304
    ds_read_b128 v[140:143], v19 offset:0
    v_and_b32 v63, 0xffff0000, v153
    v_lshlrev_b32 v64, 16, v154
    v_and_b32 v65, 0xffff0000, v154
    v_mfma_f32_32x32x16_bf16 v[88:103], v[156:159], v[160:163], v[88:103]
    ds_read_b64_tr_b16 v[148:149], v11 offset:2048
    ds_read_b64_tr_b16 v[150:151], v11 offset:2304
    v_lshlrev_b32 v66, 16, v155
    v_and_b32 v67, 0xffff0000, v155
    v_fmac_f32 v56, v60, v60
    v_mfma_f32_32x32x16_bf16 v[120:135], v[156:159], v[164:167], v[120:135]
    v_fmac_f32 v57, v61, v61
    v_fmac_f32 v58, v62, v62
    v_fmac_f32 v59, v63, v63
pg_4:
    s_cbranch_execz pf_ret
    v_fmac_f32 v56, v64, v64
    v_fmac_f32 v57, v65, v65
    v_mfma_f32_16x16x32_bf16 v[48:51], v[40:43], v[152:155], v[48:51]
    v_fmac_f32 v58, v66, v66
    v_mfma_f32_16x16x32_bf16 v[52:55], v[40:43], v[160:163], v[52:55]
    v_fmac_f32 v59, v67, v67
    s_waitcnt lgkmcnt(6)
    v_mfma_f32_32x32x16_bf16 v[72:87], v[168:171], v[176:179], v[72:87]
    ds_read_b128 v[152:155], v20 offset:0
    ds_read_b64_tr_b16 v[160:161], v10 offset:4096
    v_lshlrev_b32 v60, 16, v168
    v_and_b32 v61, 0xffff0000, v168
    v_lshlrev_b32 v62, 16, v169
    v_mfma_f32_32x32x16_bf16 v[104:119], v[168:171], v[180:183], v[104:119]
    ds_read_b64_tr_b16 v[162:163], v10 offset:4352
    ds_read_b128 v[156:159], v21 offset:0
    v_and_b32 v63, 0xffff0000, v169
    v_lshlrev_b32 v64, 16, v170
    v_and_b32 v65, 0xffff0000, v170
    v_mfma_f32_32x32x16_bf16 v[88:103], v[172:175], v[176:179], v[88:103]
    ds_read_b64_tr_b16 v[164:165], v11 offset:4096
    ds_read_b64_tr_b16 v[166:167], v11 offset:4352
    v_lshlrev_b32 v66, 16, v171
    v_and_b32 v67, 0xffff0000, v171
    v_fmac_f32 v56, v60, v60
    v_mfma_f32_32x32x16_bf16 v[120:135], v[172:175], v[180:183], v[120:135]
    v_fmac_f32 v57, v61, v61
    v_fmac_f32 v58, v62, v62
    v_fmac_f32 v59, v63, v63
    v_fmac_f32 v56, v64, v64
    v_fmac_f32 v57, v65, v65
    v_mfma_f32_16x16x32_bf16 v[48:51], v[40:43], v[168:171], v[48:51]
    v_fmac_f32 v58, v66, v66
    v_mfma_f32_16x16x32_bf16 v[52:55], v[40:43], v[176:179], v[52:55]
    v_fmac_f32 v59, v67, v67
    s_waitcnt lgkmcnt(6)
    v_mfma_f32_32x32x16_bf16 v[72:87], v[136:139], v[144:147], v[72:87]
    ds_read_b128 v[168:171], v22 offset:0
    ds_read_b64_tr_b16 v[176:177], v10 offset:6144
    v_lshlrev_b32 v60, 16, v136
    v_and_b32 v61, 0xffff0000, v136
    v_lshlrev_b32 v62, 16, v137
    v_mfma_f32_32x32x16_bf16 v[104:119], v[136:139], v[148:151], v[104:119]
    ds_read_b64_tr_b16 v[178:179], v10 offset:6400
    ds_read_b128 v[172:175], v23 offset:0
    v_and_b32 v63, 0xffff0000, v137
    v_lshlrev_b32 v64, 16, v138
    v_and_b32 v65, 0xffff0000, v138
    v_mfma_f32_32x32x16_bf16 v[88:103], v[140:143], v[144:147], v[88:103]
    ds_read_b64_tr_b16 v[180:181], v11 offset:6144
    ds_read_b64_tr_b16 v[182:183], v11 offset:6400
    v_lshlrev_b32 v66, 16, v139
    v_and_b32 v67, 0xffff0000, v139
    v_fmac_f32 v56, v60, v60
    v_mfma_f32_32x32x16_bf16 v[120:135], v[140:143], v[148:151], v[120:135]
    v_fmac_f32 v57, v61, v61
    v_fmac_f32 v58, v62, v62
    v_fmac_f32 v59, v63, v63
    v_fmac_f32 v56, v64, v64
    v_fmac_f32 v57, v65, v65
    v_mfma_f32_16x16x32_bf16 v[48:51], v[40:43], v[136:139], v[48:51]
    v_fmac_f32 v58, v66, v66
    v_mfma_f32_16x16x32_bf16 v[52:55], v[40:43], v[144:147], v[52:55]
    v_fmac_f32 v59, v67, v67
    s_barrier
    s_waitcnt lgkmcnt(6)
    v_mfma_f32_32x32x16_bf16 v[72:87], v[152:155], v[160:163], v[72:87]
    ds_read_b128 v[136:139], v16 offset:32768
    ds_read_b64_tr_b16 v[144:145], v10 offset:32768
    v_lshlrev_b32 v60, 16, v152
    v_and_b32 v61, 0xffff0000, v152
    v_lshlrev_b32 v62, 16, v153
    v_mfma_f32_32x32x16_bf16 v[104:119], v[152:155], v[164:167], v[104:119]
    ds_read_b64_tr_b16 v[146:147], v10 offset:33024
    ds_read_b128 v[140:143], v17 offset:32768
    v_and_b32 v63, 0xffff0000, v153
    v_lshlrev_b32 v64, 16, v154
    v_and_b32 v65, 0xffff0000, v154
    v_mfma_f32_32x32x16_bf16 v[88:103], v[156:159], v[160:163], v[88:103]
    ds_read_b64_tr_b16 v[148:149], v11 offset:32768
    ds_read_b64_tr_b16 v[150:151], v11 offset:33024
    v_lshlrev_b32 v66, 16, v155
    v_and_b32 v67, 0xffff0000, v155
    v_fmac_f32 v56, v60, v60
    v_mfma_f32_32x32x16_bf16 v[120:135], v[156:159], v[164:167], v[120:135]
    v_fmac_f32 v57, v61, v61
    v_fmac_f32 v58, v62, v62
    v_fmac_f32 v59, v63, v63
    v_fmac_f32 v56, v64, v64
    v_fmac_f32 v57, v65, v65
    v_mfma_f32_16x16x32_bf16 v[48:51], v[40:43], v[152:155], v[48:51]
    v_fmac_f32 v58, v66, v66
    v_mfma_f32_16x16x32_bf16 v[52:55], v[40:43], v[160:163], v[52:55]
    v_fmac_f32 v59, v67, v67
    s_waitcnt lgkmcnt(6)
    v_mfma_f32_32x32x16_bf16 v[72:87], v[168:171], v[176:179], v[72:87]
    ds_read_b128 v[152:155], v18 offset:32768
    ds_read_b64_tr_b16 v[160:161], v10 offset:34816
    v_lshlrev_b32 v60, 16, v168
    v_and_b32 v61, 0xffff0000, v168
    v_lshlrev_b32 v62, 16, v169
    v_mfma_f32_32x32x16_bf16 v[104:119], v[168:171], v[180:183], v[104:119]
    ds_read_b64_tr_b16 v[162:163], v10 offset:35072
    ds_read_b128 v[156:159], v19 offset:32768
    v_and_b32 v63, 0xffff0000, v169
    v_lshlrev_b32 v64, 16, v170
    v_and_b32 v65, 0xffff0000, v170
    v_mfma_f32_32x32x16_bf16 v[88:103], v[172:175], v[176:179], v[88:103]
    ds_read_b64_tr_b16 v[164:165], v11 offset:34816
    ds_read_b64_tr_b16 v[166:167], v11 offset:35072
    v_lshlrev_b32 v66, 16, v171
    v_and_b32 v67, 0xffff0000, v171
    v_fmac_f32 v56, v60, v60
    v_mfma_f32_32x32x16_bf16 v[120:135], v[172:175], v[180:183], v[120:135]
    v_fmac_f32 v57, v61, v61
    v_fmac_f32 v58, v62, v62
    v_fmac_f32 v59, v63, v63
    v_fmac_f32 v56, v64, v64
    v_fmac_f32 v57, v65, v65
    v_mfma_f32_16x16x32_bf16 v[48:51], v[40:43], v[168:171], v[48:51]
    v_fmac_f32 v58, v66, v66
    v_mfma_f32_16x16x32_bf16 v[52:55], v[40:43], v[176:179], v[52:55]
    v_fmac_f32 v59, v67, v67
    s_waitcnt lgkmcnt(6)
    v_mfma_f32_32x32x16_bf16 v[72:87], v[136:139], v[144:147], v[72:87]
    ds_read_b128 v[168:171], v20 offset:32768
    ds_read_b64_tr_b16 v[176:177], v10 offset:36864
    v_lshlrev_b32 v60, 16, v136
    v_and_b32 v61, 0xffff0000, v136
    v_lshlrev_b32 v62, 16, v137
    v_mfma_f32_32x32x16_bf16 v[104:119], v[136:139], v[148:151], v[104:119]
    ds_read_b64_tr_b16 v[178:179], v10 offset:37120
    ds_read_b128 v[172:175], v21 offset:32768
    v_and_b32 v63, 0xffff0000, v137
    v_lshlrev_b32 v64, 16, v138
    v_and_b32 v65, 0xffff0000, v138
    v_mfma_f32_32x32x16_bf16 v[88:103], v[140:143], v[144:147], v[88:103]
    ds_read_b64_tr_b16 v[180:181], v11 offset:36864
    ds_read_b64_tr_b16 v[182:183], v11 offset:37120
    v_lshlrev_b32 v66, 16, v139
    v_and_b32 v67, 0xffff0000, v139
    v_fmac_f32 v56, v60, v60
    v_mfma_f32_32x32x16_bf16 v[120:135], v[140:143], v[148:151], v[120:135]
    v_fmac_f32 v57, v61, v61
    v_fmac_f32 v58, v62, v62
    v_fmac_f32 v59, v63, v63
    v_fmac_f32 v56, v64, v64
    v_fmac_f32 v57, v65, v65
    v_mfma_f32_16x16x32_bf16 v[48:51], v[40:43], v[136:139], v[48:51]
    v_fmac_f32 v58, v66, v66
    v_mfma_f32_16x16x32_bf16 v[52:55], v[40:43], v[144:147], v[52:55]
    v_fmac_f32 v59, v67, v67
    s_waitcnt lgkmcnt(6)
    v_mfma_f32_32x32x16_bf16 v[72:87], v[152:155], v[160:163], v[72:87]
    ds_read_b128 v[136:139], v22 offset:32768
    ds_read_b64_tr_b16 v[144:145], v10 offset:38912
    v_lshlrev_b32 v60, 16, v152
    v_and_b32 v61, 0xffff0000, v152
    v_lshlrev_b32 v62, 16, v153
    v_mfma_f32_32x32x16_bf16 v[104:119], v[152:155], v[164:167], v[104:119]
    ds_read_b64_tr_b16 v[146:147], v10 offset:39168
    ds_read_b128 v[140:143], v23 offset:32768
    v_and_b32 v63, 0xffff0000, v153
    v_lshlrev_b32 v64, 16, v154
    v_and_b32 v65, 0xffff0000, v154
    v_mfma_f32_32x32x16_bf16 v[88:103], v[156:159], v[160:163], v[88:103]
    ds_read_b64_tr_b16 v[148:149], v11 offset:38912
    ds_read_b64_tr_b16 v[150:151], v11 offset:39168
    v_lshlrev_b32 v66, 16, v155
    v_and_b32 v67, 0xffff0000, v155
    v_fmac_f32 v56, v60, v60
    v_mfma_f32_32x32x16_bf16 v[120:135], v[156:159], v[164:167], v[120:135]
    v_fmac_f32 v57, v61, v61
    v_fmac_f32 v58, v62, v62
    v_fmac_f32 v59, v63, v63
    v_fmac_f32 v56, v64, v64
    v_fmac_f32 v57, v65, v65
    v_mfma_f32_16x16x32_bf16 v[48:51], v[40:43], v[152:155], v[48:51]
    v_fmac_f32 v58, v66, v66
    v_mfma_f32_16x16x32_bf16 v[52:55], v[40:43], v[160:163], v[52:55]
    v_fmac_f32 v59, v67, v67
    s_barrier
    s_waitcnt lgkmcnt(6)
    v_mfma_f32_32x32x16_bf16 v[72:87], v[168:171], v[176:179], v[72:87]
    ds_read_b128 v[152:155], v24 offset:0
    ds_read_b64_tr_b16 v[160:161], v12 offset:0
    v_lshlrev_b32 v60, 16, v168
    v_and_b32 v61, 0xffff0000, v168
    v_lshlrev_b32 v62, 16, v169
    v_mfma_f32_32x32x16_bf16 v[104:119], v[168:171], v[180:183], v[104:119]
    ds_read_b64_tr_b16 v[162:163], v12 offset:256
    ds_read_b128 v[156:159], v25 offset:0
    v_and_b32 v63, 0xffff0000, v169
    v_lshlrev_b32 v64, 16, v170
    v_and_b32 v65, 0xffff0000, v170
    v_mfma_f32_32x32x16_bf16 v[88:103], v[172:175], v[176:179], v[88:103]
    ds_read_b64_tr_b16 v[164:165], v13 offset:0
    ds_read_b64_tr_b16 v[166:167], v13 offset:256
    v_lshlrev_b32 v66, 16, v171
    v_and_b32 v67, 0xffff0000, v171
    v_fmac_f32 v56, v60, v60
    v_mfma_f32_32x32x16_bf16 v[120:135], v[172:175], v[180:183], v[120:135]
    v_fmac_f32 v57, v61, v61
    v_fmac_f32 v58, v62, v62
    v_fmac_f32 v59, v63, v63
    v_fmac_f32 v56, v64, v64
    v_fmac_f32 v57, v65, v65
    v_mfma_f32_16x16x32_bf16 v[48:51], v[40:43], v[168:171], v[48:51]
    v_fmac_f32 v58, v66, v66
    v_mfma_f32_16x16x32_bf16 v[52:55], v[40:43], v[176:179], v[52:55]
    v_fmac_f32 v59, v67, v67
    s_waitcnt lgkmcnt(6)
    v_mfma_f32_32x32x16_bf16 v[72:87], v[136:139], v[144:147], v[72:87]
    ds_read_b128 v[168:171], v26 offset:0
    ds_read_b64_tr_b16 v[176:177], v12 offset:2048
    v_lshlrev_b32 v60, 16, v136
    v_and_b32 v61, 0xffff0000, v136
    v_lshlrev_b32 v62, 16, v137
    v_mfma_f32_32x32x16_bf16 v[104:119], v[136:139], v[148:151], v[104:119]
    ds_read_b64_tr_b16 v[178:179], v12 offset:2304
    ds_read_b128 v[172:175], v27 offset:0
    v_and_b32 v63, 0xffff0000, v137
    v_lshlrev_b32 v64, 16, v138
    v_and_b32 v65, 0xffff0000, v138
    v_mfma_f32_32x32x16_bf16 v[88:103], v[140:143], v[144:147], v[88:103]
    ds_read_b64_tr_b16 v[180:181], v13 offset:2048
    ds_read_b64_tr_b16 v[182:183], v13 offset:2304
    v_lshlrev_b32 v66, 16, v139
    v_and_b32 v67, 0xffff0000, v139
    v_fmac_f32 v56, v60, v60
    v_mfma_f32_32x32x16_bf16 v[120:135], v[140:143], v[148:151], v[120:135]
    v_fmac_f32 v57, v61, v61
    v_fmac_f32 v58, v62, v62
    v_fmac_f32 v59, v63, v63
    v_fmac_f32 v56, v64, v64
    v_fmac_f32 v57, v65, v65
    v_mfma_f32_16x16x32_bf16 v[48:51], v[40:43], v[136:139], v[48:51]
    v_fmac_f32 v58, v66, v66
    v_mfma_f32_16x16x32_bf16 v[52:55], v[40:43], v[144:147], v[52:55]
    v_fmac_f32 v59, v67, v67
    s_waitcnt lgkmcnt(6)
    v_mfma_f32_32x32x16_bf16 v[72:87], v[152:155], v[160:163], v[72:87]
    ds_read_b128 v[136:139], v28 offset:0
    ds_read_b64_tr_b16 v[144:145], v12 offset:4096
    v_lshlrev_b32 v60, 16, v152
    v_and_b32 v61, 0xffff0000, v152
    v_lshlrev_b32 v62, 16, v153
    v_mfma_f32_32x32x16_bf16 v[104:119], v[152:155], v[164:167], v[104:119]
    ds_read_b64_tr_b16 v[146:147], v12 offset:4352
    ds_read_b128 v[140:143], v29 offset:0
    v_and_b32 v63, 0xffff0000, v153
    v_lshlrev_b32 v64, 16, v154
    v_and_b32 v65, 0xffff0000, v154
    v_mfma_f32_32x32x16_bf16 v[88:103], v[156:159], v[160:163], v[88:103]
    ds_read_b64_tr_b16 v[148:149], v13 offset:4096
    ds_read_b64_tr_b16 v[150:151], v13 offset:4352
    v_lshlrev_b32 v66, 16, v155
    v_and_b32 v67, 0xffff0000, v155
    v_fmac_f32 v56, v60, v60
    v_mfma_f32_32x32x16_bf16 v[120:135], v[156:159], v[164:167], v[120:135]
    v_fmac_f32 v57, v61, v61
    v_fmac_f32 v58, v62, v62
    v_fmac_f32 v59, v63, v63
    v_fmac_f32 v56, v64, v64
    v_fmac_f32 v57, v65, v65
    v_mfma_f32_16x16x32_bf16 v[48:51], v[40:43], v[152:155], v[48:51]
    v_fmac_f32 v58, v66, v66
    v_mfma_f32_16x16x32_bf16 v[52:55], v[40:43], v[160:163], v[52:55]
    v_fmac_f32 v59, v67, v67
    s_waitcnt lgkmcnt(6)
    v_mfma_f32_32x32x16_bf16 v[72:87], v[168:171], v[176:179], v[72:87]
    ds_read_b128 v[152:155], v30 offset:0
    ds_read_b64_tr_b16 v[160:161], v12 offset:6144
    v_lshlrev_b32 v60, 16, v168
    v_and_b32 v61, 0xffff0000, v168
    v_lshlrev_b32 v62, 16, v169
    v_mfma_f32_32x32x16_bf16 v[104:119], v[168:171], v[180:183], v[104:119]
    ds_read_b64_tr_b16 v[162:163], v12 offset:6400
    ds_read_b128 v[156:159], v31 offset:0
    v_and_b32 v63, 0xffff0000, v169
    v_lshlrev_b32 v64, 16, v170
    v_and_b32 v65, 0xffff0000, v170
    v_mfma_f32_32x32x16_bf16 v[88:103], v[172:175], v[176:179], v[88:103]
    ds_read_b64_tr_b16 v[164:165], v13 offset:6144
    ds_read_b64_tr_b16 v[166:167], v13 offset:6400
    v_lshlrev_b32 v66, 16, v171
    v_and_b32 v67, 0xffff0000, v171
    v_fmac_f32 v56, v60, v60
    v_mfma_f32_32x32x16_bf16 v[120:135], v[172:175], v[180:183], v[120:135]
    v_fmac_f32 v57, v61, v61
    v_fmac_f32 v58, v62, v62
    v_fmac_f32 v59, v63, v63
    v_fmac_f32 v56, v64, v64
    v_fmac_f32 v57, v65, v65
    v_mfma_f32_16x16x32_bf16 v[48:51], v[40:43], v[168:171], v[48:51]
    v_fmac_f32 v58, v66, v66
    v_mfma_f32_16x16x32_bf16 v[52:55], v[40:43], v[176:179], v[52:55]
    v_fmac_f32 v59, v67, v67
    s_barrier
    s_waitcnt lgkmcnt(6)
    v_mfma_f32_32x32x16_bf16 v[72:87], v[136:139], v[144:147], v[72:87]
    ds_read_b128 v[168:171], v24 offset:32768
    ds_read_b64_tr_b16 v[176:177], v12 offset:32768
    v_lshlrev_b32 v60, 16, v136
    v_and_b32 v61, 0xffff0000, v136
    v_lshlrev_b32 v62, 16, v137
    v_mfma_f32_32x32x16_bf16 v[104:119], v[136:139], v[148:151], v[104:119]
    ds_read_b64_tr_b16 v[178:179], v12 offset:33024
    ds_read_b128 v[172:175], v25 offset:32768
    v_and_b32 v63, 0xffff0000, v137
    v_lshlrev_b32 v64, 16, v138
    v_and_b32 v65, 0xffff0000, v138
    v_mfma_f32_32x32x16_bf16 v[88:103], v[140:143], v[144:147], v[88:103]
    ds_read_b64_tr_b16 v[180:181], v13 offset:32768
    ds_read_b64_tr_b16 v[182:183], v13 offset:33024
    v_lshlrev_b32 v66, 16, v139
    v_and_b32 v67, 0xffff0000, v139
    v_fmac_f32 v56, v60, v60
    v_mfma_f32_32x32x16_bf16 v[120:135], v[140:143], v[148:151], v[120:135]
    v_fmac_f32 v57, v61, v61
    v_fmac_f32 v58, v62, v62
    v_fmac_f32 v59, v63, v63
    v_fmac_f32 v56, v64, v64
    v_fmac_f32 v57, v65, v65
    v_mfma_f32_16x16x32_bf16 v[48:51], v[40:43], v[136:139], v[48:51]
    v_fmac_f32 v58, v66, v66
    v_mfma_f32_16x16x32_bf16 v[52:55], v[40:43], v[144:147], v[52:55]
    v_fmac_f32 v59, v67, v67
    s_waitcnt lgkmcnt(6)
    v_mfma_f32_32x32x16_bf16 v[72:87], v[152:155], v[160:163], v[72:87]
    ds_read_b128 v[136:139], v26 offset:32768
    ds_read_b64_tr_b16 v[144:145], v12 offset:34816
    v_lshlrev_b32 v60, 16, v152
    v_and_b32 v61, 0xffff0000, v152
    v_lshlrev_b32 v62, 16, v153
    v_mfma_f32_32x32x16_bf16 v[104:119], v[152:155], v[164:167], v[104:119]
    ds_read_b64_tr_b16 v[146:147], v12 offset:35072
    ds_read_b128 v[140:143], v27 offset:32768
    v_and_b32 v63, 0xffff0000, v153
    v_lshlrev_b32 v64, 16, v154
    v_and_b32 v65, 0xffff0000, v154
    v_mfma_f32_32x32x16_bf16 v[88:103], v[156:159], v[160:163], v[88:103]
    ds_read_b64_tr_b16 v[148:149], v13 offset:34816
    ds_read_b64_tr_b16 v[150:151], v13 offset:35072
    v_lshlrev_b32 v66, 16, v155
    v_and_b32 v67, 0xffff0000, v155
    v_fmac_f32 v56, v60, v60
    v_mfma_f32_32x32x16_bf16 v[120:135], v[156:159], v[164:167], v[120:135]
    v_fmac_f32 v57, v61, v61
    v_fmac_f32 v58, v62, v62
    v_fmac_f32 v59, v63, v63
    v_fmac_f32 v56, v64, v64
    v_fmac_f32 v57, v65, v65
    v_mfma_f32_16x16x32_bf16 v[48:51], v[40:43], v[152:155], v[48:51]
    v_fmac_f32 v58, v66, v66
    v_mfma_f32_16x16x32_bf16 v[52:55], v[40:43], v[160:163], v[52:55]
    v_fmac_f32 v59, v67, v67
    s_waitcnt lgkmcnt(6)
    v_mfma_f32_32x32x16_bf16 v[72:87], v[168:171], v[176:179], v[72:87]
    ds_read_b128 v[152:155], v28 offset:32768
    ds_read_b64_tr_b16 v[160:161], v12 offset:36864
    v_lshlrev_b32 v60, 16, v168
    v_and_b32 v61, 0xffff0000, v168
    v_lshlrev_b32 v62, 16, v169
    v_mfma_f32_32x32x16_bf16 v[104:119], v[168:171], v[180:183], v[104:119]
    ds_read_b64_tr_b16 v[162:163], v12 offset:37120
    ds_read_b128 v[156:159], v29 offset:32768
    v_and_b32 v63, 0xffff0000, v169
    v_lshlrev_b32 v64, 16, v170
    v_and_b32 v65, 0xffff0000, v170
    v_mfma_f32_32x32x16_bf16 v[88:103], v[172:175], v[176:179], v[88:103]
    ds_read_b64_tr_b16 v[164:165], v13 offset:36864
    ds_read_b64_tr_b16 v[166:167], v13 offset:37120
    v_lshlrev_b32 v66, 16, v171
    v_and_b32 v67, 0xffff0000, v171
    v_fmac_f32 v56, v60, v60
    v_mfma_f32_32x32x16_bf16 v[120:135], v[172:175], v[180:183], v[120:135]
    v_fmac_f32 v57, v61, v61
    v_fmac_f32 v58, v62, v62
    v_fmac_f32 v59, v63, v63
    v_fmac_f32 v56, v64, v64
    v_fmac_f32 v57, v65, v65
    v_mfma_f32_16x16x32_bf16 v[48:51], v[40:43], v[168:171], v[48:51]
    v_fmac_f32 v58, v66, v66
    v_mfma_f32_16x16x32_bf16 v[52:55], v[40:43], v[176:179], v[52:55]
    v_fmac_f32 v59, v67, v67
    s_waitcnt lgkmcnt(6)
    v_mfma_f32_32x32x16_bf16 v[72:87], v[136:139], v[144:147], v[72:87]
    ds_read_b128 v[168:171], v30 offset:32768
    ds_read_b64_tr_b16 v[176:177], v12 offset:38912
    v_lshlrev_b32 v60, 16, v136
    v_and_b32 v61, 0xffff0000, v136
    v_lshlrev_b32 v62, 16, v137
    v_mfma_f32_32x32x16_bf16 v[104:119], v[136:139], v[148:151], v[104:119]
    ds_read_b64_tr_b16 v[178:179], v12 offset:39168
    ds_read_b128 v[172:175], v31 offset:32768
    v_and_b32 v63, 0xffff0000, v137
    v_lshlrev_b32 v64, 16, v138
    v_and_b32 v65, 0xffff0000, v138
    v_mfma_f32_32x32x16_bf16 v[88:103], v[140:143], v[144:147], v[88:103]
    ds_read_b64_tr_b16 v[180:181], v13 offset:38912
    ds_read_b64_tr_b16 v[182:183], v13 offset:39168
    v_lshlrev_b32 v66, 16, v139
    v_and_b32 v67, 0xffff0000, v139
    v_fmac_f32 v56, v60, v60
    v_mfma_f32_32x32x16_bf16 v[120:135], v[140:143], v[148:151], v[120:135]
    v_fmac_f32 v57, v61, v61
    v_fmac_f32 v58, v62, v62
    v_fmac_f32 v59, v63, v63
    v_fmac_f32 v56, v64, v64
    v_fmac_f32 v57, v65, v65
    v_mfma_f32_16x16x32_bf16 v[48:51], v[40:43], v[136:139], v[48:51]
    v_fmac_f32 v58, v66, v66
    v_mfma_f32_16x16x32_bf16 v[52:55], v[40:43], v[144:147], v[52:55]
    v_fmac_f32 v59, v67, v67
    s_waitcnt lgkmcnt(6)
    v_mfma_f32_32x32x16_bf16 v[72:87], v[152:155], v[160:163], v[72:87]
    v_lshlrev_b32 v60, 16, v152
    v_and_b32 v61, 0xffff0000, v152
    v_lshlrev_b32 v62, 16, v153
    v_mfma_f32_32x32x16_bf16 v[104:119], v[152:155], v[164:167], v[104:119]
    v_and_b32 v63, 0xffff0000, v153
    v_lshlrev_b32 v64, 16, v154
    v_and_b32 v65, 0xffff0000, v154
    v_mfma_f32_32x32x16_bf16 v[88:103], v[156:159], v[160:163], v[88:103]
    v_lshlrev_b32 v66, 16, v155
    v_and_b32 v67, 0xffff0000, v155
    v_fmac_f32 v56, v60, v60
    v_mfma_f32_32x32x16_bf16 v[120:135], v[156:159], v[164:167], v[120:135]
    v_fmac_f32 v57, v61, v61
    v_fmac_f32 v58, v62, v62
    v_fmac_f32 v59, v63, v63
    v_fmac_f32 v56, v64, v64
    v_fmac_f32 v57, v65, v65
    v_mfma_f32_16x16x32_bf16 v[48:51], v[40:43], v[152:155], v[48:51]
    v_fmac_f32 v58, v66, v66
    v_mfma_f32_16x16x32_bf16 v[52:55], v[40:43], v[160:163], v[52:55]
    v_fmac_f32 v59, v67, v67
    s_waitcnt lgkmcnt(0)
    v_mfma_f32_16x16x32_bf16 v[48:51], v[40:43], v[168:171], v[48:51]
    v_lshlrev_b32 v60, 16, v168
    v_and_b32 v61, 0xffff0000, v168
    v_mfma_f32_16x16x32_bf16 v[52:55], v[40:43], v[176:179], v[52:55]
    v_lshlrev_b32 v62, 16, v169
    v_and_b32 v63, 0xffff0000, v169
    v_mfma_f32_32x32x16_bf16 v[72:87], v[168:171], v[176:179], v[72:87]
    v_lshlrev_b32 v64, 16, v170
    v_and_b32 v65, 0xffff0000, v170
    v_lshlrev_b32 v66, 16, v171
    v_and_b32 v67, 0xffff0000, v171
    v_fmac_f32 v56, v60, v60
    v_fmac_f32 v57, v61, v61
    v_mfma_f32_32x32x16_bf16 v[104:119], v[168:171], v[180:183], v[104:119]
    v_fmac_f32 v58, v62, v62
    v_fmac_f32 v59, v63, v63
    v_fmac_f32 v56, v64, v64
    v_fmac_f32 v57, v65, v65
    v_fmac_f32 v58, v66, v66
    v_fmac_f32 v59, v67, v67
    v_mfma_f32_32x32x16_bf16 v[88:103], v[172:175], v[176:179], v[88:103]
    v_mfma_f32_32x32x16_bf16 v[120:135], v[172:175], v[180:183], v[120:135]
    v_add_f32 v56, v56, v57
    v_add_f32 v58, v58, v59
    v_add_f32 v56, v56, v58
    v_mov_b32 v57, v56
    s_nop 1
    v_permlane32_swap_b32 v56, v57
    v_mul_f32 v48, 0xbae38e39, v48
    v_add_f32 v56, v56, v57
    v_mov_b32 v57, 0x3727c5ac
    v_fmac_f32 v57, 0x3ae38e39, v56
    v_fma_f32 v57, -v48, v48, v57
    v_max_f32 v57, 0x3727c5ac, v57
    v_rsq_f32 v64, v57
    v_cvt_pk_bf16_f32 v68, v48, v52
    v_lshlrev_b32 v69, 16, v68
    v_and_b32 v71, 0xffff0000, v68
    v_sub_f32 v49, v48, v69
    v_sub_f32 v53, v52, v71
    v_cvt_pk_bf16_f32 v60, v69, v49
    s_mov_b32 s46, 0
    s_mov_b32 s47, -1
    v_cndmask_b32 v71, v71, v53, s[46:47]
    v_cvt_pk_bf16_f32 v136, v71, v71
    s_lshl_b32 s42, s36, 10
    s_add_u32 s42, s42, 159744
    v_lshl_add_u32 v68, v2, 2, s42
    ds_write_b32 v68, v60
    ds_write_b32 v68, v64 offset:256
    ds_write_b32 v68, v136 offset:512
    v_xor_b32 v69, 2048, v68
    v_xor_b32 v71, 1024, v68
    v_mov_b32 v61, 0
    v_mov_b32 v63, 0
    v_mov_b32 v137, 0
    v_mov_b32 v139, 0
    s_nop 0
    v_mfma_f32_32x32x8_bf16 v[72:87], v[60:61], v[136:137], v[72:87]
    s_waitcnt lgkmcnt(0)
    s_barrier
    ds_read_b32 v62, v69
    ds_read_b32 v138, v71 offset:512
    v_lshlrev_b32 v68, 4, v70
    v_add_u32 v68, s42, v68
    v_xor_b32 v69, 2048, v68
    ds_read_b128 v[16:19], v68 offset:256
    ds_read_b128 v[20:23], v68 offset:288
    ds_read_b128 v[24:27], v68 offset:320
    ds_read_b128 v[28:31], v68 offset:352
    ds_read_b128 v[32:35], v69 offset:256
    ds_read_b128 v[36:39], v69 offset:288
    ds_read_b128 v[40:43], v69 offset:320
    ds_read_b128 v[44:47], v69 offset:352
    s_cmp_ge_u32 s49, 54
    s_cbranch_scc1 sequential_preLN__sliding_block__glu_gated_bilinear__prompt_kernel_vdone
    s_waitcnt lgkmcnt(8)
    v_mfma_f32_32x32x8_bf16 v[104:119], v[60:61], v[138:139], v[104:119]
    v_mfma_f32_32x32x8_bf16 v[88:103], v[62:63], v[136:137], v[88:103]
    v_mfma_f32_32x32x8_bf16 v[120:135], v[62:63], v[138:139], v[120:135]
    s_xor_b32 s42, s48, 0
    s_mul_i32 s42, s42, 36864
    s_xor_b32 s45, s49, 0
    s_sub_u32 s45, s45, 36
    s_lshl_b32 s45, s45, 9
    s_add_u32 s42, s42, s45
    s_add_u32 s45, s42, 18432
    s_waitcnt lgkmcnt(4)
    v_mul_f32 v72, v16, v72
    v_mul_f32 v73, v17, v73
    v_mul_f32 v74, v18, v74
    v_mul_f32 v75, v19, v75
    v_mul_f32 v76, v20, v76
    v_mul_f32 v77, v21, v77
    v_mul_f32 v78, v22, v78
    v_mul_f32 v79, v23, v79
    v_cvt_pk_bf16_f32 v144, v72, v73
    v_cvt_pk_bf16_f32 v145, v74, v75
    v_cvt_pk_bf16_f32 v146, v76, v77
    v_cvt_pk_bf16_f32 v147, v78, v79
    buffer_store_dwordx4 v[144:147], v7, s[28:31], s42 offen sc1
    v_mul_f32 v80, v24, v80
    v_mul_f32 v81, v25, v81
    v_mul_f32 v82, v26, v82
    v_mul_f32 v83, v27, v83
    v_mul_f32 v84, v28, v84
    v_mul_f32 v85, v29, v85
    v_mul_f32 v86, v30, v86
    v_mul_f32 v87, v31, v87
    v_cvt_pk_bf16_f32 v148, v80, v81
    v_cvt_pk_bf16_f32 v149, v82, v83
    v_cvt_pk_bf16_f32 v150, v84, v85
    v_cvt_pk_bf16_f32 v151, v86, v87
    buffer_store_dwordx4 v[148:151], v7, s[28:31], s45 offen sc1
    s_xor_b32 s42, s48, 0
    s_mul_i32 s42, s42, 36864
    s_xor_b32 s45, s49, 1
    s_sub_u32 s45, s45, 36
    s_lshl_b32 s45, s45, 9
    s_add_u32 s42, s42, s45
    s_add_u32 s45, s42, 18432
    v_mul_f32 v104, v16, v104
    v_mul_f32 v105, v17, v105
    v_mul_f32 v106, v18, v106
    v_mul_f32 v107, v19, v107
    v_mul_f32 v108, v20, v108
    v_mul_f32 v109, v21, v109
    v_mul_f32 v110, v22, v110
    v_mul_f32 v111, v23, v111
    v_cvt_pk_bf16_f32 v152, v104, v105
    v_cvt_pk_bf16_f32 v153, v106, v107
    v_cvt_pk_bf16_f32 v154, v108, v109
    v_cvt_pk_bf16_f32 v155, v110, v111
    buffer_store_dwordx4 v[152:155], v7, s[28:31], s42 offen sc1
    v_mul_f32 v112, v24, v112
    v_mul_f32 v113, v25, v113
    v_mul_f32 v114, v26, v114
    v_mul_f32 v115, v27, v115
    v_mul_f32 v116, v28, v116
    v_mul_f32 v117, v29, v117
    v_mul_f32 v118, v30, v118
    v_mul_f32 v119, v31, v119
    v_cvt_pk_bf16_f32 v156, v112, v113
    v_cvt_pk_bf16_f32 v157, v114, v115
    v_cvt_pk_bf16_f32 v158, v116, v117
    v_cvt_pk_bf16_f32 v159, v118, v119
    buffer_store_dwordx4 v[156:159], v7, s[28:31], s45 offen sc1
    s_xor_b32 s42, s48, 1
    s_mul_i32 s42, s42, 36864
    s_xor_b32 s45, s49, 0
    s_sub_u32 s45, s45, 36
    s_lshl_b32 s45, s45, 9
    s_add_u32 s42, s42, s45
    s_add_u32 s45, s42, 18432
    s_waitcnt lgkmcnt(0)
    v_mul_f32 v88, v32, v88
    v_mul_f32 v89, v33, v89
    v_mul_f32 v90, v34, v90
    v_mul_f32 v91, v35, v91
    v_mul_f32 v92, v36, v92
    v_mul_f32 v93, v37, v93
    v_mul_f32 v94, v38, v94
    v_mul_f32 v95, v39, v95
    v_cvt_pk_bf16_f32 v160, v88, v89
    v_cvt_pk_bf16_f32 v161, v90, v91
    v_cvt_pk_bf16_f32 v162, v92, v93
    v_cvt_pk_bf16_f32 v163, v94, v95
    buffer_store_dwordx4 v[160:163], v7, s[28:31], s42 offen sc1
    v_mul_f32 v96, v40, v96
    v_mul_f32 v97, v41, v97
    v_mul_f32 v98, v42, v98
    v_mul_f32 v99, v43, v99
    v_mul_f32 v100, v44, v100
    v_mul_f32 v101, v45, v101
    v_mul_f32 v102, v46, v102
    v_mul_f32 v103, v47, v103
    v_cvt_pk_bf16_f32 v164, v96, v97
    v_cvt_pk_bf16_f32 v165, v98, v99
    v_cvt_pk_bf16_f32 v166, v100, v101
    v_cvt_pk_bf16_f32 v167, v102, v103
    buffer_store_dwordx4 v[164:167], v7, s[28:31], s45 offen sc1
    s_xor_b32 s42, s48, 1
    s_mul_i32 s42, s42, 36864
    s_xor_b32 s45, s49, 1
    s_sub_u32 s45, s45, 36
    s_lshl_b32 s45, s45, 9
    s_add_u32 s42, s42, s45
    s_add_u32 s45, s42, 18432
    v_mul_f32 v120, v32, v120
    v_mul_f32 v121, v33, v121
    v_mul_f32 v122, v34, v122
    v_mul_f32 v123, v35, v123
    v_mul_f32 v124, v36, v124
    v_mul_f32 v125, v37, v125
    v_mul_f32 v126, v38, v126
    v_mul_f32 v127, v39, v127
    v_cvt_pk_bf16_f32 v168, v120, v121
    v_cvt_pk_bf16_f32 v169, v122, v123
    v_cvt_pk_bf16_f32 v170, v124, v125
    v_cvt_pk_bf16_f32 v171, v126, v127
    buffer_store_dwordx4 v[168:171], v7, s[28:31], s42 offen sc1
    v_mul_f32 v128, v40, v128
    v_mul_f32 v129, v41, v129
    v_mul_f32 v130, v42, v130
    v_mul_f32 v131, v43, v131
    v_mul_f32 v132, v44, v132
    v_mul_f32 v133, v45, v133
    v_mul_f32 v134, v46, v134
    v_mul_f32 v135, v47, v135
    v_cvt_pk_bf16_f32 v172, v128, v129
    v_cvt_pk_bf16_f32 v173, v130, v131
    v_cvt_pk_bf16_f32 v174, v132, v133
    v_cvt_pk_bf16_f32 v175, v134, v135
    buffer_store_dwordx4 v[172:175], v7, s[28:31], s45 offen sc1
sequential_preLN__sliding_block__glu_gated_bilinear__prompt_kernel_vdone:
    s_mul_i32 s46, s51, 128
    s_lshl_b32 s47, s36, 2
    s_add_u32 s46, s46, s47
    s_add_u32 s46, s46, 0xd00000
    v_mov_b32 v1, 1
    s_waitcnt vmcnt(0)
    s_mov_b64 exec, 1
    buffer_store_dword v1, off, s[32:35], s46 sc1
    s_mov_b64 exec, -1
    s_barrier
    s_branch sequential_preLN__sliding_block__glu_gated_bilinear__prompt_kernel_entry
sequential_preLN__sliding_block__glu_gated_bilinear__prompt_kernel_pf:
    s_cmp_lt_u32 s36, 4
    s_cbranch_scc1 sequential_preLN__sliding_block__glu_gated_bilinear__prompt_kernel_hl11
    s_load_dwordx2 s[60:61], s[0:1], 32
    s_load_dwordx2 s[64:65], s[0:1], 40
    s_load_dwordx2 s[68:69], s[0:1], 48
    s_load_dwordx2 s[78:79], s[0:1], 16
    s_and_b32 s36, s36, 3
    s_waitcnt lgkmcnt(0)
    s_mov_b32 s32, s10
    s_mov_b32 s33, s11
    s_mov_b32 s34, 0x10000000
    s_mov_b32 s35, 0x00020000
    v_mov_b32 v12, -1
    v_mov_b32 v13, -1
    v_mov_b32 v14, -1
    v_mov_b32 v15, -1
    v_lshlrev_b32 v1, 4, v2
    s_mul_i32 s59, s2, 9216
    s_and_b32 s46, s36, 1
    s_mul_i32 s46, s46, 4096
    s_add_u32 s59, s59, s46
    s_lshr_b32 s46, s36, 1
    s_mul_i32 s46, s46, 2359296
    s_add_u32 s59, s59, s46
    s_add_u32 s59, s59, 0x800000
    s_and_b32 s47, s2, 31
    s_lshr_b32 s48, s2, 5
    s_lshl_b32 s49, s48, 10
    s_sub_u32 s50, s47, 5
    s_lshl_b32 s50, s50, 13
    s_add_u32 s50, s50, s49
    s_add_u32 s50, s50, 0x2800000
    s_lshl_b32 s51, s48, 2
    s_add_u32 s51, s51, s47
    s_lshl_b32 s51, s51, 10
    s_add_u32 s51, s51, 0xc81c00
    s_cmp_lt_u32 s47, 5
    s_cselect_b32 s50, s51, s50
    s_add_u32 s49, s49, 0xc80000
    s_cmp_eq_u32 s47, 0
    s_cselect_b32 s50, s49, s50
    s_cmp_lt_u32 s47, 17
    s_cselect_b32 s50, s50, s59
    s_cmp_eq_u32 s36, 0
    s_cselect_b32 s50, s50, s59
    s_add_u32 s51, s59, 4096
    s_bitcmp1_b32 s36, 0
    s_cselect_b32 s50, s51, s50
    s_mov_b32 s72, s8
    s_mov_b32 s73, s9
    s_mov_b32 s74, 0x100
    s_mov_b32 s75, 0x00020000
    v_and_b32 v21, 7, v2
    v_lshlrev_b32 v21, 2, v21
    s_lshl_b32 s37, s36, 5
    s_add_u32 s37, s37, s2
    s_sub_u32 s37, s37, 224
    s_mov_b32 s16, s78
    s_mov_b32 s17, s79
    s_mov_b32 s18, 0xa2000
    s_mov_b32 s19, 0x00020000
    s_add_u32 s12, s10, 0x3800000
    s_addc_u32 s13, s11, 0
    s_mov_b32 s14, 0xb5000
    s_mov_b32 s15, 0x00020000
    s_cmp_ge_u32 s37, 36
    s_cbranch_scc1 sequential_preLN__sliding_block__glu_gated_bilinear__prompt_kernel_nb12
    s_lshl_b32 s38, s37, 4
    v_lshrrev_b32 v4, 2, v2
    v_add_u32 v4, s38, v4
    v_lshrrev_b32 v6, 4, v4
    v_mul_u32_u24 v5, 18, v6
    v_bfe_u32 v6, v4, 2, 1
    v_lshl_add_u32 v5, v6, 3, v5
    v_bfe_u32 v6, v4, 3, 1
    v_lshl_add_u32 v5, v6, 2, v5
    v_and_b32 v6, 3, v4
    v_add_u32 v5, v5, v6
    v_subrev_u32 v6, 512, v4
    v_lshrrev_b32 v6, 1, v6
    v_mul_u32_u24 v6, 18, v6
    v_and_b32 v7, 1, v4
    v_add3_u32 v6, v6, v7, 16
    v_cmp_lt_u32 vcc, 511, v4
    s_nop 1
    v_cndmask_b32 v5, v5, v6, vcc
    v_mul_u32_u24 v5, 1152, v5
    v_and_b32 v6, 3, v2
    v_lshl_add_u32 v5, v6, 4, v5
    buffer_load_dwordx4 v[64:67], v5, s[16:19], 0 offen offset:0
    buffer_load_dwordx4 v[68:71], v5, s[16:19], 0 offen offset:64
    buffer_load_dwordx4 v[72:75], v5, s[16:19], 0 offen offset:128
    buffer_load_dwordx4 v[76:79], v5, s[16:19], 0 offen offset:192
    buffer_load_dwordx4 v[80:83], v5, s[16:19], 0 offen offset:256
    buffer_load_dwordx4 v[84:87], v5, s[16:19], 0 offen offset:320
    buffer_load_dwordx4 v[88:91], v5, s[16:19], 0 offen offset:384
    buffer_load_dwordx4 v[92:95], v5, s[16:19], 0 offen offset:448
    buffer_load_dwordx4 v[96:99], v5, s[16:19], 0 offen offset:512
    buffer_load_dwordx4 v[100:103], v5, s[16:19], 0 offen offset:576
    buffer_load_dwordx4 v[104:107], v5, s[16:19], 0 offen offset:640
    buffer_load_dwordx4 v[108:111], v5, s[16:19], 0 offen offset:704
    buffer_load_dwordx4 v[112:115], v5, s[16:19], 0 offen offset:768
    buffer_load_dwordx4 v[116:119], v5, s[16:19], 0 offen offset:832
    buffer_load_dwordx4 v[120:123], v5, s[16:19], 0 offen offset:896
    buffer_load_dwordx4 v[124:127], v5, s[16:19], 0 offen offset:960
    buffer_load_dwordx4 v[128:131], v5, s[16:19], 0 offen offset:1024
    buffer_load_dwordx4 v[132:135], v5, s[16:19], 0 offen offset:1088
sequential_preLN__sliding_block__glu_gated_bilinear__prompt_kernel_nb12:
    buffer_store_dwordx4 v[12:15], v1, s[32:35], s59 offen offset:0 sc1
    buffer_store_dwordx4 v[12:15], v1, s[32:35], s59 offen offset:1024 sc1
    buffer_store_dwordx4 v[12:15], v1, s[32:35], s59 offen offset:2048 sc1
    buffer_store_dwordx4 v[12:15], v1, s[32:35], s59 offen offset:3072 sc1
    buffer_store_dwordx4 v[12:15], v1, s[32:35], s50 offen sc1
    s_mov_b32 s62, 0x510000
    s_mov_b32 s63, 0x00020000
    s_mov_b32 s66, 0x510000
    s_mov_b32 s67, 0x00020000
    s_and_b32 s46, s36, 1
    s_lshl_b32 s46, s46, 1
    s_lshr_b32 s47, s36, 1
    s_or_b32 s46, s46, s47
    s_lshl_b32 s76, s46, 10
    s_mul_i32 s77, s36, 73728
    s_and_b32 s46, s2, 7
    s_mul_i32 s46, s46, 1152
    s_add_u32 s77, s77, s46
    s_bfe_u32 s46, s2, 0x20003
    s_lshl_b32 s46, s46, 8
    s_add_u32 s77, s77, s46
    v_bfe_u32 v24, v2, 2, 3
    v_bfe_u32 v25, v2, 4, 1
    v_lshlrev_b32 v25, 1, v25
    v_and_b32 v26, 3, v2
    v_xor_b32 v25, v25, v26
    v_lshlrev_b32 v25, 4, v25
    v_lshrrev_b32 v26, 5, v2
    v_lshl_add_u32 v25, v26, 6, v25
    v_mul_u32_u24 v16, 9216, v24
    v_add_u32 v16, v16, v25
    s_mov_b32 s70, 0x510000
    s_mov_b32 s71, 0x00020000
    s_mov_b32 s82, 0x510000
    s_mov_b32 s83, 0x00020000
    s_bitcmp1_b32 s36, 0
    s_cselect_b32 s80, s64, s60
    s_cselect_b32 s81, s65, s61
    s_lshr_b32 s46, s2, 3
    s_lshl_b32 s46, s46, 2
    s_add_u32 s46, s46, s36
    s_and_b32 s57, s2, 7
    s_mul_i32 s57, s57, 1152
    s_mul_i32 s58, s57, 576
    s_mul_i32 s47, s46, 36
    v_add_u32 v24, s47, v2
    v_lshrrev_b32 v25, 3, v24
    v_lshlrev_b32 v24, 7, v24
    v_lshl_add_u32 v9, v25, 7, v24
    s_lshr_b32 s46, s46, 1
    s_and_b32 s47, s46, 31
    v_lshrrev_b32 v24, 2, v2
    v_mul_u32_u24 v24, 9216, v24
    v_and_b32 v25, 3, v2
    v_lshl_add_u32 v24, v25, 8, v24
    v_add_u32 v24, 128, v24
    v_lshrrev_b32 v25, 3, v2
    v_mul_u32_u24 v25, 9216, v25
    v_and_b32 v26, 7, v2
    v_lshl_add_u32 v25, v26, 7, v25
    s_mul_i32 s48, s47, 110592
    s_mul_i32 s49, s47, 55296
    s_add_u32 s49, s49, 3538944
    s_cmp_lt_u32 s46, 32
    s_cselect_b32 s48, s48, s49
    s_cselect_b64 vcc, -1, 0
    v_cndmask_b32 v8, v25, v24, vcc
    s_add_u32 s57, s57, s48
    s_mul_i32 s56, s46, 55296
    s_and_b32 s47, s2, 7
    s_mul_i32 s47, s47, 1152
    s_add_u32 s56, s56, s47
    v_subrev_u32 v11, 128, v24
    s_mov_b64 exec, 0xffffff
    buffer_load_dword v17, v11, s[80:83], s56 offen
    s_mov_b64 exec, -1
    s_cmp_ge_u32 s37, 36
    s_cbranch_scc1 sequential_preLN__sliding_block__glu_gated_bilinear__prompt_kernel_nb13
    s_mov_b32 s38, 0x3f803f80
    v_mov_b32 v28, 0
    v_mov_b32 v29, 0
    v_mov_b32 v30, 0
    v_mov_b32 v31, 0
    s_waitcnt vmcnt(23)
    v_dot2c_f32_bf16 v28, s38, v64
    v_dot2c_f32_bf16 v29, s38, v65
    v_dot2c_f32_bf16 v30, s38, v66
    v_dot2c_f32_bf16 v31, s38, v67
    s_waitcnt vmcnt(22)
    v_dot2c_f32_bf16 v28, s38, v68
    v_dot2c_f32_bf16 v29, s38, v69
    v_dot2c_f32_bf16 v30, s38, v70
    v_dot2c_f32_bf16 v31, s38, v71
    s_waitcnt vmcnt(21)
    v_dot2c_f32_bf16 v28, s38, v72
    v_dot2c_f32_bf16 v29, s38, v73
    v_dot2c_f32_bf16 v30, s38, v74
    v_dot2c_f32_bf16 v31, s38, v75
    s_waitcnt vmcnt(20)
    v_dot2c_f32_bf16 v28, s38, v76
    v_dot2c_f32_bf16 v29, s38, v77
    v_dot2c_f32_bf16 v30, s38, v78
    v_dot2c_f32_bf16 v31, s38, v79
    s_waitcnt vmcnt(19)
    v_dot2c_f32_bf16 v28, s38, v80
    v_dot2c_f32_bf16 v29, s38, v81
    v_dot2c_f32_bf16 v30, s38, v82
    v_dot2c_f32_bf16 v31, s38, v83
    s_waitcnt vmcnt(18)
    v_dot2c_f32_bf16 v28, s38, v84
    v_dot2c_f32_bf16 v29, s38, v85
    v_dot2c_f32_bf16 v30, s38, v86
    v_dot2c_f32_bf16 v31, s38, v87
    s_waitcnt vmcnt(17)
    v_dot2c_f32_bf16 v28, s38, v88
    v_dot2c_f32_bf16 v29, s38, v89
    v_dot2c_f32_bf16 v30, s38, v90
    v_dot2c_f32_bf16 v31, s38, v91
    s_waitcnt vmcnt(16)
    v_dot2c_f32_bf16 v28, s38, v92
    v_dot2c_f32_bf16 v29, s38, v93
    v_dot2c_f32_bf16 v30, s38, v94
    v_dot2c_f32_bf16 v31, s38, v95
    s_waitcnt vmcnt(15)
    v_dot2c_f32_bf16 v28, s38, v96
    v_dot2c_f32_bf16 v29, s38, v97
    v_dot2c_f32_bf16 v30, s38, v98
    v_dot2c_f32_bf16 v31, s38, v99
    s_waitcnt vmcnt(14)
    v_dot2c_f32_bf16 v28, s38, v100
    v_dot2c_f32_bf16 v29, s38, v101
    v_dot2c_f32_bf16 v30, s38, v102
    v_dot2c_f32_bf16 v31, s38, v103
    s_waitcnt vmcnt(13)
    v_dot2c_f32_bf16 v28, s38, v104
    v_dot2c_f32_bf16 v29, s38, v105
    v_dot2c_f32_bf16 v30, s38, v106
    v_dot2c_f32_bf16 v31, s38, v107
    s_waitcnt vmcnt(12)
    v_dot2c_f32_bf16 v28, s38, v108
    v_dot2c_f32_bf16 v29, s38, v109
    v_dot2c_f32_bf16 v30, s38, v110
    v_dot2c_f32_bf16 v31, s38, v111
    s_waitcnt vmcnt(11)
    v_dot2c_f32_bf16 v28, s38, v112
    v_dot2c_f32_bf16 v29, s38, v113
    v_dot2c_f32_bf16 v30, s38, v114
    v_dot2c_f32_bf16 v31, s38, v115
    s_waitcnt vmcnt(10)
    v_dot2c_f32_bf16 v28, s38, v116
    v_dot2c_f32_bf16 v29, s38, v117
    v_dot2c_f32_bf16 v30, s38, v118
    v_dot2c_f32_bf16 v31, s38, v119
    s_waitcnt vmcnt(9)
    v_dot2c_f32_bf16 v28, s38, v120
    v_dot2c_f32_bf16 v29, s38, v121
    v_dot2c_f32_bf16 v30, s38, v122
    v_dot2c_f32_bf16 v31, s38, v123
    s_waitcnt vmcnt(8)
    v_dot2c_f32_bf16 v28, s38, v124
    v_dot2c_f32_bf16 v29, s38, v125
    v_dot2c_f32_bf16 v30, s38, v126
    v_dot2c_f32_bf16 v31, s38, v127
    s_waitcnt vmcnt(7)
    v_dot2c_f32_bf16 v28, s38, v128
    v_dot2c_f32_bf16 v29, s38, v129
    v_dot2c_f32_bf16 v30, s38, v130
    v_dot2c_f32_bf16 v31, s38, v131
    s_waitcnt vmcnt(6)
    v_dot2c_f32_bf16 v28, s38, v132
    v_dot2c_f32_bf16 v29, s38, v133
    v_dot2c_f32_bf16 v30, s38, v134
    v_dot2c_f32_bf16 v31, s38, v135
    s_nop 0
    v_add_f32 v28, v28, v29
    s_nop 0
    v_add_f32 v30, v30, v31
    v_add_f32 v28, v28, v30
    s_nop 1
    v_add_f32_dpp v28, v28, v28 quad_perm:[1,0,3,2] row_mask:0xf bank_mask:0xf
    s_nop 1
    v_add_f32_dpp v28, v28, v28 quad_perm:[2,3,0,1] row_mask:0xf bank_mask:0xf
    v_mul_f32 v28, 0x3ae38e39, v28
    v_cvt_pk_bf16_f32 v28, v28, v28
    v_and_b32 v6, 3, v2
    v_mul_u32_u24 v6, 37888, v6
    v_lshrrev_b32 v7, 5, v2
    v_lshl_add_u32 v6, v7, 9, v6
    v_bfe_u32 v7, v2, 2, 3
    v_lshl_add_u32 v6, v7, 1, v6
    s_lshl_b32 s38, s37, 10
    s_add_u32 s38, s38, 589824
    buffer_store_short v28, v6, s[12:15], s38 offen offset:256 sc1
    buffer_load_dword v20, v21, s[72:75], 0 offen sc1
sequential_preLN__sliding_block__glu_gated_bilinear__prompt_kernel_nb13:
    s_waitcnt vmcnt(0)
    s_cmp_lg_u32 s36, 0
    s_cbranch_scc1 sequential_preLN__sliding_block__glu_gated_bilinear__prompt_kernel_z014
    s_mov_b32 s46, 4096
sequential_preLN__sliding_block__glu_gated_bilinear__prompt_kernel_z0l15:
    v_cmp_eq_u32 vcc, 0, v20
    s_cbranch_vccz sequential_preLN__sliding_block__glu_gated_bilinear__prompt_kernel_z014
    s_sleep 2
    buffer_load_dword v20, v21, s[72:75], 0 offen sc1
    s_waitcnt vmcnt(0)
    s_sub_u32 s46, s46, 1
    s_cbranch_scc0 sequential_preLN__sliding_block__glu_gated_bilinear__prompt_kernel_z0l15
sequential_preLN__sliding_block__glu_gated_bilinear__prompt_kernel_z014:
    s_barrier
    s_cmp_lg_u32 s36, 0
    s_cbranch_scc1 sequential_preLN__sliding_block__glu_gated_bilinear__prompt_kernel_fd16
    s_lshr_b32 s46, s2, 3
    s_mul_i32 s46, s46, 128
    s_and_b32 s47, s2, 7
    s_lshl_b32 s47, s47, 2
    s_add_u32 s46, s46, s47
    s_add_u32 s46, s46, 0xd00040
    v_mov_b32 v20, 1
    s_mov_b64 exec, 1
    buffer_store_dword v20, off, s[32:35], s46 sc1
    s_mov_b64 exec, -1
sequential_preLN__sliding_block__glu_gated_bilinear__prompt_kernel_fd16:
    s_mov_b64 exec, 0
    s_waitcnt lgkmcnt(0)
    s_call_b64 s[98:99], pfd_6
    s_branch pfc_6
pfd_6:
    s_cmp_eq_u32 s36, 0
    s_cbranch_scc1 pg_en
    s_cmp_eq_u32 s36, 1
    s_cbranch_scc1 pg_7
    s_cmp_eq_u32 s36, 2
    s_cbranch_scc1 pg_8
    s_branch pg_9
pfc_6:
    s_mov_b64 exec, -1
    s_mov_b64 exec, 0
    s_waitcnt lgkmcnt(0)
    s_call_b64 s[98:99], pfd_7
    s_branch pfc_7
pfd_7:
    s_cmp_eq_u32 s36, 0
    s_cbranch_scc1 pg_a
    s_cmp_eq_u32 s36, 1
    s_cbranch_scc1 pg_b
    s_cmp_eq_u32 s36, 2
    s_cbranch_scc1 pg_c
    s_branch pg_d
pfc_7:
    s_mov_b64 exec, -1
    s_mov_b64 exec, 0
    s_waitcnt lgkmcnt(0)
    s_call_b64 s[98:99], pfd_8
    s_branch pfc_8
pfd_8:
    s_cmp_eq_u32 s36, 0
    s_cbranch_scc1 pg_e
    s_cmp_eq_u32 s36, 1
    s_cbranch_scc1 pf_ret
    s_cmp_eq_u32 s36, 2
    s_cbranch_scc1 pf_ret
    s_branch pf_ret
pfc_8:
    s_mov_b64 exec, -1
    s_barrier
    s_add_u32 s46, s77, 0
    s_add_u32 m0, s76, 0
    s_nop 0
    buffer_load_dwordx4 v16, s[60:63], s46 offen lds
    s_add_u32 s46, s77, 0
    s_add_u32 m0, s76, 8192
    s_nop 0
    buffer_load_dwordx4 v16, s[64:67], s46 offen lds
    s_add_u32 s46, s77, 294912
    s_add_u32 m0, s76, 4096
    s_nop 0
    buffer_load_dwordx4 v16, s[60:63], s46 offen lds
    s_add_u32 s46, s77, 294912
    s_add_u32 m0, s76, 12288
    s_nop 0
    buffer_load_dwordx4 v16, s[64:67], s46 offen lds
    s_add_u32 s46, s77, 589824
    s_add_u32 m0, s76, 16384
    s_nop 0
    buffer_load_dwordx4 v16, s[60:63], s46 offen lds
    s_add_u32 s46, s77, 589824
    s_add_u32 m0, s76, 24576
    s_nop 0
    buffer_load_dwordx4 v16, s[64:67], s46 offen lds
    s_add_u32 s46, s77, 884736
    s_add_u32 m0, s76, 20480
    s_nop 0
    buffer_load_dwordx4 v16, s[60:63], s46 offen lds
    s_add_u32 s46, s77, 884736
    s_add_u32 m0, s76, 28672
    s_nop 0
    buffer_load_dwordx4 v16, s[64:67], s46 offen lds
    s_add_u32 s46, s77, 1179648
    s_add_u32 m0, s76, 32768
    s_nop 0
    buffer_load_dwordx4 v16, s[60:63], s46 offen lds
    s_add_u32 s46, s77, 1179648
    s_add_u32 m0, s76, 40960
    s_nop 0
    buffer_load_dwordx4 v16, s[64:67], s46 offen lds
    s_add_u32 s46, s77, 1474560
    s_add_u32 m0, s76, 36864
    s_nop 0
    buffer_load_dwordx4 v16, s[60:63], s46 offen lds
    s_add_u32 s46, s77, 1474560
    s_add_u32 m0, s76, 45056
    s_nop 0
    buffer_load_dwordx4 v16, s[64:67], s46 offen lds
    s_add_u32 s46, s77, 1769472
    s_add_u32 m0, s76, 49152
    s_nop 0
    buffer_load_dwordx4 v16, s[60:63], s46 offen lds
    s_add_u32 s46, s77, 1769472
    s_add_u32 m0, s76, 57344
    s_nop 0
    buffer_load_dwordx4 v16, s[64:67], s46 offen lds
    s_add_u32 s46, s77, 2064384
    s_add_u32 m0, s76, 53248
    s_nop 0
    buffer_load_dwordx4 v16, s[60:63], s46 offen lds
    s_add_u32 s46, s77, 2064384
    s_add_u32 m0, s76, 61440
    s_nop 0
    buffer_load_dwordx4 v16, s[64:67], s46 offen lds
    s_add_u32 s46, s77, 2359296
    s_add_u32 m0, s76, 65536
    s_nop 0
    buffer_load_dwordx4 v16, s[60:63], s46 offen lds
    s_add_u32 s46, s77, 2359296
    s_add_u32 m0, s76, 73728
    s_nop 0
    buffer_load_dwordx4 v16, s[64:67], s46 offen lds
    s_add_u32 s46, s77, 2654208
    s_add_u32 m0, s76, 69632
    s_nop 0
    buffer_load_dwordx4 v16, s[60:63], s46 offen lds
    s_add_u32 s46, s77, 2654208
    s_add_u32 m0, s76, 77824
    s_nop 0
    buffer_load_dwordx4 v16, s[64:67], s46 offen lds
    s_add_u32 s46, s77, 2949120
    s_add_u32 m0, s76, 81920
    s_nop 0
    buffer_load_dwordx4 v16, s[60:63], s46 offen lds
    s_add_u32 s46, s77, 2949120
    s_add_u32 m0, s76, 90112
    s_nop 0
    buffer_load_dwordx4 v16, s[64:67], s46 offen lds
    s_add_u32 s46, s77, 3244032
    s_add_u32 m0, s76, 86016
    s_nop 0
    buffer_load_dwordx4 v16, s[60:63], s46 offen lds
    s_add_u32 s46, s77, 3244032
    s_add_u32 m0, s76, 94208
    s_nop 0
    buffer_load_dwordx4 v16, s[64:67], s46 offen lds
    s_add_u32 s36, s36, 4
    s_branch sequential_preLN__sliding_block__glu_gated_bilinear__prompt_kernel_entry
sequential_preLN__sliding_block__glu_gated_bilinear__prompt_kernel_hl11:
    s_load_dwordx2 s[62:63], s[0:1], 16
    s_load_dwordx4 s[40:43], s[0:1], 32
    s_load_dwordx2 s[44:45], s[0:1], 48
    s_sub_u32 s37, s2, 224
    s_lshl_b32 s37, s37, 2
    s_add_u32 s37, s37, s36
    v_lshlrev_b32 v3, 4, v2
    s_waitcnt lgkmcnt(0)
    s_mov_b32 s16, s62
    s_mov_b32 s17, s63
    s_mov_b32 s18, 0xa2000
    s_mov_b32 s19, 0x00020000
    s_add_u32 s12, s10, 0x3800000
    s_addc_u32 s13, s11, 0
    s_mov_b32 s14, 0xb5000
    s_mov_b32 s15, 0x00020000
    s_add_u32 s20, s10, 0x3000000
    s_addc_u32 s21, s11, 0
    s_mov_b32 s22, 0x1b0000
    s_mov_b32 s23, 0x00020000
    v_lshrrev_b32 v11, 5, v2
    v_lshlrev_b32 v11, 3, v11
    s_add_u32 s38, s37, 0
    s_mul_i32 s39, s38, 1821
    s_lshr_b32 s39, s39, 16
    s_mul_i32 s46, s39, 36
    s_sub_u32 s46, s38, s46
    s_mul_i32 s50, s46, 57
    s_lshr_b32 s50, s50, 5
    s_and_b32 s50, s50, 16
    s_lshl_b32 s39, s39, 6
    s_mov_b32 s48, 31
    s_lshl_b32 s46, s46, 4
    v_add_u32 v4, s46, v11
    v_lshrrev_b32 v6, 4, v4
    v_mul_u32_u24 v5, 18, v6
    v_bfe_u32 v6, v4, 2, 1
    v_lshl_add_u32 v5, v6, 3, v5
    v_bfe_u32 v6, v4, 3, 1
    v_lshl_add_u32 v5, v6, 2, v5
    v_and_b32 v6, 3, v4
    v_add_u32 v5, v5, v6
    v_subrev_u32 v6, 512, v4
    v_lshrrev_b32 v6, 1, v6
    v_mul_u32_u24 v6, 18, v6
    v_and_b32 v7, 1, v4
    v_add3_u32 v6, v6, v7, 16
    v_cmp_lt_u32 vcc, 511, v4
    s_nop 1
    v_cndmask_b32 v5, v5, v6, vcc
    v_and_b32 v6, s48, v2
    v_xor_b32 v6, s50, v6
    v_lshlrev_b32 v6, 1, v6
    v_mul_u32_u24 v5, 1152, v5
    v_add_u32 v5, v5, v6
    v_mov_b32 v6, 2304
    v_mov_b32 v7, 20736
    v_cndmask_b32 v6, v6, v7, vcc
    v_add_u32 v8, v5, v6
    v_mov_b32 v6, 9216
    v_mov_b32 v7, 41472
    v_cndmask_b32 v6, v6, v7, vcc
    v_add_u32 v9, v5, v6
    v_mov_b32 v6, 11520
    v_mov_b32 v7, 62208
    v_cndmask_b32 v6, v6, v7, vcc
    v_add_u32 v10, v5, v6
    buffer_load_ushort v16, v5, s[16:19], s39 offen
    buffer_load_ushort v17, v5, s[16:19], s39 offen offset:1152
    buffer_load_ushort v18, v8, s[16:19], s39 offen
    buffer_load_ushort v19, v8, s[16:19], s39 offen offset:1152
    buffer_load_ushort v20, v9, s[16:19], s39 offen
    buffer_load_ushort v21, v9, s[16:19], s39 offen offset:1152
    buffer_load_ushort v22, v10, s[16:19], s39 offen
    buffer_load_ushort v23, v10, s[16:19], s39 offen offset:1152
    s_add_u32 s38, s37, 128
    s_mul_i32 s39, s38, 1821
    s_lshr_b32 s39, s39, 16
    s_mul_i32 s46, s39, 36
    s_sub_u32 s46, s38, s46
    s_mul_i32 s50, s46, 57
    s_lshr_b32 s50, s50, 5
    s_and_b32 s50, s50, 16
    s_lshl_b32 s39, s39, 6
    s_mov_b32 s48, 31
    s_lshl_b32 s46, s46, 4
    v_add_u32 v4, s46, v11
    v_lshrrev_b32 v6, 4, v4
    v_mul_u32_u24 v5, 18, v6
    v_bfe_u32 v6, v4, 2, 1
    v_lshl_add_u32 v5, v6, 3, v5
    v_bfe_u32 v6, v4, 3, 1
    v_lshl_add_u32 v5, v6, 2, v5
    v_and_b32 v6, 3, v4
    v_add_u32 v5, v5, v6
    v_subrev_u32 v6, 512, v4
    v_lshrrev_b32 v6, 1, v6
    v_mul_u32_u24 v6, 18, v6
    v_and_b32 v7, 1, v4
    v_add3_u32 v6, v6, v7, 16
    v_cmp_lt_u32 vcc, 511, v4
    s_nop 1
    v_cndmask_b32 v5, v5, v6, vcc
    v_and_b32 v6, s48, v2
    v_xor_b32 v6, s50, v6
    v_lshlrev_b32 v6, 1, v6
    v_mul_u32_u24 v5, 1152, v5
    v_add_u32 v5, v5, v6
    v_mov_b32 v6, 2304
    v_mov_b32 v7, 20736
    v_cndmask_b32 v6, v6, v7, vcc
    v_add_u32 v8, v5, v6
    v_mov_b32 v6, 9216
    v_mov_b32 v7, 41472
    v_cndmask_b32 v6, v6, v7, vcc
    v_add_u32 v9, v5, v6
    v_mov_b32 v6, 11520
    v_mov_b32 v7, 62208
    v_cndmask_b32 v6, v6, v7, vcc
    v_add_u32 v10, v5, v6
    buffer_load_ushort v24, v5, s[16:19], s39 offen
    buffer_load_ushort v25, v5, s[16:19], s39 offen offset:1152
    buffer_load_ushort v26, v8, s[16:19], s39 offen
    buffer_load_ushort v27, v8, s[16:19], s39 offen offset:1152
    buffer_load_ushort v28, v9, s[16:19], s39 offen
    buffer_load_ushort v29, v9, s[16:19], s39 offen offset:1152
    buffer_load_ushort v30, v10, s[16:19], s39 offen
    buffer_load_ushort v31, v10, s[16:19], s39 offen offset:1152
    s_add_u32 s38, s37, 256
    s_mul_i32 s39, s38, 1821
    s_lshr_b32 s39, s39, 16
    s_mul_i32 s46, s39, 36
    s_sub_u32 s46, s38, s46
    s_mul_i32 s50, s46, 57
    s_lshr_b32 s50, s50, 5
    s_and_b32 s50, s50, 16
    s_lshl_b32 s39, s39, 6
    s_mov_b32 s48, 31
    s_lshl_b32 s46, s46, 4
    v_add_u32 v4, s46, v11
    v_lshrrev_b32 v6, 4, v4
    v_mul_u32_u24 v5, 18, v6
    v_bfe_u32 v6, v4, 2, 1
    v_lshl_add_u32 v5, v6, 3, v5
    v_bfe_u32 v6, v4, 3, 1
    v_lshl_add_u32 v5, v6, 2, v5
    v_and_b32 v6, 3, v4
    v_add_u32 v5, v5, v6
    v_subrev_u32 v6, 512, v4
    v_lshrrev_b32 v6, 1, v6
    v_mul_u32_u24 v6, 18, v6
    v_and_b32 v7, 1, v4
    v_add3_u32 v6, v6, v7, 16
    v_cmp_lt_u32 vcc, 511, v4
    s_nop 1
    v_cndmask_b32 v5, v5, v6, vcc
    v_and_b32 v6, s48, v2
    v_xor_b32 v6, s50, v6
    v_lshlrev_b32 v6, 1, v6
    v_mul_u32_u24 v5, 1152, v5
    v_add_u32 v5, v5, v6
    v_mov_b32 v6, 2304
    v_mov_b32 v7, 20736
    v_cndmask_b32 v6, v6, v7, vcc
    v_add_u32 v8, v5, v6
    v_mov_b32 v6, 9216
    v_mov_b32 v7, 41472
    v_cndmask_b32 v6, v6, v7, vcc
    v_add_u32 v9, v5, v6
    v_mov_b32 v6, 11520
    v_mov_b32 v7, 62208
    v_cndmask_b32 v6, v6, v7, vcc
    v_add_u32 v10, v5, v6
    buffer_load_ushort v32, v5, s[16:19], s39 offen
    buffer_load_ushort v33, v5, s[16:19], s39 offen offset:1152
    buffer_load_ushort v34, v8, s[16:19], s39 offen
    buffer_load_ushort v35, v8, s[16:19], s39 offen offset:1152
    buffer_load_ushort v36, v9, s[16:19], s39 offen
    buffer_load_ushort v37, v9, s[16:19], s39 offen offset:1152
    buffer_load_ushort v38, v10, s[16:19], s39 offen
    buffer_load_ushort v39, v10, s[16:19], s39 offen offset:1152
    s_add_u32 s38, s37, 384
    s_mul_i32 s39, s38, 1821
    s_lshr_b32 s39, s39, 16
    s_mul_i32 s46, s39, 36
    s_sub_u32 s46, s38, s46
    s_mul_i32 s50, s46, 57
    s_lshr_b32 s50, s50, 5
    s_and_b32 s50, s50, 16
    s_lshl_b32 s39, s39, 6
    s_mov_b32 s48, 31
    s_lshl_b32 s46, s46, 4
    v_add_u32 v4, s46, v11
    v_lshrrev_b32 v6, 4, v4
    v_mul_u32_u24 v5, 18, v6
    v_bfe_u32 v6, v4, 2, 1
    v_lshl_add_u32 v5, v6, 3, v5
    v_bfe_u32 v6, v4, 3, 1
    v_lshl_add_u32 v5, v6, 2, v5
    v_and_b32 v6, 3, v4
    v_add_u32 v5, v5, v6
    v_subrev_u32 v6, 512, v4
    v_lshrrev_b32 v6, 1, v6
    v_mul_u32_u24 v6, 18, v6
    v_and_b32 v7, 1, v4
    v_add3_u32 v6, v6, v7, 16
    v_cmp_lt_u32 vcc, 511, v4
    s_nop 1
    v_cndmask_b32 v5, v5, v6, vcc
    v_and_b32 v6, s48, v2
    v_xor_b32 v6, s50, v6
    v_lshlrev_b32 v6, 1, v6
    v_mul_u32_u24 v5, 1152, v5
    v_add_u32 v5, v5, v6
    v_mov_b32 v6, 2304
    v_mov_b32 v7, 20736
    v_cndmask_b32 v6, v6, v7, vcc
    v_add_u32 v8, v5, v6
    v_mov_b32 v6, 9216
    v_mov_b32 v7, 41472
    v_cndmask_b32 v6, v6, v7, vcc
    v_add_u32 v9, v5, v6
    v_mov_b32 v6, 11520
    v_mov_b32 v7, 62208
    v_cndmask_b32 v6, v6, v7, vcc
    v_add_u32 v10, v5, v6
    buffer_load_ushort v40, v5, s[16:19], s39 offen
    buffer_load_ushort v41, v5, s[16:19], s39 offen offset:1152
    buffer_load_ushort v42, v8, s[16:19], s39 offen
    buffer_load_ushort v43, v8, s[16:19], s39 offen offset:1152
    buffer_load_ushort v44, v9, s[16:19], s39 offen
    buffer_load_ushort v45, v9, s[16:19], s39 offen offset:1152
    buffer_load_ushort v46, v10, s[16:19], s39 offen
    buffer_load_ushort v47, v10, s[16:19], s39 offen offset:1152
    s_add_u32 s38, s37, 512
    s_mul_i32 s39, s38, 1821
    s_lshr_b32 s39, s39, 16
    s_mul_i32 s46, s39, 36
    s_sub_u32 s46, s38, s46
    s_mul_i32 s50, s46, 57
    s_lshr_b32 s50, s50, 5
    s_and_b32 s50, s50, 16
    s_lshl_b32 s39, s39, 6
    s_sub_u32 s47, s38, 576
    s_mul_i32 s48, s47, 1772
    s_lshr_b32 s48, s48, 16
    s_mul_i32 s49, s48, 37
    s_sub_u32 s49, s47, s49
    s_lshl_b32 s48, s48, 5
    s_add_u32 s48, s48, 1024
    s_cmp_eq_u32 s49, 36
    s_cselect_b32 s48, 0x10000000, s48
    s_cselect_b32 s49, 0, s49
    s_cselect_b32 s58, -1, 0xffff
    s_cmp_lt_u32 s38, 576
    s_cselect_b32 s46, s46, s49
    s_cselect_b32 s39, s39, s48
    s_cselect_b32 s48, 31, 15
    s_cselect_b32 s50, s50, 0
    s_cselect_b32 s58, -1, s58
    s_cmp_lt_u32 s38, 724
    s_cselect_b32 s46, s46, 0
    s_cselect_b32 s39, s39, 0
    s_lshl_b32 s46, s46, 4
    v_add_u32 v4, s46, v11
    v_lshrrev_b32 v6, 4, v4
    v_mul_u32_u24 v5, 18, v6
    v_bfe_u32 v6, v4, 2, 1
    v_lshl_add_u32 v5, v6, 3, v5
    v_bfe_u32 v6, v4, 3, 1
    v_lshl_add_u32 v5, v6, 2, v5
    v_and_b32 v6, 3, v4
    v_add_u32 v5, v5, v6
    v_subrev_u32 v6, 512, v4
    v_lshrrev_b32 v6, 1, v6
    v_mul_u32_u24 v6, 18, v6
    v_and_b32 v7, 1, v4
    v_add3_u32 v6, v6, v7, 16
    v_cmp_lt_u32 vcc, 511, v4
    s_nop 1
    v_cndmask_b32 v5, v5, v6, vcc
    v_and_b32 v6, s48, v2
    v_xor_b32 v6, s50, v6
    v_lshlrev_b32 v6, 1, v6
    v_mul_u32_u24 v5, 1152, v5
    v_add_u32 v5, v5, v6
    v_mov_b32 v6, 2304
    v_mov_b32 v7, 20736
    v_cndmask_b32 v6, v6, v7, vcc
    v_add_u32 v8, v5, v6
    v_mov_b32 v6, 9216
    v_mov_b32 v7, 41472
    v_cndmask_b32 v6, v6, v7, vcc
    v_add_u32 v9, v5, v6
    v_mov_b32 v6, 11520
    v_mov_b32 v7, 62208
    v_cndmask_b32 v6, v6, v7, vcc
    v_add_u32 v10, v5, v6
    buffer_load_ushort v48, v5, s[16:19], s39 offen
    buffer_load_ushort v49, v5, s[16:19], s39 offen offset:1152
    buffer_load_ushort v50, v8, s[16:19], s39 offen
    buffer_load_ushort v51, v8, s[16:19], s39 offen offset:1152
    buffer_load_ushort v52, v9, s[16:19], s39 offen
    buffer_load_ushort v53, v9, s[16:19], s39 offen offset:1152
    buffer_load_ushort v54, v10, s[16:19], s39 offen
    buffer_load_ushort v55, v10, s[16:19], s39 offen offset:1152
    s_add_u32 s38, s37, 640
    s_mul_i32 s39, s38, 1821
    s_lshr_b32 s39, s39, 16
    s_mul_i32 s46, s39, 36
    s_sub_u32 s46, s38, s46
    s_mul_i32 s50, s46, 57
    s_lshr_b32 s50, s50, 5
    s_and_b32 s50, s50, 16
    s_lshl_b32 s39, s39, 6
    s_sub_u32 s47, s38, 576
    s_mul_i32 s48, s47, 1772
    s_lshr_b32 s48, s48, 16
    s_mul_i32 s49, s48, 37
    s_sub_u32 s49, s47, s49
    s_lshl_b32 s48, s48, 5
    s_add_u32 s48, s48, 1024
    s_cmp_eq_u32 s49, 36
    s_cselect_b32 s48, 0x10000000, s48
    s_cselect_b32 s49, 0, s49
    s_cselect_b32 s59, -1, 0xffff
    s_cmp_lt_u32 s38, 576
    s_cselect_b32 s46, s46, s49
    s_cselect_b32 s39, s39, s48
    s_cselect_b32 s48, 31, 15
    s_cselect_b32 s50, s50, 0
    s_cselect_b32 s59, -1, s59
    s_cmp_lt_u32 s38, 724
    s_cselect_b32 s46, s46, 0
    s_cselect_b32 s39, s39, 0
    s_lshl_b32 s46, s46, 4
    v_add_u32 v4, s46, v11
    v_lshrrev_b32 v6, 4, v4
    v_mul_u32_u24 v5, 18, v6
    v_bfe_u32 v6, v4, 2, 1
    v_lshl_add_u32 v5, v6, 3, v5
    v_bfe_u32 v6, v4, 3, 1
    v_lshl_add_u32 v5, v6, 2, v5
    v_and_b32 v6, 3, v4
    v_add_u32 v5, v5, v6
    v_subrev_u32 v6, 512, v4
    v_lshrrev_b32 v6, 1, v6
    v_mul_u32_u24 v6, 18, v6
    v_and_b32 v7, 1, v4
    v_add3_u32 v6, v6, v7, 16
    v_cmp_lt_u32 vcc, 511, v4
    s_nop 1
    v_cndmask_b32 v5, v5, v6, vcc
    v_and_b32 v6, s48, v2
    v_xor_b32 v6, s50, v6
    v_lshlrev_b32 v6, 1, v6
    v_mul_u32_u24 v5, 1152, v5
    v_add_u32 v5, v5, v6
    v_mov_b32 v6, 2304
    v_mov_b32 v7, 20736
    v_cndmask_b32 v6, v6, v7, vcc
    v_add_u32 v8, v5, v6
    v_mov_b32 v6, 9216
    v_mov_b32 v7, 41472
    v_cndmask_b32 v6, v6, v7, vcc
    v_add_u32 v9, v5, v6
    v_mov_b32 v6, 11520
    v_mov_b32 v7, 62208
    v_cndmask_b32 v6, v6, v7, vcc
    v_add_u32 v10, v5, v6
    buffer_load_ushort v56, v5, s[16:19], s39 offen
    buffer_load_ushort v57, v5, s[16:19], s39 offen offset:1152
    buffer_load_ushort v58, v8, s[16:19], s39 offen
    buffer_load_ushort v59, v8, s[16:19], s39 offen offset:1152
    buffer_load_ushort v60, v9, s[16:19], s39 offen
    buffer_load_ushort v61, v9, s[16:19], s39 offen offset:1152
    buffer_load_ushort v62, v10, s[16:19], s39 offen
    buffer_load_ushort v63, v10, s[16:19], s39 offen offset:1152
    s_mov_b32 s24, s40
    s_mov_b32 s25, s41
    s_mov_b32 s26, 0x510000
    s_mov_b32 s27, 0x00020000
    s_mov_b32 s28, s42
    s_mov_b32 s29, s43
    s_mov_b32 s30, 0x510000
    s_mov_b32 s31, 0x00020000
    s_mov_b32 s80, s44
    s_mov_b32 s81, s45
    s_mov_b32 s82, 0x510000
    s_mov_b32 s83, 0x00020000
    s_mov_b32 s84, s40
    s_mov_b32 s85, s41
    s_mov_b32 s86, 0x510000
    s_mov_b32 s87, 0x00020000
    s_lshr_b32 s38, s37, 3
    s_cmp_ge_u32 s38, 8
    s_cselect_b32 s84, s42, s40
    s_cselect_b32 s85, s43, s41
    v_lshrrev_b32 v4, 3, v2
    v_and_b32 v5, 7, v2
    v_lshlrev_b32 v5, 4, v5
    v_mul_u32_u24 v12, 9216, v4
    v_add_u32 v12, v12, v5
    v_mul_u32_u24 v14, 1152, v4
    v_add_u32 v14, v14, v5
    v_bfe_u32 v5, v2, 1, 2
    v_mul_u32_u24 v13, 55296, v5
    v_lshl_add_u32 v13, v4, 5, v13
    v_and_b32 v5, 1, v2
    v_lshl_add_u32 v13, v5, 4, v13
    s_add_u32 s39, s38, 0
    s_add_u32 s46, s37, 0
    s_and_b32 s46, s46, 7
    s_mul_i32 s47, s46, 221184
    s_lshl_b32 s48, s39, 8
    s_add_u32 s64, s47, s48
    s_mul_i32 s39, s39, 73728
    s_mul_i32 s46, s46, 1152
    s_add_u32 s46, s46, s39
    buffer_load_dwordx4 v[64:67], v12, s[24:27], s46 offen offset:1024
    s_add_u32 s39, s38, 16
    s_add_u32 s46, s37, 1
    s_and_b32 s46, s46, 7
    s_mul_i32 s47, s46, 221184
    s_lshl_b32 s48, s39, 8
    s_add_u32 s65, s47, s48
    s_mul_i32 s39, s39, 73728
    s_mul_i32 s46, s46, 1152
    s_add_u32 s46, s46, s39
    buffer_load_dwordx4 v[68:71], v12, s[24:27], s46 offen offset:1024
    s_add_u32 s39, s38, 32
    s_add_u32 s46, s37, 2
    s_and_b32 s46, s46, 7
    s_mul_i32 s47, s46, 221184
    s_lshl_b32 s48, s39, 8
    s_add_u32 s66, s47, s48
    s_mul_i32 s39, s39, 73728
    s_mul_i32 s46, s46, 1152
    s_add_u32 s46, s46, s39
    buffer_load_dwordx4 v[72:75], v12, s[24:27], s46 offen offset:1024
    s_add_u32 s39, s38, 48
    s_add_u32 s46, s37, 3
    s_and_b32 s46, s46, 7
    s_mul_i32 s47, s46, 221184
    s_lshl_b32 s48, s39, 8
    s_add_u32 s67, s47, s48
    s_mul_i32 s39, s39, 73728
    s_mul_i32 s46, s46, 1152
    s_add_u32 s46, s46, s39
    buffer_load_dwordx4 v[76:79], v12, s[24:27], s46 offen offset:1024
    s_add_u32 s39, s38, 64
    s_add_u32 s46, s37, 4
    s_and_b32 s46, s46, 7
    s_mul_i32 s47, s46, 221184
    s_lshl_b32 s48, s39, 8
    s_add_u32 s68, s47, s48
    s_cmp_ge_u32 s39, 72
    s_cselect_b32 s47, 72, 0
    s_sub_u32 s39, s39, s47
    s_mul_i32 s39, s39, 73728
    s_mul_i32 s46, s46, 1152
    s_add_u32 s46, s46, s39
    buffer_load_dwordx4 v[80:83], v12, s[84:87], s46 offen offset:1024
    s_add_u32 s39, s38, 80
    s_add_u32 s46, s37, 5
    s_and_b32 s46, s46, 7
    s_mul_i32 s47, s46, 221184
    s_lshl_b32 s48, s39, 8
    s_add_u32 s69, s47, s48
    s_sub_u32 s39, s39, 72
    s_mul_i32 s39, s39, 73728
    s_mul_i32 s46, s46, 1152
    s_add_u32 s46, s46, s39
    buffer_load_dwordx4 v[84:87], v12, s[28:31], s46 offen offset:1024
    s_add_u32 s39, s38, 96
    s_add_u32 s46, s37, 6
    s_and_b32 s46, s46, 7
    s_mul_i32 s47, s46, 221184
    s_lshl_b32 s48, s39, 8
    s_add_u32 s70, s47, s48
    s_sub_u32 s39, s39, 72
    s_mul_i32 s39, s39, 73728
    s_mul_i32 s46, s46, 1152
    s_add_u32 s46, s46, s39
    buffer_load_dwordx4 v[88:91], v12, s[28:31], s46 offen offset:1024
    s_add_u32 s39, s38, 112
    s_add_u32 s46, s37, 7
    s_and_b32 s46, s46, 7
    s_mul_i32 s47, s46, 221184
    s_lshl_b32 s48, s39, 8
    s_add_u32 s71, s47, s48
    s_sub_u32 s39, s39, 72
    s_mul_i32 s39, s39, 73728
    s_mul_i32 s46, s46, 1152
    s_add_u32 s46, s46, s39
    buffer_load_dwordx4 v[92:95], v12, s[28:31], s46 offen offset:1024
    s_add_u32 s39, s38, 128
    s_add_u32 s46, s37, 8
    s_and_b32 s46, s46, 7
    s_mul_i32 s47, s46, 221184
    s_lshl_b32 s48, s39, 8
    s_add_u32 s72, s47, s48
    s_sub_u32 s39, s39, 72
    s_mul_i32 s39, s39, 73728
    s_mul_i32 s46, s46, 1152
    s_add_u32 s46, s46, s39
    buffer_load_dwordx4 v[96:99], v12, s[28:31], s46 offen offset:1024
    s_add_u32 s39, s38, 144
    s_add_u32 s46, s37, 9
    s_and_b32 s46, s46, 7
    s_mul_i32 s47, s46, 221184
    s_lshl_b32 s48, s39, 8
    s_add_u32 s73, s47, s48
    s_sub_u32 s39, s39, 144
    s_mul_i32 s39, s39, 9216
    s_mul_i32 s46, s46, 663552
    s_add_u32 s46, s46, s39
    buffer_load_dwordx4 v[100:103], v14, s[80:83], s46 offen offset:1024
    s_add_u32 s39, s38, 160
    s_add_u32 s46, s37, 10
    s_and_b32 s46, s46, 7
    s_mul_i32 s47, s46, 221184
    s_lshl_b32 s48, s39, 8
    s_add_u32 s74, s47, s48
    s_sub_u32 s39, s39, 144
    s_mul_i32 s39, s39, 9216
    s_mul_i32 s46, s46, 663552
    s_add_u32 s46, s46, s39
    buffer_load_dwordx4 v[104:107], v14, s[80:83], s46 offen offset:1024
    s_add_u32 s39, s38, 176
    s_add_u32 s46, s37, 11
    s_and_b32 s46, s46, 7
    s_mul_i32 s47, s46, 221184
    s_lshl_b32 s48, s39, 8
    s_add_u32 s75, s47, s48
    s_sub_u32 s39, s39, 144
    s_mul_i32 s39, s39, 9216
    s_mul_i32 s46, s46, 663552
    s_add_u32 s46, s46, s39
    buffer_load_dwordx4 v[108:111], v14, s[80:83], s46 offen offset:1024
    s_add_u32 s39, s38, 192
    s_add_u32 s46, s37, 12
    s_and_b32 s46, s46, 7
    s_mul_i32 s47, s46, 221184
    s_lshl_b32 s48, s39, 8
    s_add_u32 s76, s47, s48
    s_sub_u32 s39, s39, 144
    s_mul_i32 s39, s39, 9216
    s_mul_i32 s46, s46, 663552
    s_add_u32 s46, s46, s39
    buffer_load_dwordx4 v[112:115], v14, s[80:83], s46 offen offset:1024
    s_add_u32 s39, s38, 208
    s_min_u32 s39, s39, 215
    s_add_u32 s46, s37, 13
    s_and_b32 s46, s46, 7
    s_mul_i32 s47, s46, 221184
    s_lshl_b32 s48, s39, 8
    s_add_u32 s77, s47, s48
    s_sub_u32 s39, s39, 144
    s_mul_i32 s39, s39, 9216
    s_mul_i32 s46, s46, 663552
    s_add_u32 s46, s46, s39
    buffer_load_dwordx4 v[116:119], v14, s[80:83], s46 offen offset:1024
    s_waitcnt vmcnt(54)
    v_lshl_or_b32 v16, v17, 16, v16
    v_lshl_or_b32 v17, v19, 16, v18
    v_lshl_or_b32 v18, v21, 16, v20
    v_lshl_or_b32 v19, v23, 16, v22
    s_add_u32 s38, s37, 0
    s_lshl_b32 s38, s38, 10
    buffer_store_dwordx4 v[16:19], v3, s[12:15], s38 offen sc1
    s_waitcnt vmcnt(47)
    v_lshl_or_b32 v24, v25, 16, v24
    v_lshl_or_b32 v25, v27, 16, v26
    v_lshl_or_b32 v26, v29, 16, v28
    v_lshl_or_b32 v27, v31, 16, v30
    s_add_u32 s38, s37, 128
    s_lshl_b32 s38, s38, 10
    buffer_store_dwordx4 v[24:27], v3, s[12:15], s38 offen sc1
    s_waitcnt vmcnt(40)
    v_lshl_or_b32 v32, v33, 16, v32
    v_lshl_or_b32 v33, v35, 16, v34
    v_lshl_or_b32 v34, v37, 16, v36
    v_lshl_or_b32 v35, v39, 16, v38
    s_add_u32 s38, s37, 256
    s_lshl_b32 s38, s38, 10
    buffer_store_dwordx4 v[32:35], v3, s[12:15], s38 offen sc1
    s_waitcnt vmcnt(33)
    v_lshl_or_b32 v40, v41, 16, v40
    v_lshl_or_b32 v41, v43, 16, v42
    v_lshl_or_b32 v42, v45, 16, v44
    v_lshl_or_b32 v43, v47, 16, v46
    s_add_u32 s38, s37, 384
    s_lshl_b32 s38, s38, 10
    buffer_store_dwordx4 v[40:43], v3, s[12:15], s38 offen sc1
    s_waitcnt vmcnt(26)
    v_lshl_or_b32 v48, v49, 16, v48
    v_lshl_or_b32 v49, v51, 16, v50
    v_lshl_or_b32 v50, v53, 16, v52
    v_lshl_or_b32 v51, v55, 16, v54
    s_add_u32 s38, s37, 512
    s_lshl_b32 s38, s38, 10
    s_mov_b32 exec_lo, s58
    s_mov_b32 exec_hi, s58
    buffer_store_dwordx4 v[48:51], v3, s[12:15], s38 offen sc1
    s_mov_b64 exec, -1
    s_waitcnt vmcnt(19)
    v_lshl_or_b32 v56, v57, 16, v56
    v_lshl_or_b32 v57, v59, 16, v58
    v_lshl_or_b32 v58, v61, 16, v60
    v_lshl_or_b32 v59, v63, 16, v62
    s_add_u32 s38, s37, 640
    s_lshl_b32 s38, s38, 10
    s_mov_b32 exec_lo, s59
    s_mov_b32 exec_hi, s59
    buffer_store_dwordx4 v[56:59], v3, s[12:15], s38 offen sc1
    s_mov_b64 exec, -1
    s_waitcnt vmcnt(19)
    buffer_store_dwordx4 v[64:67], v13, s[20:23], s64 offen sc1
    s_waitcnt vmcnt(19)
    buffer_store_dwordx4 v[68:71], v13, s[20:23], s65 offen sc1
    s_waitcnt vmcnt(19)
    buffer_store_dwordx4 v[72:75], v13, s[20:23], s66 offen sc1
    s_waitcnt vmcnt(19)
    buffer_store_dwordx4 v[76:79], v13, s[20:23], s67 offen sc1
    s_waitcnt vmcnt(19)
    buffer_store_dwordx4 v[80:83], v13, s[20:23], s68 offen sc1
    s_waitcnt vmcnt(19)
    buffer_store_dwordx4 v[84:87], v13, s[20:23], s69 offen sc1
    s_waitcnt vmcnt(19)
    buffer_store_dwordx4 v[88:91], v13, s[20:23], s70 offen sc1
    s_waitcnt vmcnt(19)
    buffer_store_dwordx4 v[92:95], v13, s[20:23], s71 offen sc1
    s_waitcnt vmcnt(19)
    buffer_store_dwordx4 v[96:99], v13, s[20:23], s72 offen sc1
    s_waitcnt vmcnt(19)
    buffer_store_dwordx4 v[100:103], v13, s[20:23], s73 offen sc1
    s_waitcnt vmcnt(19)
    buffer_store_dwordx4 v[104:107], v13, s[20:23], s74 offen sc1
    s_waitcnt vmcnt(19)
    buffer_store_dwordx4 v[108:111], v13, s[20:23], s75 offen sc1
    s_waitcnt vmcnt(19)
    buffer_store_dwordx4 v[112:115], v13, s[20:23], s76 offen sc1
    s_waitcnt vmcnt(19)
    buffer_store_dwordx4 v[116:119], v13, s[20:23], s77 offen sc1
    s_barrier
    s_mov_b32 s32, s10
    s_mov_b32 s33, s11
    s_mov_b32 s34, 0x10000000
    s_mov_b32 s35, 0x00020000
    s_mul_i32 s46, s2, 128
    s_lshl_b32 s47, s36, 2
    s_add_u32 s46, s46, s47
    s_add_u32 s46, s46, 0xd00000
    v_mov_b32 v1, 1
    s_waitcnt vmcnt(0)
    s_mov_b64 exec, 1
    buffer_store_dword v1, off, s[32:35], s46 sc1
    s_mov_b64 exec, -1
    s_barrier
sequential_preLN__sliding_block__glu_gated_bilinear__prompt_kernel_entry:
    s_mov_b64 exec, -1
pg_en:
    s_cbranch_execz pf_ret
    s_load_dwordx4 s[4:7], s[0:1], 32
    s_load_dwordx4 s[28:31], s[0:1], 48
    s_load_dwordx2 s[96:97], s[0:1], 0
    s_and_b32 s37, s2, 7
    s_bfe_u32 s38, s2, 0x20003
    s_lshr_b32 s3, s2, 5
    s_lshl_b32 s3, s3, 3
    s_add_u32 s39, s3, s36
    s_lshl_b32 s40, s37, 2
    s_add_u32 s40, s40, s38
    s_lshl_b32 s41, s36, 10
    s_add_u32 s44, s39, s36
    s_sub_u32 s44, s44, 8
    s_mul_i32 s49, s40, 9
    s_lshr_b32 s49, s49, 1
    s_lshl_b32 s49, s49, 8
    s_mul_i32 s47, s39, 73728
    s_add_u32 s47, s47, s49
    s_add_u32 s49, s49, 36864
    s_max_i32 s60, s44, 0
    s_add_i32 s61, s44, 1
    s_max_i32 s61, s61, 0
    v_lshlrev_b32 v12, 4, v2
    v_lshrrev_b32 v24, 4, v2
    v_add_u32 v24, s44, v24
    v_max_i32 v24, 0, v24
    v_mul_u32_u24 v24, 73728, v24
    v_and_b32 v25, 15, v2
    v_lshl_add_u32 v30, v25, 4, v24
    v_lshrrev_b32 v26, 5, v2
    v_and_b32 v27, 31, v2
    s_mul_i32 s8, s40, 288
    v_mul_u32_u24 v24, 9216, v26
    v_lshl_add_u32 v24, v27, 4, v24
    v_add_u32 v31, s8, v24
    v_lshlrev_b32 v24, 3, v27
    v_lshl_add_u32 v25, v26, 8, v24
    s_lshl_b32 s45, s36, 11
    s_mov_b32 s58, -1
    s_mov_b32 s59, 0
    s_waitcnt lgkmcnt(0)
    s_mov_b32 s12, s10
    s_mov_b32 s13, s11
    s_mov_b32 s14, 0x10000000
    s_mov_b32 s15, 0x00020000
    s_mov_b32 s55, 0xd00000
    s_lshr_b32 s8, s49, 6
    s_sub_u32 s8, s8, 576
    v_bfe_u32 v32, v2, 1, 2
    v_and_b32 v33, 1, v2
    v_mul_u32_u24 v34, 576, v32
    v_mad_u32_u24 v34, v33, 19, v34
    v_add_u32 v34, s8, v34
    v_lshrrev_b32 v34, 6, v34
    s_lshr_b32 s8, s60, 1
    v_mov_b32 v33, s8
    s_lshr_b32 s8, s39, 1
    v_mov_b32 v35, s8
    v_cmp_eq_u32 vcc, 0, v32
    s_nop 1
    v_cndmask_b32 v33, v33, v35, vcc
    s_add_u32 s8, s3, s37
    s_lshr_b32 s9, s8, 1
    s_and_b32 s8, s8, 1
    v_mov_b32 v35, s9
    v_mov_b32 v36, s8
    v_cmp_eq_u32 vcc, 3, v32
    s_nop 1
    v_cndmask_b32 v33, v33, v35, vcc
    v_cndmask_b32 v34, v34, v36, vcc
    v_lshrrev_b32 v35, 1, v33
    v_lshrrev_b32 v36, 1, v34
    v_mad_u32_u24 v35, v35, 14, v36
    v_and_b32 v33, 1, v33
    v_and_b32 v34, 1, v34
    v_lshl_add_u32 v33, v34, 1, v33
    v_lshlrev_b32 v33, 2, v33
    v_mul_u32_u24 v35, 128, v35
    v_add_u32 v15, v35, v33
    v_and_b32 v46, 31, v2
    v_mul_u32_u24 v46, 128, v46
    s_add_u32 s51, s55, 28672
    v_bfe_u32 v32, v2, 1, 2
    v_mul_u32_u24 v32, 128, v32
    v_and_b32 v33, 1, v2
    v_lshl_add_u32 v47, v33, 4, v32
    s_mul_i32 s8, s3, 64
    s_add_u32 s8, s8, 0xd00040
    s_cmp_eq_u32 s36, 5
    s_cselect_b32 s51, s8, s51
    s_cselect_b64 vcc, -1, 0
    v_cndmask_b32 v46, v46, v47, vcc
    s_and_b32 s8, s36, 6
    s_cmp_lg_u32 s8, 4
    s_cbranch_scc1 sequential_preLN__sliding_block__glu_gated_bilinear__prompt_kernel_b117
    buffer_load_dwordx4 v[48:51], v46, s[12:15], s51 offen sc1
sequential_preLN__sliding_block__glu_gated_bilinear__prompt_kernel_b117:
    s_mov_b64 exec, 0xff
    s_mov_b32 s9, 4096
sequential_preLN__sliding_block__glu_gated_bilinear__prompt_kernel_pl20:
    buffer_load_dword v40, v15, s[12:15], s55 offen sc1
    s_waitcnt vmcnt(0)
    v_cmp_eq_u32 vcc, 0, v40
    s_nop 0
    s_and_b32 s62, vcc_lo, 15
    s_cbranch_scc0 sequential_preLN__sliding_block__glu_gated_bilinear__prompt_kernel_b219
    s_mov_b64 exec, vcc
    s_sleep 4
    s_sub_u32 s9, s9, 1
    s_cbranch_scc0 sequential_preLN__sliding_block__glu_gated_bilinear__prompt_kernel_pl20
sequential_preLN__sliding_block__glu_gated_bilinear__prompt_kernel_b219:
    s_mov_b32 s62, vcc_lo
    s_mov_b64 exec, -1
    s_mul_i32 s9, s60, 73728
    s_add_u32 s9, s9, s49
    s_add_u32 m0, s45, 98304
    s_nop 0
    buffer_load_dwordx4 v12, s[12:15], s9 offen sc1 lds
    s_mul_i32 s9, s61, 73728
    s_add_u32 s9, s9, s49
    s_add_u32 m0, s45, 99328
    s_nop 0
    buffer_load_dwordx4 v12, s[12:15], s9 offen sc1 lds
    s_lshl_b32 s9, s36, 9
    s_add_u32 m0, s9, 114688
    s_add_u32 s9, s49, 1024
    s_mov_b64 exec, s[58:59]
    buffer_load_dwordx4 v30, s[12:15], s9 offen sc1 lds
    s_mov_b64 exec, -1
    buffer_load_dwordx2 v[224:225], v25, s[12:15], s47 offen offset:0 sc1
    buffer_load_dwordx2 v[226:227], v25, s[12:15], s47 offen offset:512 sc1
    buffer_load_dwordx2 v[228:229], v25, s[12:15], s47 offen offset:1024 sc1
    s_mov_b32 s52, 0x3ffff
    s_mov_b32 s53, 0x3ffff
    s_mov_b64 exec, s[52:53]
    s_lshl_b32 s8, s36, 12
    s_add_u32 s8, s8, 119808
    s_not_b64 exec, exec
    v_mov_b32 v32, 0x3f803f80
    v_mov_b32 v33, 0x3f803f80
    v_mov_b32 v34, 0x3f803f80
    v_mov_b32 v35, 0x3f803f80
    v_add_u32 v5, s8, v12
    ds_write_b128 v5, v[32:35] offset:0
    ds_write_b128 v5, v[32:35] offset:1024
    ds_write_b128 v5, v[32:35] offset:2048
    ds_write_b128 v5, v[32:35] offset:3072
    s_mov_b64 exec, -1
    s_mov_b32 s16, s4
    s_mov_b32 s17, s5
    s_mov_b32 s18, 0x510000
    s_mov_b32 s19, 0x00020000
    s_mov_b32 s20, s6
    s_mov_b32 s21, s7
    s_mov_b32 s22, 0x510000
    s_mov_b32 s23, 0x00020000
    s_mov_b32 s24, s28
    s_mov_b32 s25, s29
    s_mov_b32 s26, 0x510000
    s_mov_b32 s27, 0x00020000
    s_mov_b32 s32, s30
    s_mov_b32 s33, s31
    s_mov_b32 s34, 0x240000
    s_mov_b32 s35, 0x00020000
    s_mov_b32 s98, 0x240000
    s_mov_b32 s99, 0x00020000
    s_mov_b32 s28, s60
    s_mov_b32 s29, s61
    s_mov_b32 s30, s8
    v_mov_b32 v41, v31
    s_add_u32 s8, s41, 98304
    v_add_u32 v3, s8, v25
    s_lshl_b32 s8, s36, 8
    s_add_u32 s8, s8, 114688
    v_add_u32 v4, s8, v24
    s_add_u32 s8, s45, 119808
    v_add_u32 v5, s8, v12
    v_lshlrev_b32 v30, 2, v26
    v_sub_u32 v6, v27, v30
    v_cmp_le_i32 s[64:65], 0, v6
    v_cmp_le_i32 s[66:67], 1, v6
    v_cmp_le_i32 s[68:69], 2, v6
    v_cmp_le_i32 s[70:71], 3, v6
    v_cmp_le_i32 s[72:73], 8, v6
    v_cmp_le_i32 s[74:75], 9, v6
    v_cmp_le_i32 s[76:77], 10, v6
    v_cmp_le_i32 s[78:79], 11, v6
    v_cmp_le_i32 s[80:81], 16, v6
    v_cmp_le_i32 s[82:83], 17, v6
    v_cmp_le_i32 s[84:85], 18, v6
    v_cmp_le_i32 s[86:87], 19, v6
    v_cmp_le_i32 s[88:89], 24, v6
    v_cmp_le_i32 s[90:91], 25, v6
    v_cmp_le_i32 s[92:93], 26, v6
    v_cmp_le_i32 s[94:95], 27, v6
    v_mov_b32 v24, 0xffff
    v_cndmask_b32 v232, 0, v24, s[64:65]
    v_cndmask_b32 v232, v232, -1, s[66:67]
    v_cndmask_b32 v233, 0, v24, s[68:69]
    v_cndmask_b32 v233, v233, -1, s[70:71]
    v_cndmask_b32 v234, 0, v24, s[72:73]
    v_cndmask_b32 v234, v234, -1, s[74:75]
    v_cndmask_b32 v235, 0, v24, s[76:77]
    v_cndmask_b32 v235, v235, -1, s[78:79]
    v_cndmask_b32 v236, 0, v24, s[80:81]
    v_cndmask_b32 v236, v236, -1, s[82:83]
    v_cndmask_b32 v237, 0, v24, s[84:85]
    v_cndmask_b32 v237, v237, -1, s[86:87]
    v_cndmask_b32 v238, 0, v24, s[88:89]
    v_cndmask_b32 v238, v238, -1, s[90:91]
    v_cndmask_b32 v239, 0, v24, s[92:93]
    v_cndmask_b32 v239, v239, -1, s[94:95]
    s_bitcmp1_b32 s40, 0
    s_cselect_b32 s52, 0, -1
    s_mov_b32 s53, -1
    s_cselect_b32 s56, -1, 0
    s_mov_b32 s57, 0
    v_mov_b32 v24, 0x3f803f80
    v_cndmask_b32 v10, 0, v24, s[58:59]
    v_cndmask_b32 v11, 0, v24, s[58:59]
    s_sub_i32 s54, 8, s39
    s_and_b32 s8, s36, 1
    s_lshl_b32 s8, s8, 1
    s_bfe_u32 s9, s36, 0x10001
    s_or_b32 s8, s8, s9
    s_and_b32 s9, s36, 4
    s_or_b32 s8, s8, s9
    s_lshl_b32 s42, s8, 10
    s_mul_i32 s43, s36, 73728
    s_mul_i32 s8, s37, 1152
    s_add_u32 s43, s43, s8
    s_lshl_b32 s9, s38, 8
    s_add_u32 s43, s43, s9
    s_mul_i32 s46, s39, 36864
    v_bfe_u32 v20, v2, 2, 3
    v_bfe_u32 v21, v2, 4, 1
    v_lshlrev_b32 v21, 1, v21
    v_and_b32 v22, 3, v2
    v_xor_b32 v21, v21, v22
    v_lshlrev_b32 v21, 4, v21
    v_lshrrev_b32 v23, 5, v2
    v_lshl_add_u32 v21, v23, 6, v21
    v_mul_u32_u24 v8, 9216, v20
    v_add_u32 v8, v8, v21
    s_lshl_b32 s8, s37, 3
    s_lshr_b32 s9, s2, 5
    s_add_u32 s8, s8, s9
    s_lshl_b32 s48, s8, 2
    s_add_u32 s48, s48, s38
    s_lshl_b32 s48, s48, 16
    s_add_u32 s48, s48, s41
    s_add_u32 s48, s48, 0x1000000
    s_add_u32 s3, s3, s37
    s_mul_i32 s50, s3, 36864
    s_and_b32 s8, s36, 3
    s_mul_i32 s63, s8, 9216
    s_lshl_b32 s9, s38, 2
    s_lshr_b32 s60, s36, 1
    s_add_u32 s9, s9, s60
    s_mul_i32 s60, s9, 36864
    s_xor_b32 s9, s9, 1
    s_mul_i32 s61, s9, 36864
    s_add_u32 s9, s63, 0x3800000
    s_add_u32 s60, s60, s9
    s_add_u32 s61, s61, s9
    s_mul_i32 s44, s38, 37888
    s_add_u32 s44, s44, s9
    s_add_u32 s44, s44, 589824
    s_add_u32 s63, s63, s50
    s_add_u32 s63, s63, 0x800000
    s_cmp_lt_u32 s36, 4
    s_cselect_b32 s4, 0x1ffff, 0
    s_mov_b32 s5, s4
    s_lshl_b32 s45, s38, 3
    s_add_u32 s45, s45, s36
    v_mul_u32_u24 v30, 1152, v27
    v_lshl_add_u32 v30, v26, 3, v30
    v_lshlrev_b32 v31, 2, v27
    s_lshl_b32 s6, s45, 5
    s_add_u32 s6, s6, s50
    s_lshl_b32 s7, s38, 5
    s_add_u32 s7, s7, s50
    s_bfe_u32 s8, s36, 0x10001
    s_lshl_b32 s8, s8, 4
    s_add_u32 s7, s7, s8
    s_and_b32 s8, s36, 1
    s_lshl_b32 s8, s8, 2
    s_add_u32 s7, s7, s8
    s_lshl_b32 s8, s3, 7
    s_add_u32 s8, s8, 0xf00000
    buffer_load_dword v230, v30, s[96:99], s7 offen offset:1024
    v_mov_b32 v42, v31
    buffer_load_dwordx2 v[28:29], v30, s[96:99], s6 offen
    buffer_load_dwordx2 v[30:31], v30, s[96:99], s6 offen offset:16
    s_cmp_eq_u32 s62, 0
    s_cbranch_scc1 sequential_preLN__sliding_block__glu_gated_bilinear__prompt_kernel_b321
    s_mov_b64 exec, 0xff
    s_mov_b32 s9, 4096
sequential_preLN__sliding_block__glu_gated_bilinear__prompt_kernel_pl22:
    buffer_load_dword v40, v15, s[12:15], s55 offen sc1
    s_waitcnt vmcnt(0)
    v_cmp_eq_u32 vcc, 0, v40
    s_nop 0
    s_and_b32 s62, vcc_lo, 255
    s_cbranch_scc0 sequential_preLN__sliding_block__glu_gated_bilinear__prompt_kernel_b321
    s_mov_b64 exec, vcc
    s_sleep 4
    s_sub_u32 s9, s9, 1
    s_cbranch_scc0 sequential_preLN__sliding_block__glu_gated_bilinear__prompt_kernel_pl22
sequential_preLN__sliding_block__glu_gated_bilinear__prompt_kernel_b321:
    s_mov_b32 exec_lo, 0x3ffff
    s_mov_b32 exec_hi, 0x3ffff
    s_mul_i32 s9, s28, 36864
    s_add_u32 s9, s9, 0x500000
    s_add_u32 m0, s30, 0
    s_nop 0
    buffer_load_dwordx4 v41, s[12:15], s9 offen sc1 lds
    s_add_u32 m0, s30, 1024
    s_add_u32 s9, s9, 18432
    buffer_load_dwordx4 v41, s[12:15], s9 offen sc1 lds
    s_mul_i32 s9, s29, 36864
    s_add_u32 s9, s9, 0x500000
    s_add_u32 m0, s30, 2048
    s_nop 0
    buffer_load_dwordx4 v41, s[12:15], s9 offen sc1 lds
    s_add_u32 m0, s30, 3072
    s_add_u32 s9, s9, 18432
    buffer_load_dwordx4 v41, s[12:15], s9 offen sc1 lds
    s_mov_b64 exec, -1
    buffer_load_dword v231, v42, s[12:15], s8 offen sc1
    s_lshr_b32 s8, s2, 3
pg_7:
    s_cbranch_execz pf_ret
    s_lshl_b32 s8, s8, 3
    s_add_u32 s8, s8, s36
    s_mul_i32 s9, s37, 1152
    s_lshr_b32 s8, s8, 1
    s_and_b32 s28, s8, 63
    v_lshrrev_b32 v7, 2, v2
    v_mul_u32_u24 v7, 9216, v7
    v_and_b32 v13, 3, v2
    v_lshl_add_u32 v7, v13, 8, v7
    v_add_u32 v7, 128, v7
    v_lshrrev_b32 v13, 3, v2
    v_mul_u32_u24 v13, 9216, v13
    v_and_b32 v14, 7, v2
    v_lshl_add_u32 v13, v14, 7, v13
    s_mul_i32 s29, s28, 55296
    s_mul_i32 s28, s28, 27648
    s_add_u32 s28, s28, 3538944
    s_cmp_lt_u32 s8, 64
    s_cselect_b32 s28, s29, s28
    s_cselect_b64 vcc, -1, 0
    v_cndmask_b32 v7, v13, v7, vcc
    s_add_u32 s28, s28, s9
    v_add_u32 v7, s28, v7
    s_bitcmp1_b32 s36, 0
    s_cselect_b32 s28, s20, s16
    s_cselect_b32 s29, s21, s17
    s_mov_b32 s30, s18
    s_mov_b32 s31, 0x00020000
    s_and_b32 s8, s36, 6
    s_cmp_lg_u32 s8, 4
    s_cbranch_scc1 sequential_preLN__sliding_block__glu_gated_bilinear__prompt_kernel_xp23
    s_mov_b32 s9, 4096
sequential_preLN__sliding_block__glu_gated_bilinear__prompt_kernel_xl24:
    v_min_u32 v48, v48, v49
    v_min3_u32 v48, v50, v51, v48
    v_cmp_eq_u32 vcc, 0, v48
    s_cbranch_vccz sequential_preLN__sliding_block__glu_gated_bilinear__prompt_kernel_xp23
    buffer_load_dwordx4 v[48:51], v46, s[12:15], s51 offen sc1
    s_waitcnt vmcnt(0)
    s_sub_u32 s9, s9, 1
    s_cbranch_scc0 sequential_preLN__sliding_block__glu_gated_bilinear__prompt_kernel_xl24
sequential_preLN__sliding_block__glu_gated_bilinear__prompt_kernel_xp23:
    s_waitcnt vmcnt(8)
    v_cndmask_b32 v224, 0, v224, s[52:53]
    v_cndmask_b32 v228, 0, v228, s[58:59]
    v_cndmask_b32 v229, 0, v229, s[56:57]
    s_barrier
    ds_read_b64 v[32:33], v3 offset:8192
    ds_read_b64 v[34:35], v3 offset:8704
    ds_read_b64 v[36:37], v4 offset:2048
    ds_read_b64 v[40:41], v3 offset:0
    ds_read_b64 v[42:43], v3 offset:512
    ds_read_b64 v[44:45], v4 offset:0
    ds_read_b64 v[48:49], v3 offset:1024
    ds_read_b64 v[50:51], v3 offset:1536
    ds_read_b64 v[52:53], v4 offset:256
    s_waitcnt lgkmcnt(6)
    v_mfma_f32_32x32x16_bf16 v[208:223], v[32:35], v[224:227], 0
    v_mfma_f32_32x32x8_bf16 v[208:223], v[36:37], v[228:229], v[208:223]
    ds_read_b64 v[56:57], v3 offset:2048
    ds_read_b64 v[58:59], v3 offset:2560
    ds_read_b64 v[60:61], v4 offset:512
    s_mov_b64 exec, 0xffffff
    s_mov_b32 s31, 0x00020000
    buffer_load_dword v17, v7, s[28:31], 0 offen
    s_mov_b64 exec, -1
    s_waitcnt lgkmcnt(6)
    s_cmp_gt_i32 s54, 0
    s_cbranch_scc1 sequential_preLN__sliding_block__glu_gated_bilinear__prompt_kernel_neg25
    v_mfma_f32_32x32x16_bf16 v[80:95], v[40:43], v[224:227], 0
    v_mfma_f32_32x32x8_bf16 v[80:95], v[44:45], v[228:229], v[80:95]
sequential_preLN__sliding_block__glu_gated_bilinear__prompt_kernel_back26:
    ds_read_b64 v[32:33], v3 offset:3072
    ds_read_b64 v[34:35], v3 offset:3584
    ds_read_b64 v[36:37], v4 offset:768
    s_waitcnt lgkmcnt(6)
    s_cmp_gt_i32 s54, 1
    s_cbranch_scc1 sequential_preLN__sliding_block__glu_gated_bilinear__prompt_kernel_neg27
    v_mfma_f32_32x32x16_bf16 v[96:111], v[48:51], v[224:227], 0
    v_mfma_f32_32x32x8_bf16 v[96:111], v[52:53], v[228:229], v[96:111]
sequential_preLN__sliding_block__glu_gated_bilinear__prompt_kernel_back28:
    ds_read_b64 v[40:41], v3 offset:4096
    ds_read_b64 v[42:43], v3 offset:4608
    ds_read_b64 v[44:45], v4 offset:1024
    s_nop 0
    v_cndmask_b32 v208, v80, v208, s[64:65]
    v_cndmask_b32 v209, v81, v209, s[66:67]
    v_cndmask_b32 v210, v82, v210, s[68:69]
    v_cndmask_b32 v211, v83, v211, s[70:71]
    v_cndmask_b32 v212, v84, v212, s[72:73]
    v_cndmask_b32 v213, v85, v213, s[74:75]
    v_cndmask_b32 v214, v86, v214, s[76:77]
    v_cndmask_b32 v215, v87, v215, s[78:79]
    v_cndmask_b32 v216, v88, v216, s[80:81]
    v_cndmask_b32 v217, v89, v217, s[82:83]
    v_cndmask_b32 v218, v90, v218, s[84:85]
    v_cndmask_b32 v219, v91, v219, s[86:87]
    s_waitcnt lgkmcnt(6)
    s_cmp_gt_i32 s54, 2
    s_cbranch_scc1 sequential_preLN__sliding_block__glu_gated_bilinear__prompt_kernel_neg29
    v_mfma_f32_32x32x16_bf16 v[112:127], v[56:59], v[224:227], 0
    v_mfma_f32_32x32x8_bf16 v[112:127], v[60:61], v[228:229], v[112:127]
sequential_preLN__sliding_block__glu_gated_bilinear__prompt_kernel_back30:
    ds_read_b64 v[48:49], v3 offset:5120
    ds_read_b64 v[50:51], v3 offset:5632
    ds_read_b64 v[52:53], v4 offset:1280
    v_cndmask_b32 v220, v92, v220, s[88:89]
    v_cndmask_b32 v221, v93, v221, s[90:91]
    v_cndmask_b32 v222, v94, v222, s[92:93]
    v_cndmask_b32 v223, v95, v223, s[94:95]
    v_max_f32 v24, v208, v209
    v_max_f32 v25, v210, v211
    v_max_f32 v26, v212, v213
    v_max_f32 v27, v214, v215
    v_max3_f32 v24, v216, v217, v24
    v_max3_f32 v25, v218, v219, v25
    v_max3_f32 v26, v220, v221, v26
    v_max3_f32 v27, v222, v223, v27
    s_waitcnt lgkmcnt(6)
    s_cmp_gt_i32 s54, 3
    s_cbranch_scc1 sequential_preLN__sliding_block__glu_gated_bilinear__prompt_kernel_neg31
    v_mfma_f32_32x32x16_bf16 v[128:143], v[32:35], v[224:227], 0
    v_mfma_f32_32x32x8_bf16 v[128:143], v[36:37], v[228:229], v[128:143]
sequential_preLN__sliding_block__glu_gated_bilinear__prompt_kernel_back32:
    ds_read_b64 v[56:57], v3 offset:6144
    ds_read_b64 v[58:59], v3 offset:6656
    ds_read_b64 v[60:61], v4 offset:1536
    v_max3_f32 v24, v96, v97, v24
    v_max3_f32 v25, v98, v99, v25
    v_max3_f32 v26, v100, v101, v26
    v_max3_f32 v27, v102, v103, v27
    v_max3_f32 v24, v104, v105, v24
    v_max3_f32 v25, v106, v107, v25
    v_max3_f32 v26, v108, v109, v26
    v_max3_f32 v27, v110, v111, v27
    v_max3_f32 v24, v112, v113, v24
    v_max3_f32 v25, v114, v115, v25
    v_max3_f32 v26, v116, v117, v26
    v_max3_f32 v27, v118, v119, v27
    s_waitcnt lgkmcnt(6)
    s_cmp_gt_i32 s54, 4
    s_cbranch_scc1 sequential_preLN__sliding_block__glu_gated_bilinear__prompt_kernel_neg33
    v_mfma_f32_32x32x16_bf16 v[144:159], v[40:43], v[224:227], 0
    v_mfma_f32_32x32x8_bf16 v[144:159], v[44:45], v[228:229], v[144:159]
sequential_preLN__sliding_block__glu_gated_bilinear__prompt_kernel_back34:
    ds_read_b64 v[32:33], v3 offset:7168
    ds_read_b64 v[34:35], v3 offset:7680
    ds_read_b64 v[36:37], v4 offset:1792
    v_max3_f32 v24, v120, v121, v24
    v_max3_f32 v25, v122, v123, v25
    v_max3_f32 v26, v124, v125, v26
    v_max3_f32 v27, v126, v127, v27
    v_max3_f32 v24, v128, v129, v24
    v_max3_f32 v25, v130, v131, v25
    v_max3_f32 v26, v132, v133, v26
    v_max3_f32 v27, v134, v135, v27
    v_max3_f32 v24, v136, v137, v24
    v_max3_f32 v25, v138, v139, v25
    v_max3_f32 v26, v140, v141, v26
    v_max3_f32 v27, v142, v143, v27
    s_waitcnt lgkmcnt(6)
    s_cmp_gt_i32 s54, 5
    s_cbranch_scc1 sequential_preLN__sliding_block__glu_gated_bilinear__prompt_kernel_neg35
    v_mfma_f32_32x32x16_bf16 v[160:175], v[48:51], v[224:227], 0
    v_mfma_f32_32x32x8_bf16 v[160:175], v[52:53], v[228:229], v[160:175]
sequential_preLN__sliding_block__glu_gated_bilinear__prompt_kernel_back36:
    v_max3_f32 v24, v144, v145, v24
    v_max3_f32 v25, v146, v147, v25
    v_max3_f32 v26, v148, v149, v26
    v_max3_f32 v27, v150, v151, v27
    v_max3_f32 v24, v152, v153, v24
    v_max3_f32 v25, v154, v155, v25
    v_max3_f32 v26, v156, v157, v26
    v_max3_f32 v27, v158, v159, v27
    s_waitcnt lgkmcnt(3)
    s_cmp_gt_i32 s54, 6
    s_cbranch_scc1 sequential_preLN__sliding_block__glu_gated_bilinear__prompt_kernel_neg37
    v_mfma_f32_32x32x16_bf16 v[176:191], v[56:59], v[224:227], 0
    v_mfma_f32_32x32x8_bf16 v[176:191], v[60:61], v[228:229], v[176:191]
sequential_preLN__sliding_block__glu_gated_bilinear__prompt_kernel_back38:
    v_max3_f32 v24, v160, v161, v24
    v_max3_f32 v25, v162, v163, v25
    v_max3_f32 v26, v164, v165, v26
    v_max3_f32 v27, v166, v167, v27
    v_max3_f32 v24, v168, v169, v24
    v_max3_f32 v25, v170, v171, v25
    v_max3_f32 v26, v172, v173, v26
    v_max3_f32 v27, v174, v175, v27
    s_waitcnt lgkmcnt(0)
    s_cmp_gt_i32 s54, 7
    s_cbranch_scc1 sequential_preLN__sliding_block__glu_gated_bilinear__prompt_kernel_neg39
    v_mfma_f32_32x32x16_bf16 v[192:207], v[32:35], v[224:227], 0
    v_mfma_f32_32x32x8_bf16 v[192:207], v[36:37], v[228:229], v[192:207]
sequential_preLN__sliding_block__glu_gated_bilinear__prompt_kernel_back40:
    v_max3_f32 v24, v176, v177, v24
    v_max3_f32 v25, v178, v179, v25
    v_max3_f32 v26, v180, v181, v26
    v_max3_f32 v27, v182, v183, v27
    v_max3_f32 v24, v184, v185, v24
    v_max3_f32 v25, v186, v187, v25
    v_max3_f32 v26, v188, v189, v26
    v_max3_f32 v27, v190, v191, v27
    s_waitcnt vmcnt(2)
    s_barrier
    ds_read_b128 v[32:35], v5 offset:2048
    ds_read_b128 v[36:39], v5 offset:3072
    ds_read_b128 v[40:43], v5 offset:4096
    ds_read_b128 v[44:47], v5 offset:5120
    ds_read_b128 v[48:51], v5 offset:6144
    ds_read_b128 v[52:55], v5 offset:7168
    v_max3_f32 v24, v192, v193, v24
    v_max3_f32 v25, v194, v195, v25
    v_max3_f32 v26, v196, v197, v26
    v_max3_f32 v27, v198, v199, v27
    v_max3_f32 v24, v200, v201, v24
    v_max3_f32 v25, v202, v203, v25
    v_max3_f32 v26, v204, v205, v26
    v_max3_f32 v27, v206, v207, v27
    v_max_f32 v24, v24, v25
    v_max3_f32 v24, v26, v27, v24
    v_mov_b32 v25, v24
    s_nop 1
    v_permlane32_swap_b32 v24, v25
    v_max_f32 v24, v24, v25
    v_and_b32 v25, 0xffff0000, v24
    v_sub_f32 v25, v25, v24
    v_xor_b32 v24, 0x80000000, v24
    v_and_b32 v27, 0xffff0000, v25
    v_lshrrev_b32 v24, 16, v24
    v_sub_f32 v25, v25, v27
    v_or_b32 v26, v24, v27
    v_lshrrev_b32 v27, 16, v25
    s_nop 1
    v_mfma_f32_32x32x8_bf16 v[96:111], v[10:11], v[26:27], v[96:111]
    v_mfma_f32_32x32x8_bf16 v[112:127], v[10:11], v[26:27], v[112:127]
    s_nop 10
    v_exp_f32 v96, v96
    v_exp_f32 v97, v97
    v_exp_f32 v98, v98
    v_exp_f32 v99, v99
    v_exp_f32 v100, v100
    v_exp_f32 v101, v101
    v_exp_f32 v102, v102
    v_exp_f32 v103, v103
    v_cvt_pk_bf16_f32 v96, v96, v97
    v_cvt_pk_bf16_f32 v97, v98, v99
    v_cvt_pk_bf16_f32 v98, v100, v101
    v_cvt_pk_bf16_f32 v99, v102, v103
    s_waitcnt lgkmcnt(4)
    v_exp_f32 v104, v104
    v_exp_f32 v105, v105
    v_mfma_f32_32x32x16_bf16 v[64:79], v[32:35], v[96:99], 0
    v_mfma_f32_32x32x8_bf16 v[128:143], v[10:11], v[26:27], v[128:143]
    v_exp_f32 v106, v106
    v_exp_f32 v107, v107
    v_exp_f32 v108, v108
    v_exp_f32 v109, v109
    v_exp_f32 v110, v110
    v_exp_f32 v111, v111
    v_cvt_pk_bf16_f32 v100, v104, v105
    v_cvt_pk_bf16_f32 v101, v106, v107
    v_cvt_pk_bf16_f32 v102, v108, v109
    v_cvt_pk_bf16_f32 v103, v110, v111
    v_exp_f32 v112, v112
    v_exp_f32 v113, v113
    v_mfma_f32_32x32x16_bf16 v[64:79], v[36:39], v[100:103], v[64:79]
    ds_read_b128 v[56:59], v5 offset:8192
    ds_read_b128 v[60:63], v5 offset:9216
    v_exp_f32 v114, v114
    v_exp_f32 v115, v115
    v_exp_f32 v116, v116
    v_exp_f32 v117, v117
    v_exp_f32 v118, v118
    v_exp_f32 v119, v119
    v_cvt_pk_bf16_f32 v112, v112, v113
    v_cvt_pk_bf16_f32 v113, v114, v115
    v_cvt_pk_bf16_f32 v114, v116, v117
    v_cvt_pk_bf16_f32 v115, v118, v119
    s_waitcnt lgkmcnt(4)
    v_exp_f32 v120, v120
    v_exp_f32 v121, v121
    v_mfma_f32_32x32x16_bf16 v[64:79], v[40:43], v[112:115], v[64:79]
    v_mfma_f32_32x32x8_bf16 v[144:159], v[10:11], v[26:27], v[144:159]
    s_add_u32 s9, s60, 0
    buffer_load_dwordx4 v[240:243], v12, s[12:15], s9 offen offset:0 sc1
    v_exp_f32 v122, v122
    v_exp_f32 v123, v123
    v_exp_f32 v124, v124
    v_exp_f32 v125, v125
    v_exp_f32 v126, v126
    s_add_u32 s9, s61, 0
    buffer_load_dwordx4 v[244:247], v12, s[12:15], s9 offen offset:0 sc1
    v_exp_f32 v127, v127
    v_cvt_pk_bf16_f32 v116, v120, v121
    v_cvt_pk_bf16_f32 v117, v122, v123
    v_cvt_pk_bf16_f32 v118, v124, v125
    v_cvt_pk_bf16_f32 v119, v126, v127
    v_exp_f32 v128, v128
    v_exp_f32 v129, v129
    v_mfma_f32_32x32x16_bf16 v[64:79], v[44:47], v[116:119], v[64:79]
    ds_read_b128 v[32:35], v5 offset:10240
    ds_read_b128 v[36:39], v5 offset:11264
    s_add_u32 s9, s44, 0
    s_mov_b64 exec, s[4:5]
    buffer_load_dwordx4 v[248:251], v12, s[12:15], s9 offen offset:0 sc1
    s_mov_b64 exec, -1
    v_exp_f32 v130, v130
    v_exp_f32 v131, v131
    v_exp_f32 v132, v132
    v_exp_f32 v133, v133
    v_exp_f32 v134, v134
    s_add_u32 s9, s60, 0
    buffer_load_dwordx4 v[252:255], v12, s[12:15], s9 offen offset:1024 sc1
    v_exp_f32 v135, v135
    v_cvt_pk_bf16_f32 v128, v128, v129
    v_cvt_pk_bf16_f32 v129, v130, v131
    v_cvt_pk_bf16_f32 v130, v132, v133
    v_cvt_pk_bf16_f32 v131, v134, v135
    s_waitcnt lgkmcnt(4)
    v_exp_f32 v136, v136
    v_exp_f32 v137, v137
    v_mfma_f32_32x32x16_bf16 v[64:79], v[48:51], v[128:131], v[64:79]
    v_mfma_f32_32x32x8_bf16 v[160:175], v[10:11], v[26:27], v[160:175]
    s_add_u32 s9, s61, 0
    buffer_load_dwordx4 v[224:227], v12, s[12:15], s9 offen offset:1024 sc1
    v_exp_f32 v138, v138
    v_exp_f32 v139, v139
    v_exp_f32 v140, v140
    v_exp_f32 v141, v141
    v_exp_f32 v142, v142
    s_add_u32 s9, s44, 0
    s_mov_b64 exec, s[4:5]
    buffer_load_dwordx4 v[88:91], v12, s[12:15], s9 offen offset:1024 sc1
    s_mov_b64 exec, -1
    v_exp_f32 v143, v143
    v_cvt_pk_bf16_f32 v132, v136, v137
    v_cvt_pk_bf16_f32 v133, v138, v139
    v_cvt_pk_bf16_f32 v134, v140, v141
    v_cvt_pk_bf16_f32 v135, v142, v143
    v_exp_f32 v144, v144
    v_exp_f32 v145, v145
    v_mfma_f32_32x32x16_bf16 v[64:79], v[52:55], v[132:135], v[64:79]
    ds_read_b128 v[40:43], v5 offset:12288
    ds_read_b128 v[44:47], v5 offset:13312
    s_add_u32 s9, s60, 0
    buffer_load_dwordx4 v[92:95], v12, s[12:15], s9 offen offset:2048 sc1
    v_exp_f32 v146, v146
    v_exp_f32 v147, v147
    v_exp_f32 v148, v148
    v_exp_f32 v149, v149
    v_exp_f32 v150, v150
    s_add_u32 s9, s61, 0
    buffer_load_dwordx4 v[104:107], v12, s[12:15], s9 offen offset:2048 sc1
    v_exp_f32 v151, v151
    v_cvt_pk_bf16_f32 v144, v144, v145
    v_cvt_pk_bf16_f32 v145, v146, v147
    v_cvt_pk_bf16_f32 v146, v148, v149
    v_cvt_pk_bf16_f32 v147, v150, v151
    s_waitcnt lgkmcnt(4)
    v_exp_f32 v152, v152
    v_exp_f32 v153, v153
    v_mfma_f32_32x32x16_bf16 v[64:79], v[56:59], v[144:147], v[64:79]
    v_mfma_f32_32x32x8_bf16 v[176:191], v[10:11], v[26:27], v[176:191]
    s_add_u32 s9, s44, 0
    s_mov_b64 exec, s[4:5]
    buffer_load_dwordx4 v[108:111], v12, s[12:15], s9 offen offset:2048 sc1
    s_mov_b64 exec, -1
    v_exp_f32 v154, v154
    v_exp_f32 v155, v155
    v_exp_f32 v156, v156
    v_exp_f32 v157, v157
    v_exp_f32 v158, v158
    s_add_u32 s9, s60, 0
    buffer_load_dwordx4 v[96:99], v12, s[12:15], s9 offen offset:3072 sc1
    v_exp_f32 v159, v159
    v_cvt_pk_bf16_f32 v148, v152, v153
    v_cvt_pk_bf16_f32 v149, v154, v155
    v_cvt_pk_bf16_f32 v150, v156, v157
    v_cvt_pk_bf16_f32 v151, v158, v159
    v_exp_f32 v160, v160
    v_exp_f32 v161, v161
    v_mfma_f32_32x32x16_bf16 v[64:79], v[60:63], v[148:151], v[64:79]
    ds_read_b128 v[48:51], v5 offset:14336
    ds_read_b128 v[52:55], v5 offset:15360
    s_add_u32 s9, s61, 0
    buffer_load_dwordx4 v[100:103], v12, s[12:15], s9 offen offset:3072 sc1
    v_exp_f32 v162, v162
    v_exp_f32 v163, v163
    v_exp_f32 v164, v164
    v_exp_f32 v165, v165
    v_exp_f32 v166, v166
    s_add_u32 s9, s44, 0
    s_mov_b64 exec, s[4:5]
    buffer_load_dwordx4 v[120:123], v12, s[12:15], s9 offen offset:3072 sc1
    s_mov_b64 exec, -1
    v_exp_f32 v167, v167
    v_cvt_pk_bf16_f32 v160, v160, v161
    v_cvt_pk_bf16_f32 v161, v162, v163
    v_cvt_pk_bf16_f32 v162, v164, v165
    v_cvt_pk_bf16_f32 v163, v166, v167
    s_waitcnt lgkmcnt(4)
    v_exp_f32 v168, v168
    v_exp_f32 v169, v169
    v_mfma_f32_32x32x16_bf16 v[64:79], v[32:35], v[160:163], v[64:79]
    v_mfma_f32_32x32x8_bf16 v[192:207], v[10:11], v[26:27], v[192:207]
    s_add_u32 s9, s60, 4096
    buffer_load_dwordx4 v[124:127], v12, s[12:15], s9 offen offset:0 sc1
    v_exp_f32 v170, v170
    v_exp_f32 v171, v171
    v_exp_f32 v172, v172
    v_exp_f32 v173, v173
    v_exp_f32 v174, v174
    s_add_u32 s9, s61, 4096
    buffer_load_dwordx4 v[112:115], v12, s[12:15], s9 offen offset:0 sc1
    v_exp_f32 v175, v175
    v_cvt_pk_bf16_f32 v164, v168, v169
    v_cvt_pk_bf16_f32 v165, v170, v171
    v_cvt_pk_bf16_f32 v166, v172, v173
    v_cvt_pk_bf16_f32 v167, v174, v175
    v_exp_f32 v176, v176
    v_exp_f32 v177, v177
    v_mfma_f32_32x32x16_bf16 v[64:79], v[36:39], v[164:167], v[64:79]
    ds_read_b128 v[56:59], v5 offset:16384
    ds_read_b128 v[60:63], v5 offset:17408
    s_add_u32 s9, s44, 4096
    s_mov_b64 exec, s[4:5]
    buffer_load_dwordx4 v[116:119], v12, s[12:15], s9 offen offset:0 sc1
    s_mov_b64 exec, -1
    v_exp_f32 v178, v178
    v_exp_f32 v179, v179
    v_exp_f32 v180, v180
    v_exp_f32 v181, v181
    v_exp_f32 v182, v182
    s_add_u32 s9, s60, 4096
    buffer_load_dwordx4 v[136:139], v12, s[12:15], s9 offen offset:1024 sc1
    v_exp_f32 v183, v183
    v_cvt_pk_bf16_f32 v176, v176, v177
    v_cvt_pk_bf16_f32 v177, v178, v179
    v_cvt_pk_bf16_f32 v178, v180, v181
    v_cvt_pk_bf16_f32 v179, v182, v183
    s_waitcnt lgkmcnt(4)
    v_exp_f32 v184, v184
    v_exp_f32 v185, v185
    v_mfma_f32_32x32x16_bf16 v[64:79], v[40:43], v[176:179], v[64:79]
    v_mfma_f32_32x32x8_bf16 v[208:223], v[10:11], v[26:27], v[208:223]
    s_add_u32 s9, s61, 4096
    buffer_load_dwordx4 v[140:143], v12, s[12:15], s9 offen offset:1024 sc1
    v_exp_f32 v186, v186
    v_exp_f32 v187, v187
    v_exp_f32 v188, v188
    v_exp_f32 v189, v189
    v_exp_f32 v190, v190
    s_add_u32 s9, s44, 4096
    s_mov_b64 exec, s[4:5]
    buffer_load_dwordx4 v[128:131], v12, s[12:15], s9 offen offset:1024 sc1
    s_mov_b64 exec, -1
    v_exp_f32 v191, v191
    v_cvt_pk_bf16_f32 v180, v184, v185
    v_cvt_pk_bf16_f32 v181, v186, v187
    v_cvt_pk_bf16_f32 v182, v188, v189
    v_cvt_pk_bf16_f32 v183, v190, v191
    v_exp_f32 v192, v192
    v_exp_f32 v193, v193
    v_mfma_f32_32x32x16_bf16 v[64:79], v[44:47], v[180:183], v[64:79]
    ds_read_b128 v[32:35], v5 offset:0
    ds_read_b128 v[36:39], v5 offset:1024
    s_add_u32 s9, s60, 4096
    buffer_load_dwordx4 v[132:135], v12, s[12:15], s9 offen offset:2048 sc1
    v_exp_f32 v194, v194
    v_exp_f32 v195, v195
    v_exp_f32 v196, v196
    v_exp_f32 v197, v197
    v_exp_f32 v198, v198
    s_add_u32 s9, s61, 4096
    buffer_load_dwordx4 v[152:155], v12, s[12:15], s9 offen offset:2048 sc1
    v_exp_f32 v199, v199
    v_cvt_pk_bf16_f32 v192, v192, v193
    v_cvt_pk_bf16_f32 v193, v194, v195
    v_cvt_pk_bf16_f32 v194, v196, v197
    v_cvt_pk_bf16_f32 v195, v198, v199
    s_waitcnt lgkmcnt(4)
    v_exp_f32 v200, v200
    v_exp_f32 v201, v201
    v_mfma_f32_32x32x16_bf16 v[64:79], v[48:51], v[192:195], v[64:79]
    s_add_u32 s9, s44, 4096
    s_mov_b64 exec, s[4:5]
    buffer_load_dwordx4 v[156:159], v12, s[12:15], s9 offen offset:2048 sc1
    s_mov_b64 exec, -1
    v_exp_f32 v202, v202
    v_exp_f32 v203, v203
    v_exp_f32 v204, v204
    v_exp_f32 v205, v205
    v_exp_f32 v206, v206
    s_add_u32 s9, s60, 4096
    buffer_load_dwordx4 v[144:147], v12, s[12:15], s9 offen offset:3072 sc1
    v_exp_f32 v207, v207
    v_cvt_pk_bf16_f32 v196, v200, v201
    v_cvt_pk_bf16_f32 v197, v202, v203
    v_cvt_pk_bf16_f32 v198, v204, v205
    v_cvt_pk_bf16_f32 v199, v206, v207
    v_exp_f32 v208, v208
    v_exp_f32 v209, v209
    v_mfma_f32_32x32x16_bf16 v[64:79], v[52:55], v[196:199], v[64:79]
    s_add_u32 s9, s61, 4096
    buffer_load_dwordx4 v[148:151], v12, s[12:15], s9 offen offset:3072 sc1
    v_exp_f32 v210, v210
    v_exp_f32 v211, v211
    v_exp_f32 v212, v212
    v_exp_f32 v213, v213
    v_exp_f32 v214, v214
    v_exp_f32 v215, v215
    v_cvt_pk_bf16_f32 v208, v208, v209
    v_cvt_pk_bf16_f32 v209, v210, v211
    v_cvt_pk_bf16_f32 v210, v212, v213
    s_add_u32 s9, s44, 4096
    s_mov_b64 exec, s[4:5]
    buffer_load_dwordx4 v[168:171], v12, s[12:15], s9 offen offset:3072 sc1
    s_mov_b64 exec, -1
    v_cvt_pk_bf16_f32 v211, v214, v215
    v_bfi_b32 v80, v232, 0, v208
    v_and_b32 v208, v232, v208
    v_bfi_b32 v81, v233, 0, v209
    v_and_b32 v209, v233, v209
    v_bfi_b32 v82, v234, 0, v210
    v_and_b32 v210, v234, v210
    v_bfi_b32 v83, v235, 0, v211
    v_and_b32 v211, v235, v211
    s_waitcnt lgkmcnt(2)
    v_exp_f32 v216, v216
    v_exp_f32 v217, v217
    v_mfma_f32_32x32x16_bf16 v[64:79], v[56:59], v[208:211], v[64:79]
    s_add_u32 s9, s60, 8192
    buffer_load_dwordx4 v[172:175], v12, s[12:15], s9 offen offset:0 sc1
    v_exp_f32 v218, v218
    v_exp_f32 v219, v219
    v_exp_f32 v220, v220
    v_exp_f32 v221, v221
    v_exp_f32 v222, v222
    v_exp_f32 v223, v223
    v_cvt_pk_bf16_f32 v212, v216, v217
    v_cvt_pk_bf16_f32 v213, v218, v219
    v_cvt_pk_bf16_f32 v214, v220, v221
    s_add_u32 s9, s61, 8192
    buffer_load_dwordx4 v[160:163], v12, s[12:15], s9 offen offset:0 sc1
    v_cvt_pk_bf16_f32 v215, v222, v223
    v_bfi_b32 v84, v236, 0, v212
    v_and_b32 v212, v236, v212
    v_bfi_b32 v85, v237, 0, v213
    v_and_b32 v213, v237, v213
    v_bfi_b32 v86, v238, 0, v214
    v_and_b32 v214, v238, v214
    v_bfi_b32 v87, v239, 0, v215
    v_and_b32 v215, v239, v215
    s_nop 1
    v_mfma_f32_32x32x16_bf16 v[64:79], v[60:63], v[212:215], v[64:79]
    s_add_u32 s9, s44, 8192
    s_mov_b64 exec, s[4:5]
    buffer_load_dwordx4 v[164:167], v12, s[12:15], s9 offen offset:0 sc1
    s_mov_b64 exec, -1
    s_waitcnt lgkmcnt(0)
    v_mfma_f32_32x32x16_bf16 v[64:79], v[32:35], v[80:83], v[64:79]
    v_mfma_f32_32x32x16_bf16 v[64:79], v[36:39], v[84:87], v[64:79]
    s_lshl_b32 s8, s40, 10
    s_add_u32 s8, s8, s46
    s_add_u32 s8, s8, 0x800000
    s_lshr_b32 s6, s40, 2
    s_lshl_b32 s6, s6, 9
    s_and_b32 s7, s40, 3
    s_lshl_b32 s7, s7, 2
    s_add_u32 s6, s6, s7
    s_add_u32 s6, s6, s46
    s_add_u32 s6, s6, 0x808000
    s_nop 1
    v_rcp_f32 v24, v74
    s_nop 0
    v_mul_f32 v64, v64, v24
    v_mul_f32 v65, v65, v24
    v_mul_f32 v66, v66, v24
    v_mul_f32 v67, v67, v24
    v_mul_f32 v68, v68, v24
    v_mul_f32 v69, v69, v24
    v_mul_f32 v70, v70, v24
    v_mul_f32 v71, v71, v24
    v_mul_f32 v72, v72, v24
    v_mul_f32 v73, v73, v24
    v_cvt_pk_bf16_f32 v32, v64, v65
    v_cvt_pk_bf16_f32 v33, v66, v67
    v_cvt_pk_bf16_f32 v34, v68, v69
    v_cvt_pk_bf16_f32 v35, v70, v71
    v_cvt_pk_bf16_f32 v36, v72, v73
    buffer_store_dwordx4 v[32:35], v12, s[12:15], s8 offen sc1
    s_mov_b64 exec, s[58:59]
    buffer_store_dword v36, v12, s[12:15], s6 offen sc1
    s_mov_b64 exec, -1
    s_waitcnt vmcnt(21)
    v_lshlrev_b32 v64, 16, v28
    v_and_b32 v65, 0xffff0000, v28
    v_lshlrev_b32 v66, 16, v29
    v_and_b32 v67, 0xffff0000, v29
    v_lshlrev_b32 v68, 16, v30
    v_and_b32 v69, 0xffff0000, v30
    v_lshlrev_b32 v70, 16, v31
    v_and_b32 v71, 0xffff0000, v31
    v_mov_b32 v72, 0
    v_mov_b32 v73, 0
    v_mov_b32 v74, 0
    v_mov_b32 v75, 0
    v_mov_b32 v76, 0
    v_mov_b32 v77, 0
    v_mov_b32 v78, 0
    v_mov_b32 v79, 0
    s_lshl_b32 s8, s36, 11
    s_add_u32 s8, s8, 98304
    v_add_u32 v24, s8, v12
    v_xor_b32 v25, 2048, v24
    v_xor_b32 v26, 4096, v24
    v_xor_b32 v27, 6144, v24
    v_and_b32 v29, 31, v2
    v_lshlrev_b32 v29, 4, v29
    v_add_u32 v29, 155648, v29
    s_and_b32 s8, s36, 3
    s_lshl_b32 s9, s8, 2
    v_add_u32 v30, s9, v29
    s_lshr_b32 s9, s8, 1
    s_lshl_b32 s9, s9, 10
    s_and_b32 s8, s8, 1
    s_lshl_b32 s8, s8, 3
    s_add_u32 s8, s8, s9
    s_add_u32 s8, s8, 147456
    v_add_u32 v28, s8, v12
    v_bfe_u32 v20, v2, 2, 3
    v_bfe_u32 v21, v2, 4, 1
    v_lshlrev_b32 v21, 1, v21
    v_and_b32 v22, 3, v2
    v_xor_b32 v21, v21, v22
    v_lshlrev_b32 v21, 4, v21
    v_lshrrev_b32 v23, 5, v2
    v_lshl_add_u32 v21, v23, 6, v21
    s_and_b32 s8, s37, 3
    s_lshl_b32 s8, s8, 5
    v_xor_b32 v21, s8, v21
    v_mul_u32_u24 v9, 1152, v20
    v_add_u32 v9, v9, v21
    v_bfe_u32 v0, v2, 4, 1
    v_and_b32 v1, 15, v2
    v_lshlrev_b32 v21, 4, v1
    v_lshl_add_u32 v21, v0, 9, v21
    v_lshl_add_u32 v10, v23, 8, v21
    v_lshl_add_u32 v13, v23, 10, v21
    v_lshlrev_b32 v22, 3, v22
    v_lshl_add_u32 v21, v20, 6, v22
    v_lshl_add_u32 v21, v23, 10, v21
    v_lshl_add_u32 v3, v0, 5, v21
    v_xor_b32 v4, 32, v3
    v_add_u32 v5, 0x10000, v3
    v_add_u32 v6, 0x10000, v4
    v_lshl_add_u32 v21, v20, 5, v22
    v_lshl_add_u32 v21, v23, 8, v21
    v_add_u32 v7, 98304, v21
    v_and_b32 v14, 7, v2
    v_lshlrev_b32 v14, 2, v14
    v_lshl_add_u32 v11, v23, 4, v1
    v_lshlrev_b32 v11, 2, v11
    v_and_b32 v19, 31, v2
    v_lshlrev_b32 v19, 10, v19
    s_mul_i32 s53, s40, 55296
    s_add_u32 s53, s53, 0x3000000
    s_add_u32 s52, s53, 36864
    s_add_u32 s53, s53, s41
    s_lshl_b32 s54, s38, 12
    s_xor_b32 s54, s54, s41
    s_lshl_b32 s8, s37, 3
    s_lshr_b32 s9, s2, 5
    s_add_u32 s8, s8, s9
    s_lshl_b32 s47, s8, 15
    s_add_u32 s47, s47, s41
    s_add_u32 s47, s47, 0x2000000
    s_lshl_b32 s8, s37, 6
    s_add_u32 s8, s8, s39
    s_lshl_b32 s49, s8, 7
    s_add_u32 s49, s49, 0x2800000
    s_lshl_b32 s8, s38, 6
    s_add_u32 s8, s8, s39
    s_lshl_b32 s56, s8, 7
    s_add_u32 s56, s56, 0x2810000
pg_8:
    s_cbranch_execz pf_ret
    s_lshl_b32 s8, s37, 2
    s_add_u32 s57, s56, s8
    s_lshl_b32 s6, s45, 10
    s_add_u32 s6, s6, s50
    s_add_u32 s6, s6, 0xa40000
    s_mov_b32 s7, 4096
    s_barrier
    s_waitcnt vmcnt(63)
    s_cmp_ge_u32 s36, 4
    s_cbranch_scc1 sequential_preLN__sliding_block__glu_gated_bilinear__prompt_kernel_cp141
sequential_preLN__sliding_block__glu_gated_bilinear__prompt_kernel_pr43:
    s_add_u32 s9, s63, 0
    buffer_load_dwordx4 v[40:43], v12, s[12:15], s9 offen offset:0 sc1
    buffer_load_dwordx4 v[44:47], v12, s[12:15], s9 offen offset:1024 sc1
    buffer_load_dwordx4 v[48:51], v12, s[12:15], s9 offen offset:2048 sc1
    buffer_load_dwordx4 v[52:55], v12, s[12:15], s9 offen offset:3072 sc1
    s_add_u32 s9, s63, 4096
    buffer_load_dwordx4 v[56:59], v12, s[12:15], s9 offen offset:0 sc1
    buffer_load_dwordx4 v[60:63], v12, s[12:15], s9 offen offset:1024 sc1
    buffer_load_dwordx4 v[80:83], v12, s[12:15], s9 offen offset:2048 sc1
    buffer_load_dwordx4 v[84:87], v12, s[12:15], s9 offen offset:3072 sc1
    s_add_u32 s9, s63, 8192
    buffer_load_dwordx4 v[232:235], v12, s[12:15], s9 offen offset:0 sc1
    s_waitcnt vmcnt(8)
    v_mfma_f32_32x32x16_bf16 v[176:191], v[240:243], v[40:43], v[64:79]
    v_mfma_f32_32x32x16_bf16 v[192:207], v[244:247], v[40:43], 0
    v_mfma_f32_32x32x16_bf16 v[208:223], v[248:251], v[40:43], 0
    s_waitcnt vmcnt(7)
    v_mfma_f32_32x32x16_bf16 v[176:191], v[252:255], v[44:47], v[176:191]
    v_mfma_f32_32x32x16_bf16 v[192:207], v[224:227], v[44:47], v[192:207]
    v_mfma_f32_32x32x16_bf16 v[208:223], v[88:91], v[44:47], v[208:223]
    s_waitcnt vmcnt(6)
    v_mfma_f32_32x32x16_bf16 v[176:191], v[92:95], v[48:51], v[176:191]
    v_mfma_f32_32x32x16_bf16 v[192:207], v[104:107], v[48:51], v[192:207]
    v_mfma_f32_32x32x16_bf16 v[208:223], v[108:111], v[48:51], v[208:223]
    s_waitcnt vmcnt(5)
    v_mfma_f32_32x32x16_bf16 v[176:191], v[96:99], v[52:55], v[176:191]
    v_mfma_f32_32x32x16_bf16 v[192:207], v[100:103], v[52:55], v[192:207]
    v_mfma_f32_32x32x16_bf16 v[208:223], v[120:123], v[52:55], v[208:223]
    s_waitcnt vmcnt(4)
    v_mfma_f32_32x32x16_bf16 v[176:191], v[124:127], v[56:59], v[176:191]
    v_mfma_f32_32x32x16_bf16 v[192:207], v[112:115], v[56:59], v[192:207]
    v_mfma_f32_32x32x16_bf16 v[208:223], v[116:119], v[56:59], v[208:223]
    s_waitcnt vmcnt(3)
    v_mfma_f32_32x32x16_bf16 v[176:191], v[136:139], v[60:63], v[176:191]
    v_mfma_f32_32x32x16_bf16 v[192:207], v[140:143], v[60:63], v[192:207]
    v_mfma_f32_32x32x16_bf16 v[208:223], v[128:131], v[60:63], v[208:223]
    s_waitcnt vmcnt(2)
    v_mfma_f32_32x32x16_bf16 v[176:191], v[132:135], v[80:83], v[176:191]
    v_mfma_f32_32x32x16_bf16 v[192:207], v[152:155], v[80:83], v[192:207]
    v_mfma_f32_32x32x16_bf16 v[208:223], v[156:159], v[80:83], v[208:223]
    s_waitcnt vmcnt(1)
    v_mfma_f32_32x32x16_bf16 v[176:191], v[144:147], v[84:87], v[176:191]
    v_mfma_f32_32x32x16_bf16 v[192:207], v[148:151], v[84:87], v[192:207]
    v_mfma_f32_32x32x16_bf16 v[208:223], v[168:171], v[84:87], v[208:223]
    s_waitcnt vmcnt(0)
    v_mfma_f32_32x32x16_bf16 v[176:191], v[172:175], v[232:235], v[176:191]
    v_mfma_f32_32x32x16_bf16 v[192:207], v[160:163], v[232:235], v[192:207]
    v_mfma_f32_32x32x16_bf16 v[208:223], v[164:167], v[232:235], v[208:223]
    s_nop 9
    ds_write_b128 v24, v[184:187] offset:0
    ds_write_b128 v24, v[188:191] offset:1024
    ds_write_b128 v24, v[192:195] offset:16384
    ds_write_b128 v24, v[196:199] offset:17408
    ds_write_b128 v24, v[200:203] offset:32768
    ds_write_b128 v24, v[204:207] offset:33792
    v_cmp_u_f32 vcc, v184, v184
    ds_write_b128 v24, v[208:211] offset:49152
    ds_write_b128 v24, v[212:215] offset:50176
    s_mov_b64 exec, s[58:59]
    ds_write_b32 v30, v216
    s_mov_b64 exec, -1
    s_cbranch_vccz sequential_preLN__sliding_block__glu_gated_bilinear__prompt_kernel_pj42
    s_sub_u32 s7, s7, 1
    s_cbranch_scc0 sequential_preLN__sliding_block__glu_gated_bilinear__prompt_kernel_pr43
    s_branch sequential_preLN__sliding_block__glu_gated_bilinear__prompt_kernel_pj42
sequential_preLN__sliding_block__glu_gated_bilinear__prompt_kernel_cp141:
sequential_preLN__sliding_block__glu_gated_bilinear__prompt_kernel_pr45:
    s_add_u32 s9, s63, 0
    buffer_load_dwordx4 v[40:43], v12, s[12:15], s9 offen offset:0 sc1
    buffer_load_dwordx4 v[44:47], v12, s[12:15], s9 offen offset:1024 sc1
    buffer_load_dwordx4 v[48:51], v12, s[12:15], s9 offen offset:2048 sc1
    buffer_load_dwordx4 v[52:55], v12, s[12:15], s9 offen offset:3072 sc1
    s_add_u32 s9, s63, 4096
    buffer_load_dwordx4 v[56:59], v12, s[12:15], s9 offen offset:0 sc1
    buffer_load_dwordx4 v[60:63], v12, s[12:15], s9 offen offset:1024 sc1
    buffer_load_dwordx4 v[80:83], v12, s[12:15], s9 offen offset:2048 sc1
    buffer_load_dwordx4 v[84:87], v12, s[12:15], s9 offen offset:3072 sc1
    s_add_u32 s9, s63, 8192
    buffer_load_dwordx4 v[232:235], v12, s[12:15], s9 offen offset:0 sc1
    s_waitcnt vmcnt(8)
    v_mfma_f32_32x32x16_bf16 v[176:191], v[240:243], v[40:43], v[64:79]
    v_mfma_f32_32x32x16_bf16 v[192:207], v[244:247], v[40:43], 0
    s_waitcnt vmcnt(7)
    v_mfma_f32_32x32x16_bf16 v[176:191], v[252:255], v[44:47], v[176:191]
    v_mfma_f32_32x32x16_bf16 v[192:207], v[224:227], v[44:47], v[192:207]
    s_waitcnt vmcnt(6)
    v_mfma_f32_32x32x16_bf16 v[176:191], v[92:95], v[48:51], v[176:191]
    v_mfma_f32_32x32x16_bf16 v[192:207], v[104:107], v[48:51], v[192:207]
    s_waitcnt vmcnt(5)
    v_mfma_f32_32x32x16_bf16 v[176:191], v[96:99], v[52:55], v[176:191]
    v_mfma_f32_32x32x16_bf16 v[192:207], v[100:103], v[52:55], v[192:207]
    s_waitcnt vmcnt(4)
    v_mfma_f32_32x32x16_bf16 v[176:191], v[124:127], v[56:59], v[176:191]
    v_mfma_f32_32x32x16_bf16 v[192:207], v[112:115], v[56:59], v[192:207]
    s_waitcnt vmcnt(3)
    v_mfma_f32_32x32x16_bf16 v[176:191], v[136:139], v[60:63], v[176:191]
    v_mfma_f32_32x32x16_bf16 v[192:207], v[140:143], v[60:63], v[192:207]
    s_waitcnt vmcnt(2)
    v_mfma_f32_32x32x16_bf16 v[176:191], v[132:135], v[80:83], v[176:191]
    v_mfma_f32_32x32x16_bf16 v[192:207], v[152:155], v[80:83], v[192:207]
    s_waitcnt vmcnt(1)
    v_mfma_f32_32x32x16_bf16 v[176:191], v[144:147], v[84:87], v[176:191]
    v_mfma_f32_32x32x16_bf16 v[192:207], v[148:151], v[84:87], v[192:207]
    s_waitcnt vmcnt(0)
    v_mfma_f32_32x32x16_bf16 v[176:191], v[172:175], v[232:235], v[176:191]
    v_mfma_f32_32x32x16_bf16 v[192:207], v[160:163], v[232:235], v[192:207]
    s_nop 10
    ds_write_b128 v24, v[184:187] offset:0
    ds_write_b128 v24, v[188:191] offset:1024
    ds_write_b128 v24, v[192:195] offset:16384
    ds_write_b128 v24, v[196:199] offset:17408
    ds_write_b128 v24, v[200:203] offset:32768
    ds_write_b128 v24, v[204:207] offset:33792
    v_cmp_u_f32 vcc, v184, v184
    s_cbranch_vccz sequential_preLN__sliding_block__glu_gated_bilinear__prompt_kernel_pj42
    s_sub_u32 s7, s7, 1
    s_cbranch_scc0 sequential_preLN__sliding_block__glu_gated_bilinear__prompt_kernel_pr45
sequential_preLN__sliding_block__glu_gated_bilinear__prompt_kernel_pj42:
    s_waitcnt lgkmcnt(0)
    s_barrier
    ds_read_b128 v[36:39], v29
    ds_read_b128 v[40:43], v25 offset:0
    ds_read_b128 v[44:47], v25 offset:1024
    ds_read_b128 v[48:51], v26 offset:16384
    ds_read_b128 v[52:55], v26 offset:17408
    ds_read_b128 v[56:59], v27 offset:32768
    ds_read_b128 v[60:63], v27 offset:33792
    s_waitcnt lgkmcnt(6)
    v_add_f32 v36, v36, v37
    v_add_f32 v38, v38, v39
    v_add_f32 v36, v36, v38
    v_add_f32 v231, v231, v36
    v_sub_f32 v176, v176, v231
    v_sub_f32 v177, v177, v231
    v_sub_f32 v178, v178, v231
    v_sub_f32 v179, v179, v231
    v_sub_f32 v180, v180, v231
    v_sub_f32 v181, v181, v231
    v_sub_f32 v182, v182, v231
    v_sub_f32 v183, v183, v231
    s_waitcnt lgkmcnt(5)
    v_add_f32 v176, v176, v40
    v_add_f32 v177, v177, v41
    v_add_f32 v178, v178, v42
    v_add_f32 v179, v179, v43
    s_waitcnt lgkmcnt(4)
    v_add_f32 v180, v180, v44
    v_add_f32 v181, v181, v45
    v_add_f32 v182, v182, v46
    v_add_f32 v183, v183, v47
    s_waitcnt lgkmcnt(3)
    v_add_f32 v176, v176, v48
    v_add_f32 v177, v177, v49
    v_add_f32 v178, v178, v50
    v_add_f32 v179, v179, v51
    s_waitcnt lgkmcnt(2)
    v_add_f32 v180, v180, v52
    v_add_f32 v181, v181, v53
    v_add_f32 v182, v182, v54
    v_add_f32 v183, v183, v55
    s_waitcnt lgkmcnt(1)
    v_add_f32 v176, v176, v56
    v_add_f32 v177, v177, v57
    v_add_f32 v178, v178, v58
    v_add_f32 v179, v179, v59
    s_waitcnt lgkmcnt(0)
    v_add_f32 v180, v180, v60
    v_add_f32 v181, v181, v61
    v_add_f32 v182, v182, v62
    v_add_f32 v183, v183, v63
    v_cvt_pk_bf16_f32 v36, v176, v177
    v_cvt_pk_bf16_f32 v37, v178, v179
    v_cvt_pk_bf16_f32 v38, v180, v181
    v_cvt_pk_bf16_f32 v39, v182, v183
    buffer_store_dwordx4 v[36:39], v12, s[12:15], s6 offen sc1
    v_mul_f32 v32, v176, v176
    v_mul_f32 v33, v177, v177
    v_fmac_f32 v32, v178, v178
    v_fmac_f32 v33, v179, v179
    v_fmac_f32 v32, v180, v180
    v_fmac_f32 v33, v181, v181
    v_fmac_f32 v32, v182, v182
    v_fmac_f32 v33, v183, v183
    s_cmp_lt_u32 s36, 4
    s_cbranch_scc1 sequential_preLN__sliding_block__glu_gated_bilinear__prompt_kernel_nr47
    ds_read_b64 v[40:41], v28 offset:0
    ds_read_b64 v[42:43], v28 offset:2048
    ds_read_b64 v[44:45], v28 offset:4096
    ds_read_b64 v[46:47], v28 offset:6144
    v_lshlrev_b32 v0, 16, v230
    v_and_b32 v1, 0xffff0000, v230
    v_sub_f32 v0, v0, v231
    v_sub_f32 v1, v1, v231
    s_lshl_b32 s8, s38, 10
    s_add_u32 s8, s8, s50
    s_and_b32 s9, s36, 3
    s_lshl_b32 s9, s9, 2
    s_add_u32 s8, s8, s9
    s_add_u32 s8, s8, 0xa48000
    s_waitcnt lgkmcnt(3)
    v_add_f32 v0, v0, v40
    v_add_f32 v1, v1, v41
    s_waitcnt lgkmcnt(2)
    v_add_f32 v0, v0, v42
    v_add_f32 v1, v1, v43
    s_waitcnt lgkmcnt(1)
    v_add_f32 v0, v0, v44
    v_add_f32 v1, v1, v45
    s_waitcnt lgkmcnt(0)
    v_add_f32 v0, v0, v46
    v_add_f32 v1, v1, v47
    v_cvt_pk_bf16_f32 v34, v0, v1
    buffer_store_dword v34, v12, s[12:15], s8 offen sc1
    v_fmac_f32 v32, v0, v0
    v_fmac_f32 v33, v1, v1
    s_branch sequential_preLN__sliding_block__glu_gated_bilinear__prompt_kernel_nm48
sequential_preLN__sliding_block__glu_gated_bilinear__prompt_kernel_nr47:
    s_cmp_lg_u32 s45, 0
    s_cbranch_scc1 sequential_preLN__sliding_block__glu_gated_bilinear__prompt_kernel_nm48
    s_lshl_b32 s8, s3, 7
    s_add_u32 s8, s8, 0xc80000
    v_and_b32 v0, 31, v2
    v_lshlrev_b32 v0, 2, v0
    v_mov_b32 v1, v231
    buffer_store_dword v1, v0, s[12:15], s8 offen sc1
sequential_preLN__sliding_block__glu_gated_bilinear__prompt_kernel_nm48:
    v_add_f32 v32, v32, v33
    s_lshl_b32 s8, s36, 8
    s_add_u32 s8, s8, 156672
    v_lshl_add_u32 v33, v2, 2, s8
    ds_write_b32 v33, v32
    s_lshl_b32 s59, s3, 9
    s_lshl_b32 s8, s38, 2
    s_add_u32 s59, s59, s8
    s_add_u32 s59, s59, 0xc82000
    s_mul_i32 s8, s37, 576
    s_lshl_b32 s9, s36, 3
    s_add_u32 s9, s9, s8
    s_mul_i32 s9, s9, 1152
    s_lshl_b32 s3, s38, 8
    s_add_u32 s9, s9, s3
    s_lshr_b32 s3, s37, 2
    s_lshl_b32 s3, s3, 7
    s_add_u32 s44, s9, s3
    s_xor_b32 s3, s3, 128
    s_add_u32 s45, s9, s3
    s_xor_b32 s9, s38, 0
    s_mul_i32 s60, s9, 147456
    s_xor_b32 s9, s38, 1
    s_mul_i32 s61, s9, 147456
    s_xor_b32 s9, s38, 2
    s_mul_i32 s62, s9, 147456
    s_xor_b32 s9, s38, 3
    s_mul_i32 s63, s9, 147456
    s_lshl_b32 s8, s38, 2
    s_add_u32 s50, s49, s8
    s_cmp_eq_u32 s36, s37
    s_cselect_b32 s58, 1.0, 0
    s_add_u32 s8, s46, 0xa40000
    s_mov_b32 s7, 4096
    s_waitcnt vmcnt(0)
sequential_preLN__sliding_block__glu_gated_bilinear__prompt_kernel_hint49:
    buffer_load_dword v15, v19, s[12:15], s8 offen offset:1020 sc1
    s_add_u32 s9, s46, 0xa40000
    buffer_load_dwordx4 v[96:99], v13, s[12:15], s9 offen offset:0 sc1
    s_add_u32 s9, s46, 0xa40000
    buffer_load_dwordx4 v[100:103], v13, s[12:15], s9 offen offset:256 sc1
    s_add_u32 s9, s46, 0xa40000
    buffer_load_dwordx4 v[104:107], v13, s[12:15], s9 offen offset:2048 sc1
    s_add_u32 s9, s46, 0xa40000
    buffer_load_dwordx4 v[108:111], v13, s[12:15], s9 offen offset:2304 sc1
    s_sub_u32 s7, s7, 1
    s_cbranch_scc1 sequential_preLN__sliding_block__glu_gated_bilinear__prompt_kernel_hok50
    s_waitcnt vmcnt(4)
    v_cmp_eq_u32 vcc, -1, v15
    s_nop 1
    s_cbranch_vccnz sequential_preLN__sliding_block__glu_gated_bilinear__prompt_kernel_hint49
sequential_preLN__sliding_block__glu_gated_bilinear__prompt_kernel_hok50:
    s_add_u32 s9, s46, 0xa41000
    buffer_load_dwordx4 v[112:115], v13, s[12:15], s9 offen offset:0 sc1
    s_add_u32 s9, s46, 0xa41000
    buffer_load_dwordx4 v[116:119], v13, s[12:15], s9 offen offset:256 sc1
    ds_read_b64_tr_b16 v[240:241], v3 offset:0
    ds_read_b64_tr_b16 v[242:243], v3 offset:2048
    ds_read_b64_tr_b16 v[244:245], v3 offset:8192
    ds_read_b64_tr_b16 v[246:247], v3 offset:10240
    ds_read_b64_tr_b16 v[248:249], v4 offset:0
    ds_read_b64_tr_b16 v[250:251], v4 offset:2048
    s_waitcnt vmcnt(4)
    v_max_u32 v15, v96, v97
    v_max3_u32 v15, v98, v99, v15
    v_max3_u32 v15, v100, v101, v15
    v_max3_u32 v15, v102, v103, v15
    v_cmp_eq_u32 vcc, -1, v15
    s_cbranch_vccnz sequential_preLN__sliding_block__glu_gated_bilinear__prompt_kernel_retry51
sequential_preLN__sliding_block__glu_gated_bilinear__prompt_kernel_ok52:
    s_waitcnt lgkmcnt(4)
    v_mfma_f32_16x16x32_bf16 v[24:27], v[240:243], v[96:99], 0
    ds_read_b64_tr_b16 v[252:253], v4 offset:8192
    v_mov_b32 v92, -2
    v_mov_b32 v93, -2
    v_mfma_f32_16x16x32_bf16 v[28:31], v[240:243], v[100:103], 0
    ds_read_b64_tr_b16 v[254:255], v4 offset:10240
    v_mov_b32 v94, -2
    v_mov_b32 v95, -2
    s_add_u32 s9, s46, 0xa41000
    buffer_load_dwordx4 v[120:123], v13, s[12:15], s9 offen offset:2048 sc1
    s_waitcnt lgkmcnt(4)
    v_mfma_f32_16x16x32_bf16 v[32:35], v[244:247], v[96:99], 0
    ds_read_b64_tr_b16 v[240:241], v3 offset:512
    v_mfma_f32_16x16x32_bf16 v[36:39], v[244:247], v[100:103], 0
    ds_read_b64_tr_b16 v[242:243], v3 offset:2560
    s_xor_b32 s9, s48, 0x8000
    buffer_store_dwordx4 v[92:95], v12, s[12:15], s9 offen sc1
    s_waitcnt lgkmcnt(4)
    v_mfma_f32_16x16x32_bf16 v[40:43], v[248:251], v[96:99], 0
    ds_read_b64_tr_b16 v[244:245], v3 offset:8704
    v_mfma_f32_16x16x32_bf16 v[44:47], v[248:251], v[100:103], 0
    ds_read_b64_tr_b16 v[246:247], v3 offset:10752
    s_waitcnt lgkmcnt(4)
    v_mfma_f32_16x16x32_bf16 v[48:51], v[252:255], v[96:99], 0
    ds_read_b64_tr_b16 v[248:249], v4 offset:512
    v_mfma_f32_16x16x32_bf16 v[52:55], v[252:255], v[100:103], 0
    ds_read_b64_tr_b16 v[250:251], v4 offset:2560
    s_add_u32 s9, s46, 0xa41000
    buffer_load_dwordx4 v[124:127], v13, s[12:15], s9 offen offset:2304 sc1
    s_waitcnt lgkmcnt(4)
    v_mfma_f32_16x16x32_bf16 v[56:59], v[240:243], v[96:99], 0
    ds_read_b64_tr_b16 v[252:253], v4 offset:8704
    v_mfma_f32_16x16x32_bf16 v[60:63], v[240:243], v[100:103], 0
    ds_read_b64_tr_b16 v[254:255], v4 offset:10752
    s_waitcnt lgkmcnt(4)
    v_mfma_f32_16x16x32_bf16 v[64:67], v[244:247], v[96:99], 0
    ds_read_b64_tr_b16 v[240:241], v3 offset:4096
    s_waitcnt vmcnt(5)
    v_mfma_f32_16x16x32_bf16 v[68:71], v[244:247], v[100:103], 0
    ds_read_b64_tr_b16 v[242:243], v3 offset:6144
    v_max_u32 v15, v104, v105
    s_waitcnt lgkmcnt(4)
    v_mfma_f32_16x16x32_bf16 v[72:75], v[248:251], v[96:99], 0
    ds_read_b64_tr_b16 v[244:245], v3 offset:12288
    s_add_u32 s9, s46, 0xa42000
    buffer_load_dwordx4 v[128:131], v13, s[12:15], s9 offen offset:0 sc1
    v_mfma_f32_16x16x32_bf16 v[76:79], v[248:251], v[100:103], 0
    ds_read_b64_tr_b16 v[246:247], v3 offset:14336
    v_max3_u32 v15, v106, v107, v15
    v_max3_u32 v15, v108, v109, v15
    s_waitcnt lgkmcnt(4)
    v_mfma_f32_16x16x32_bf16 v[80:83], v[252:255], v[96:99], 0
    ds_read_b64_tr_b16 v[248:249], v4 offset:4096
    v_max3_u32 v15, v110, v111, v15
    v_mfma_f32_16x16x32_bf16 v[84:87], v[252:255], v[100:103], 0
    ds_read_b64_tr_b16 v[250:251], v4 offset:6144
    v_cmp_eq_u32 vcc, -1, v15
    s_cbranch_vccnz sequential_preLN__sliding_block__glu_gated_bilinear__prompt_kernel_retry53
sequential_preLN__sliding_block__glu_gated_bilinear__prompt_kernel_ok54:
    s_waitcnt lgkmcnt(4)
    v_mfma_f32_16x16x32_bf16 v[24:27], v[240:243], v[104:107], v[24:27]
    ds_read_b64_tr_b16 v[252:253], v4 offset:12288
    v_mfma_f32_16x16x32_bf16 v[28:31], v[240:243], v[108:111], v[28:31]
    ds_read_b64_tr_b16 v[254:255], v4 offset:14336
    s_waitcnt lgkmcnt(4)
    v_mfma_f32_16x16x32_bf16 v[32:35], v[244:247], v[104:107], v[32:35]
    ds_read_b64_tr_b16 v[240:241], v3 offset:4608
    v_mfma_f32_16x16x32_bf16 v[36:39], v[244:247], v[108:111], v[36:39]
    ds_read_b64_tr_b16 v[242:243], v3 offset:6656
    s_waitcnt lgkmcnt(4)
    v_mfma_f32_16x16x32_bf16 v[40:43], v[248:251], v[104:107], v[40:43]
    ds_read_b64_tr_b16 v[244:245], v3 offset:12800
    v_mfma_f32_16x16x32_bf16 v[44:47], v[248:251], v[108:111], v[44:47]
    ds_read_b64_tr_b16 v[246:247], v3 offset:14848
    s_add_u32 s9, s46, 0xa42000
    buffer_load_dwordx4 v[132:135], v13, s[12:15], s9 offen offset:256 sc1
    s_waitcnt lgkmcnt(4)
    v_mfma_f32_16x16x32_bf16 v[48:51], v[252:255], v[104:107], v[48:51]
    ds_read_b64_tr_b16 v[248:249], v4 offset:4608
    v_mfma_f32_16x16x32_bf16 v[52:55], v[252:255], v[108:111], v[52:55]
    ds_read_b64_tr_b16 v[250:251], v4 offset:6656
    s_waitcnt lgkmcnt(4)
    v_mfma_f32_16x16x32_bf16 v[56:59], v[240:243], v[104:107], v[56:59]
    ds_read_b64_tr_b16 v[252:253], v4 offset:12800
    v_mfma_f32_16x16x32_bf16 v[60:63], v[240:243], v[108:111], v[60:63]
    ds_read_b64_tr_b16 v[254:255], v4 offset:14848
    s_waitcnt lgkmcnt(4)
    v_mfma_f32_16x16x32_bf16 v[64:67], v[244:247], v[104:107], v[64:67]
    ds_read_b64_tr_b16 v[240:241], v3 offset:16384
    s_add_u32 s9, s46, 0xa42000
    buffer_load_dwordx4 v[136:139], v13, s[12:15], s9 offen offset:2048 sc1
    v_mfma_f32_16x16x32_bf16 v[68:71], v[244:247], v[108:111], v[68:71]
    ds_read_b64_tr_b16 v[242:243], v3 offset:18432
    s_waitcnt vmcnt(6)
    v_max_u32 v15, v112, v113
    s_waitcnt lgkmcnt(4)
    v_mfma_f32_16x16x32_bf16 v[72:75], v[248:251], v[104:107], v[72:75]
    ds_read_b64_tr_b16 v[244:245], v3 offset:24576
    v_max3_u32 v15, v114, v115, v15
    v_mfma_f32_16x16x32_bf16 v[76:79], v[248:251], v[108:111], v[76:79]
    ds_read_b64_tr_b16 v[246:247], v3 offset:26624
    v_max3_u32 v15, v116, v117, v15
    s_waitcnt lgkmcnt(4)
    v_mfma_f32_16x16x32_bf16 v[80:83], v[252:255], v[104:107], v[80:83]
    ds_read_b64_tr_b16 v[248:249], v4 offset:16384
    s_xor_b32 s9, s48, 0xa000
    buffer_store_dwordx4 v[92:95], v12, s[12:15], s9 offen sc1
    v_mfma_f32_16x16x32_bf16 v[84:87], v[252:255], v[108:111], v[84:87]
    ds_read_b64_tr_b16 v[250:251], v4 offset:18432
    v_max3_u32 v15, v118, v119, v15
    v_cmp_eq_u32 vcc, -1, v15
    s_cbranch_vccnz sequential_preLN__sliding_block__glu_gated_bilinear__prompt_kernel_retry55
sequential_preLN__sliding_block__glu_gated_bilinear__prompt_kernel_ok56:
    s_waitcnt lgkmcnt(4)
    v_mfma_f32_16x16x32_bf16 v[24:27], v[240:243], v[112:115], v[24:27]
    ds_read_b64_tr_b16 v[252:253], v4 offset:24576
    v_mfma_f32_16x16x32_bf16 v[28:31], v[240:243], v[116:119], v[28:31]
    ds_read_b64_tr_b16 v[254:255], v4 offset:26624
    s_add_u32 s9, s46, 0xa42000
    buffer_load_dwordx4 v[140:143], v13, s[12:15], s9 offen offset:2304 sc1
    s_waitcnt lgkmcnt(4)
    v_mfma_f32_16x16x32_bf16 v[32:35], v[244:247], v[112:115], v[32:35]
    ds_read_b64_tr_b16 v[240:241], v3 offset:16896
    v_mfma_f32_16x16x32_bf16 v[36:39], v[244:247], v[116:119], v[36:39]
    ds_read_b64_tr_b16 v[242:243], v3 offset:18944
    s_waitcnt lgkmcnt(4)
    v_mfma_f32_16x16x32_bf16 v[40:43], v[248:251], v[112:115], v[40:43]
    ds_read_b64_tr_b16 v[244:245], v3 offset:25088
    v_mfma_f32_16x16x32_bf16 v[44:47], v[248:251], v[116:119], v[44:47]
    ds_read_b64_tr_b16 v[246:247], v3 offset:27136
    s_waitcnt lgkmcnt(4)
    v_mfma_f32_16x16x32_bf16 v[48:51], v[252:255], v[112:115], v[48:51]
    ds_read_b64_tr_b16 v[248:249], v4 offset:16896
    v_mfma_f32_16x16x32_bf16 v[52:55], v[252:255], v[116:119], v[52:55]
    ds_read_b64_tr_b16 v[250:251], v4 offset:18944
    s_waitcnt lgkmcnt(4)
    v_mfma_f32_16x16x32_bf16 v[56:59], v[240:243], v[112:115], v[56:59]
    ds_read_b64_tr_b16 v[252:253], v4 offset:25088
    v_mfma_f32_16x16x32_bf16 v[60:63], v[240:243], v[116:119], v[60:63]
    ds_read_b64_tr_b16 v[254:255], v4 offset:27136
    s_add_u32 s9, s46, 0xa43000
    buffer_load_dwordx4 v[144:147], v13, s[12:15], s9 offen offset:0 sc1
    s_waitcnt lgkmcnt(4)
    v_mfma_f32_16x16x32_bf16 v[64:67], v[244:247], v[112:115], v[64:67]
    ds_read_b64_tr_b16 v[240:241], v3 offset:20480
    s_waitcnt vmcnt(6)
    v_mfma_f32_16x16x32_bf16 v[68:71], v[244:247], v[116:119], v[68:71]
    ds_read_b64_tr_b16 v[242:243], v3 offset:22528
    v_max_u32 v15, v120, v121
    s_waitcnt lgkmcnt(4)
    v_mfma_f32_16x16x32_bf16 v[72:75], v[248:251], v[112:115], v[72:75]
    ds_read_b64_tr_b16 v[244:245], v3 offset:28672
    v_max3_u32 v15, v122, v123, v15
    v_mfma_f32_16x16x32_bf16 v[76:79], v[248:251], v[116:119], v[76:79]
    ds_read_b64_tr_b16 v[246:247], v3 offset:30720
    v_max3_u32 v15, v124, v125, v15
    s_waitcnt lgkmcnt(4)
    v_mfma_f32_16x16x32_bf16 v[80:83], v[252:255], v[112:115], v[80:83]
    ds_read_b64_tr_b16 v[248:249], v4 offset:20480
    s_add_u32 s9, s46, 0xa43000
    buffer_load_dwordx4 v[148:151], v13, s[12:15], s9 offen offset:256 sc1
    v_mfma_f32_16x16x32_bf16 v[84:87], v[252:255], v[116:119], v[84:87]
    ds_read_b64_tr_b16 v[250:251], v4 offset:22528
    v_max3_u32 v15, v126, v127, v15
    v_cmp_eq_u32 vcc, -1, v15
    s_cbranch_vccnz sequential_preLN__sliding_block__glu_gated_bilinear__prompt_kernel_retry57
sequential_preLN__sliding_block__glu_gated_bilinear__prompt_kernel_ok58:
    s_waitcnt lgkmcnt(4)
    v_mfma_f32_16x16x32_bf16 v[24:27], v[240:243], v[120:123], v[24:27]
    ds_read_b64_tr_b16 v[252:253], v4 offset:28672
    v_mfma_f32_16x16x32_bf16 v[28:31], v[240:243], v[124:127], v[28:31]
    ds_read_b64_tr_b16 v[254:255], v4 offset:30720
    s_waitcnt lgkmcnt(4)
    v_mfma_f32_16x16x32_bf16 v[32:35], v[244:247], v[120:123], v[32:35]
    ds_read_b64_tr_b16 v[240:241], v3 offset:20992
    v_mfma_f32_16x16x32_bf16 v[36:39], v[244:247], v[124:127], v[36:39]
    ds_read_b64_tr_b16 v[242:243], v3 offset:23040
    s_waitcnt lgkmcnt(4)
    v_mfma_f32_16x16x32_bf16 v[40:43], v[248:251], v[120:123], v[40:43]
    ds_read_b64_tr_b16 v[244:245], v3 offset:29184
    v_mfma_f32_16x16x32_bf16 v[44:47], v[248:251], v[124:127], v[44:47]
    ds_read_b64_tr_b16 v[246:247], v3 offset:31232
    s_add_u32 s9, s46, 0xa43000
    buffer_load_dwordx4 v[152:155], v13, s[12:15], s9 offen offset:2048 sc1
    s_waitcnt lgkmcnt(4)
    v_mfma_f32_16x16x32_bf16 v[48:51], v[252:255], v[120:123], v[48:51]
    ds_read_b64_tr_b16 v[248:249], v4 offset:20992
    v_mfma_f32_16x16x32_bf16 v[52:55], v[252:255], v[124:127], v[52:55]
    ds_read_b64_tr_b16 v[250:251], v4 offset:23040
    s_waitcnt lgkmcnt(4)
    v_mfma_f32_16x16x32_bf16 v[56:59], v[240:243], v[120:123], v[56:59]
    ds_read_b64_tr_b16 v[252:253], v4 offset:29184
    v_mfma_f32_16x16x32_bf16 v[60:63], v[240:243], v[124:127], v[60:63]
    ds_read_b64_tr_b16 v[254:255], v4 offset:31232
    s_waitcnt lgkmcnt(4)
    v_mfma_f32_16x16x32_bf16 v[64:67], v[244:247], v[120:123], v[64:67]
    ds_read_b64_tr_b16 v[240:241], v3 offset:32768
    s_waitcnt vmcnt(6)
    v_mfma_f32_16x16x32_bf16 v[68:71], v[244:247], v[124:127], v[68:71]
    ds_read_b64_tr_b16 v[242:243], v3 offset:34816
    v_max_u32 v15, v128, v129
    s_waitcnt lgkmcnt(4)
    v_mfma_f32_16x16x32_bf16 v[72:75], v[248:251], v[120:123], v[72:75]
    ds_read_b64_tr_b16 v[244:245], v3 offset:40960
    s_xor_b32 s9, s48, 0xc000
    buffer_store_dwordx4 v[92:95], v12, s[12:15], s9 offen sc1
    s_add_u32 s9, s46, 0xa43000
    buffer_load_dwordx4 v[156:159], v13, s[12:15], s9 offen offset:2304 sc1
    v_mfma_f32_16x16x32_bf16 v[76:79], v[248:251], v[124:127], v[76:79]
    ds_read_b64_tr_b16 v[246:247], v3 offset:43008
    v_max3_u32 v15, v130, v131, v15
    v_max3_u32 v15, v132, v133, v15
    s_waitcnt lgkmcnt(4)
    v_mfma_f32_16x16x32_bf16 v[80:83], v[252:255], v[120:123], v[80:83]
    ds_read_b64_tr_b16 v[248:249], v4 offset:32768
    v_max3_u32 v15, v134, v135, v15
    v_mfma_f32_16x16x32_bf16 v[84:87], v[252:255], v[124:127], v[84:87]
    ds_read_b64_tr_b16 v[250:251], v4 offset:34816
    v_cmp_eq_u32 vcc, -1, v15
    s_cbranch_vccnz sequential_preLN__sliding_block__glu_gated_bilinear__prompt_kernel_retry59
sequential_preLN__sliding_block__glu_gated_bilinear__prompt_kernel_ok60:
    s_waitcnt lgkmcnt(4)
    v_mfma_f32_16x16x32_bf16 v[24:27], v[240:243], v[128:131], v[24:27]
    ds_read_b64_tr_b16 v[252:253], v4 offset:40960
    v_mfma_f32_16x16x32_bf16 v[28:31], v[240:243], v[132:135], v[28:31]
    ds_read_b64_tr_b16 v[254:255], v4 offset:43008
    s_waitcnt lgkmcnt(4)
    v_mfma_f32_16x16x32_bf16 v[32:35], v[244:247], v[128:131], v[32:35]
    ds_read_b64_tr_b16 v[240:241], v3 offset:33280
    v_mfma_f32_16x16x32_bf16 v[36:39], v[244:247], v[132:135], v[36:39]
    ds_read_b64_tr_b16 v[242:243], v3 offset:35328
    s_add_u32 s9, s46, 0xa44000
    buffer_load_dwordx4 v[160:163], v13, s[12:15], s9 offen offset:0 sc1
    s_waitcnt lgkmcnt(4)
    v_mfma_f32_16x16x32_bf16 v[40:43], v[248:251], v[128:131], v[40:43]
    ds_read_b64_tr_b16 v[244:245], v3 offset:41472
    v_mfma_f32_16x16x32_bf16 v[44:47], v[248:251], v[132:135], v[44:47]
    ds_read_b64_tr_b16 v[246:247], v3 offset:43520
    s_waitcnt lgkmcnt(4)
    v_mfma_f32_16x16x32_bf16 v[48:51], v[252:255], v[128:131], v[48:51]
    ds_read_b64_tr_b16 v[248:249], v4 offset:33280
    v_mfma_f32_16x16x32_bf16 v[52:55], v[252:255], v[132:135], v[52:55]
    ds_read_b64_tr_b16 v[250:251], v4 offset:35328
    s_waitcnt lgkmcnt(4)
    v_mfma_f32_16x16x32_bf16 v[56:59], v[240:243], v[128:131], v[56:59]
    ds_read_b64_tr_b16 v[252:253], v4 offset:41472
    v_mfma_f32_16x16x32_bf16 v[60:63], v[240:243], v[132:135], v[60:63]
    ds_read_b64_tr_b16 v[254:255], v4 offset:43520
    s_add_u32 s9, s46, 0xa44000
    buffer_load_dwordx4 v[164:167], v13, s[12:15], s9 offen offset:256 sc1
    s_waitcnt lgkmcnt(4)
    v_mfma_f32_16x16x32_bf16 v[64:67], v[244:247], v[128:131], v[64:67]
    ds_read_b64_tr_b16 v[240:241], v3 offset:36864
    s_waitcnt vmcnt(7)
    v_mfma_f32_16x16x32_bf16 v[68:71], v[244:247], v[132:135], v[68:71]
    ds_read_b64_tr_b16 v[242:243], v3 offset:38912
    v_max_u32 v15, v136, v137
    s_waitcnt lgkmcnt(4)
    v_mfma_f32_16x16x32_bf16 v[72:75], v[248:251], v[128:131], v[72:75]
    ds_read_b64_tr_b16 v[244:245], v3 offset:45056
    v_max3_u32 v15, v138, v139, v15
    v_mfma_f32_16x16x32_bf16 v[76:79], v[248:251], v[132:135], v[76:79]
    ds_read_b64_tr_b16 v[246:247], v3 offset:47104
    v_max3_u32 v15, v140, v141, v15
    s_waitcnt lgkmcnt(4)
    v_mfma_f32_16x16x32_bf16 v[80:83], v[252:255], v[128:131], v[80:83]
    ds_read_b64_tr_b16 v[248:249], v4 offset:36864
    v_max3_u32 v15, v142, v143, v15
    v_mfma_f32_16x16x32_bf16 v[84:87], v[252:255], v[132:135], v[84:87]
    ds_read_b64_tr_b16 v[250:251], v4 offset:38912
    v_cmp_eq_u32 vcc, -1, v15
    s_cbranch_vccnz sequential_preLN__sliding_block__glu_gated_bilinear__prompt_kernel_retry61
sequential_preLN__sliding_block__glu_gated_bilinear__prompt_kernel_ok62:
    s_waitcnt lgkmcnt(4)
    v_mfma_f32_16x16x32_bf16 v[24:27], v[240:243], v[136:139], v[24:27]
    ds_read_b64_tr_b16 v[252:253], v4 offset:45056
    v_mfma_f32_16x16x32_bf16 v[28:31], v[240:243], v[140:143], v[28:31]
    ds_read_b64_tr_b16 v[254:255], v4 offset:47104
    s_add_u32 s9, s46, 0xa44000
    buffer_load_dwordx4 v[168:171], v13, s[12:15], s9 offen offset:2048 sc1
    s_waitcnt lgkmcnt(4)
    v_mfma_f32_16x16x32_bf16 v[32:35], v[244:247], v[136:139], v[32:35]
    ds_read_b64_tr_b16 v[240:241], v3 offset:37376
    v_mfma_f32_16x16x32_bf16 v[36:39], v[244:247], v[140:143], v[36:39]
    ds_read_b64_tr_b16 v[242:243], v3 offset:39424
    s_waitcnt lgkmcnt(4)
    v_mfma_f32_16x16x32_bf16 v[40:43], v[248:251], v[136:139], v[40:43]
    ds_read_b64_tr_b16 v[244:245], v3 offset:45568
    v_mfma_f32_16x16x32_bf16 v[44:47], v[248:251], v[140:143], v[44:47]
    ds_read_b64_tr_b16 v[246:247], v3 offset:47616
    s_waitcnt lgkmcnt(4)
    v_mfma_f32_16x16x32_bf16 v[48:51], v[252:255], v[136:139], v[48:51]
    ds_read_b64_tr_b16 v[248:249], v4 offset:37376
    v_mfma_f32_16x16x32_bf16 v[52:55], v[252:255], v[140:143], v[52:55]
    ds_read_b64_tr_b16 v[250:251], v4 offset:39424
    s_add_u32 s9, s46, 0xa44000
    buffer_load_dwordx4 v[172:175], v13, s[12:15], s9 offen offset:2304 sc1
    s_waitcnt lgkmcnt(4)
    v_mfma_f32_16x16x32_bf16 v[56:59], v[240:243], v[136:139], v[56:59]
    ds_read_b64_tr_b16 v[252:253], v4 offset:45568
    v_mfma_f32_16x16x32_bf16 v[60:63], v[240:243], v[140:143], v[60:63]
    ds_read_b64_tr_b16 v[254:255], v4 offset:47616
    s_waitcnt lgkmcnt(4)
    v_mfma_f32_16x16x32_bf16 v[64:67], v[244:247], v[136:139], v[64:67]
    s_xor_b32 s9, s48, 0xe000
    buffer_store_dwordx4 v[92:95], v12, s[12:15], s9 offen sc1
    v_mfma_f32_16x16x32_bf16 v[68:71], v[244:247], v[140:143], v[68:71]
    s_barrier
    ds_read_b64_tr_b16 v[240:241], v3 offset:49152
    ds_read_b64_tr_b16 v[242:243], v3 offset:51200
    s_waitcnt vmcnt(8)
    v_max_u32 v15, v144, v145
    s_waitcnt lgkmcnt(4)
    v_mfma_f32_16x16x32_bf16 v[72:75], v[248:251], v[136:139], v[72:75]
    ds_read_b64_tr_b16 v[244:245], v3 offset:57344
    s_add_u32 s9, s46, 0xa45000
    buffer_load_dwordx4 v[176:179], v13, s[12:15], s9 offen offset:0 sc1
    s_add_u32 s9, s43, 3538944
    s_add_u32 m0, s42, 0
    s_nop 0
    buffer_load_dwordx4 v8, s[16:19], s9 offen  lds
    v_mfma_f32_16x16x32_bf16 v[76:79], v[248:251], v[140:143], v[76:79]
    ds_read_b64_tr_b16 v[246:247], v3 offset:59392
    v_max3_u32 v15, v146, v147, v15
    v_max3_u32 v15, v148, v149, v15
    s_waitcnt lgkmcnt(4)
    v_mfma_f32_16x16x32_bf16 v[80:83], v[252:255], v[136:139], v[80:83]
    ds_read_b64_tr_b16 v[248:249], v4 offset:49152
    v_max3_u32 v15, v150, v151, v15
    v_mfma_f32_16x16x32_bf16 v[84:87], v[252:255], v[140:143], v[84:87]
    ds_read_b64_tr_b16 v[250:251], v4 offset:51200
    v_cmp_eq_u32 vcc, -1, v15
    s_cbranch_vccnz sequential_preLN__sliding_block__glu_gated_bilinear__prompt_kernel_retry63
sequential_preLN__sliding_block__glu_gated_bilinear__prompt_kernel_ok64:
    s_cmp_lg_u32 s36, 0
    s_cbranch_scc1 sequential_preLN__sliding_block__glu_gated_bilinear__prompt_kernel_nq65
    v_lshlrev_b32 v0, 2, v2
    v_add_u32 v0, 156672, v0
pg_9:
    s_cbranch_execz pf_ret
    ds_read2st64_b32 v[88:89], v0 offset0:0 offset1:1
    ds_read2st64_b32 v[90:91], v0 offset0:2 offset1:3
    ds_read2st64_b32 v[92:93], v0 offset0:4 offset1:5
    ds_read2st64_b32 v[94:95], v0 offset0:6 offset1:7
    s_waitcnt lgkmcnt(0)
    v_add_f32 v88, v88, v92
    v_add_f32 v89, v89, v93
    v_add_f32 v90, v90, v94
    v_add_f32 v91, v91, v95
    v_add_f32 v88, v88, v90
    v_add_f32 v89, v89, v91
    v_add_f32 v88, v88, v89
    v_mov_b32 v89, v88
    s_nop 1
    v_permlane32_swap_b32 v88, v89
    v_add_f32 v88, v88, v89
    s_mov_b32 exec_hi, 0
    buffer_store_dword v88, v12, s[12:15], s59 offen sc1
    s_mov_b32 exec_hi, -1
    v_mov_b32 v92, -2
    v_mov_b32 v93, -2
    v_mov_b32 v94, -2
    v_mov_b32 v95, -2
sequential_preLN__sliding_block__glu_gated_bilinear__prompt_kernel_nq65:
    s_waitcnt lgkmcnt(4)
    v_mfma_f32_16x16x32_bf16 v[24:27], v[240:243], v[144:147], v[24:27]
    ds_read_b64_tr_b16 v[252:253], v4 offset:57344
    v_mfma_f32_16x16x32_bf16 v[28:31], v[240:243], v[148:151], v[28:31]
    ds_read_b64_tr_b16 v[254:255], v4 offset:59392
    s_waitcnt lgkmcnt(4)
    v_mfma_f32_16x16x32_bf16 v[32:35], v[244:247], v[144:147], v[32:35]
    ds_read_b64_tr_b16 v[240:241], v3 offset:49664
    v_mfma_f32_16x16x32_bf16 v[36:39], v[244:247], v[148:151], v[36:39]
    ds_read_b64_tr_b16 v[242:243], v3 offset:51712
    s_waitcnt lgkmcnt(4)
    v_mfma_f32_16x16x32_bf16 v[40:43], v[248:251], v[144:147], v[40:43]
    ds_read_b64_tr_b16 v[244:245], v3 offset:57856
    v_mfma_f32_16x16x32_bf16 v[44:47], v[248:251], v[148:151], v[44:47]
    ds_read_b64_tr_b16 v[246:247], v3 offset:59904
    s_add_u32 s9, s46, 0xa45000
    buffer_load_dwordx4 v[180:183], v13, s[12:15], s9 offen offset:256 sc1
    s_waitcnt lgkmcnt(4)
    v_mfma_f32_16x16x32_bf16 v[48:51], v[252:255], v[144:147], v[48:51]
    ds_read_b64_tr_b16 v[248:249], v4 offset:49664
    v_mfma_f32_16x16x32_bf16 v[52:55], v[252:255], v[148:151], v[52:55]
    ds_read_b64_tr_b16 v[250:251], v4 offset:51712
    s_add_u32 s9, s43, 3538944
    s_add_u32 m0, s42, 8192
    s_nop 0
    buffer_load_dwordx4 v8, s[20:23], s9 offen  lds
    s_waitcnt lgkmcnt(4)
    v_mfma_f32_16x16x32_bf16 v[56:59], v[240:243], v[144:147], v[56:59]
    ds_read_b64_tr_b16 v[252:253], v4 offset:57856
    v_mfma_f32_16x16x32_bf16 v[60:63], v[240:243], v[148:151], v[60:63]
    ds_read_b64_tr_b16 v[254:255], v4 offset:59904
    s_waitcnt lgkmcnt(4)
    v_mfma_f32_16x16x32_bf16 v[64:67], v[244:247], v[144:147], v[64:67]
    ds_read_b64_tr_b16 v[240:241], v3 offset:53248
    s_add_u32 s9, s46, 0xa45000
    buffer_load_dwordx4 v[184:187], v13, s[12:15], s9 offen offset:2048 sc1
    v_mfma_f32_16x16x32_bf16 v[68:71], v[244:247], v[148:151], v[68:71]
    ds_read_b64_tr_b16 v[242:243], v3 offset:55296
    s_waitcnt vmcnt(10)
    v_max_u32 v15, v152, v153
    s_waitcnt lgkmcnt(4)
    v_mfma_f32_16x16x32_bf16 v[72:75], v[248:251], v[144:147], v[72:75]
    ds_read_b64_tr_b16 v[244:245], v3 offset:61440
    v_max3_u32 v15, v154, v155, v15
    v_mfma_f32_16x16x32_bf16 v[76:79], v[248:251], v[148:151], v[76:79]
    ds_read_b64_tr_b16 v[246:247], v3 offset:63488
    v_max3_u32 v15, v156, v157, v15
    s_waitcnt lgkmcnt(4)
    v_mfma_f32_16x16x32_bf16 v[80:83], v[252:255], v[144:147], v[80:83]
    ds_read_b64_tr_b16 v[248:249], v4 offset:53248
    v_max3_u32 v15, v158, v159, v15
    v_mfma_f32_16x16x32_bf16 v[84:87], v[252:255], v[148:151], v[84:87]
    ds_read_b64_tr_b16 v[250:251], v4 offset:55296
    v_cmp_eq_u32 vcc, -1, v15
    s_cbranch_vccnz sequential_preLN__sliding_block__glu_gated_bilinear__prompt_kernel_retry66
sequential_preLN__sliding_block__glu_gated_bilinear__prompt_kernel_ok67:
    s_waitcnt lgkmcnt(4)
    v_mfma_f32_16x16x32_bf16 v[24:27], v[240:243], v[152:155], v[24:27]
    ds_read_b64_tr_b16 v[252:253], v4 offset:61440
    s_add_u32 s9, s46, 0xa45000
    buffer_load_dwordx4 v[188:191], v13, s[12:15], s9 offen offset:2304 sc1
    v_mfma_f32_16x16x32_bf16 v[28:31], v[240:243], v[156:159], v[28:31]
    ds_read_b64_tr_b16 v[254:255], v4 offset:63488
    s_add_u32 s9, s43, 4128768
    s_add_u32 m0, s42, 16384
    s_nop 0
    buffer_load_dwordx4 v8, s[16:19], s9 offen  lds
    s_waitcnt lgkmcnt(4)
    v_mfma_f32_16x16x32_bf16 v[32:35], v[244:247], v[152:155], v[32:35]
    ds_read_b64_tr_b16 v[240:241], v3 offset:53760
    v_mfma_f32_16x16x32_bf16 v[36:39], v[244:247], v[156:159], v[36:39]
    ds_read_b64_tr_b16 v[242:243], v3 offset:55808
    s_waitcnt lgkmcnt(4)
    v_mfma_f32_16x16x32_bf16 v[40:43], v[248:251], v[152:155], v[40:43]
    ds_read_b64_tr_b16 v[244:245], v3 offset:61952
    v_mfma_f32_16x16x32_bf16 v[44:47], v[248:251], v[156:159], v[44:47]
    ds_read_b64_tr_b16 v[246:247], v3 offset:64000
    s_waitcnt lgkmcnt(4)
    v_mfma_f32_16x16x32_bf16 v[48:51], v[252:255], v[152:155], v[48:51]
    ds_read_b64_tr_b16 v[248:249], v4 offset:53760
    v_mfma_f32_16x16x32_bf16 v[52:55], v[252:255], v[156:159], v[52:55]
    ds_read_b64_tr_b16 v[250:251], v4 offset:55808
    s_waitcnt lgkmcnt(4)
    v_mfma_f32_16x16x32_bf16 v[56:59], v[240:243], v[152:155], v[56:59]
    ds_read_b64_tr_b16 v[252:253], v4 offset:61952
    v_mfma_f32_16x16x32_bf16 v[60:63], v[240:243], v[156:159], v[60:63]
    ds_read_b64_tr_b16 v[254:255], v4 offset:64000
    s_add_u32 s9, s46, 0xa46000
    buffer_load_dwordx4 v[192:195], v13, s[12:15], s9 offen offset:0 sc1
    s_waitcnt lgkmcnt(4)
    v_mfma_f32_16x16x32_bf16 v[64:67], v[244:247], v[152:155], v[64:67]
    ds_read_b64_tr_b16 v[240:241], v5 offset:0
    s_add_u32 s9, s43, 4128768
    s_add_u32 m0, s42, 24576
    s_nop 0
    buffer_load_dwordx4 v8, s[20:23], s9 offen  lds
    v_mfma_f32_16x16x32_bf16 v[68:71], v[244:247], v[156:159], v[68:71]
    ds_read_b64_tr_b16 v[242:243], v5 offset:2048
    s_waitcnt vmcnt(12)
    v_max_u32 v15, v160, v161
    s_waitcnt lgkmcnt(4)
    v_mfma_f32_16x16x32_bf16 v[72:75], v[248:251], v[152:155], v[72:75]
    ds_read_b64_tr_b16 v[244:245], v5 offset:8192
    v_max3_u32 v15, v162, v163, v15
    v_mfma_f32_16x16x32_bf16 v[76:79], v[248:251], v[156:159], v[76:79]
    ds_read_b64_tr_b16 v[246:247], v5 offset:10240
    v_max3_u32 v15, v164, v165, v15
    s_waitcnt lgkmcnt(4)
    v_mfma_f32_16x16x32_bf16 v[80:83], v[252:255], v[152:155], v[80:83]
    ds_read_b64_tr_b16 v[248:249], v6 offset:0
    s_add_u32 s9, s46, 0xa46000
    buffer_load_dwordx4 v[196:199], v13, s[12:15], s9 offen offset:256 sc1
    v_mfma_f32_16x16x32_bf16 v[84:87], v[252:255], v[156:159], v[84:87]
    ds_read_b64_tr_b16 v[250:251], v6 offset:2048
    v_max3_u32 v15, v166, v167, v15
    v_cmp_eq_u32 vcc, -1, v15
    s_cbranch_vccnz sequential_preLN__sliding_block__glu_gated_bilinear__prompt_kernel_retry68
sequential_preLN__sliding_block__glu_gated_bilinear__prompt_kernel_ok69:
    s_waitcnt lgkmcnt(4)
    v_mfma_f32_16x16x32_bf16 v[24:27], v[240:243], v[160:163], v[24:27]
    ds_read_b64_tr_b16 v[252:253], v6 offset:8192
    v_mfma_f32_16x16x32_bf16 v[28:31], v[240:243], v[164:167], v[28:31]
    ds_read_b64_tr_b16 v[254:255], v6 offset:10240
    s_waitcnt lgkmcnt(4)
    v_mfma_f32_16x16x32_bf16 v[32:35], v[244:247], v[160:163], v[32:35]
    ds_read_b64_tr_b16 v[240:241], v5 offset:512
    v_mfma_f32_16x16x32_bf16 v[36:39], v[244:247], v[164:167], v[36:39]
    ds_read_b64_tr_b16 v[242:243], v5 offset:2560
    s_waitcnt lgkmcnt(4)
    v_mfma_f32_16x16x32_bf16 v[40:43], v[248:251], v[160:163], v[40:43]
    ds_read_b64_tr_b16 v[244:245], v5 offset:8704
    s_add_u32 s9, s46, 0xa46000
    buffer_load_dwordx4 v[200:203], v13, s[12:15], s9 offen offset:2048 sc1
    v_mfma_f32_16x16x32_bf16 v[44:47], v[248:251], v[164:167], v[44:47]
    ds_read_b64_tr_b16 v[246:247], v5 offset:10752
    s_add_u32 s9, s43, 4718592
    s_add_u32 m0, s42, 32768
    s_nop 0
    buffer_load_dwordx4 v8, s[16:19], s9 offen  lds
    s_waitcnt lgkmcnt(4)
    v_mfma_f32_16x16x32_bf16 v[48:51], v[252:255], v[160:163], v[48:51]
    ds_read_b64_tr_b16 v[248:249], v6 offset:512
    v_mfma_f32_16x16x32_bf16 v[52:55], v[252:255], v[164:167], v[52:55]
    ds_read_b64_tr_b16 v[250:251], v6 offset:2560
    s_waitcnt lgkmcnt(4)
    v_mfma_f32_16x16x32_bf16 v[56:59], v[240:243], v[160:163], v[56:59]
    ds_read_b64_tr_b16 v[252:253], v6 offset:8704
    v_mfma_f32_16x16x32_bf16 v[60:63], v[240:243], v[164:167], v[60:63]
    ds_read_b64_tr_b16 v[254:255], v6 offset:10752
    s_waitcnt lgkmcnt(4)
    v_mfma_f32_16x16x32_bf16 v[64:67], v[244:247], v[160:163], v[64:67]
    ds_read_b64_tr_b16 v[240:241], v5 offset:4096
    s_waitcnt vmcnt(13)
    v_mfma_f32_16x16x32_bf16 v[68:71], v[244:247], v[164:167], v[68:71]
    ds_read_b64_tr_b16 v[242:243], v5 offset:6144
    v_max_u32 v15, v168, v169
    s_waitcnt lgkmcnt(4)
    v_mfma_f32_16x16x32_bf16 v[72:75], v[248:251], v[160:163], v[72:75]
    ds_read_b64_tr_b16 v[244:245], v5 offset:12288
    s_add_u32 s9, s46, 0xa46000
    buffer_load_dwordx4 v[204:207], v13, s[12:15], s9 offen offset:2304 sc1
    v_mfma_f32_16x16x32_bf16 v[76:79], v[248:251], v[164:167], v[76:79]
    ds_read_b64_tr_b16 v[246:247], v5 offset:14336
    v_max3_u32 v15, v170, v171, v15
    v_max3_u32 v15, v172, v173, v15
    s_waitcnt lgkmcnt(4)
    v_mfma_f32_16x16x32_bf16 v[80:83], v[252:255], v[160:163], v[80:83]
    ds_read_b64_tr_b16 v[248:249], v6 offset:4096
    s_add_u32 s9, s43, 4718592
    s_add_u32 m0, s42, 40960
    s_nop 0
    buffer_load_dwordx4 v8, s[20:23], s9 offen  lds
    v_mfma_f32_16x16x32_bf16 v[84:87], v[252:255], v[164:167], v[84:87]
    ds_read_b64_tr_b16 v[250:251], v6 offset:6144
    v_max3_u32 v15, v174, v175, v15
    v_cmp_eq_u32 vcc, -1, v15
    s_cbranch_vccnz sequential_preLN__sliding_block__glu_gated_bilinear__prompt_kernel_retry70
sequential_preLN__sliding_block__glu_gated_bilinear__prompt_kernel_ok71:
    s_waitcnt lgkmcnt(4)
    v_mfma_f32_16x16x32_bf16 v[24:27], v[240:243], v[168:171], v[24:27]
    ds_read_b64_tr_b16 v[252:253], v6 offset:12288
    v_mfma_f32_16x16x32_bf16 v[28:31], v[240:243], v[172:175], v[28:31]
    ds_read_b64_tr_b16 v[254:255], v6 offset:14336
    s_waitcnt lgkmcnt(4)
    v_mfma_f32_16x16x32_bf16 v[32:35], v[244:247], v[168:171], v[32:35]
    ds_read_b64_tr_b16 v[240:241], v5 offset:4608
    v_mfma_f32_16x16x32_bf16 v[36:39], v[244:247], v[172:175], v[36:39]
    ds_read_b64_tr_b16 v[242:243], v5 offset:6656
    s_add_u32 s9, s46, 0xa47000
    buffer_load_dwordx4 v[208:211], v13, s[12:15], s9 offen offset:0 sc1
    s_waitcnt lgkmcnt(4)
    v_mfma_f32_16x16x32_bf16 v[40:43], v[248:251], v[168:171], v[40:43]
    ds_read_b64_tr_b16 v[244:245], v5 offset:12800
    v_mfma_f32_16x16x32_bf16 v[44:47], v[248:251], v[172:175], v[44:47]
    ds_read_b64_tr_b16 v[246:247], v5 offset:14848
    s_waitcnt lgkmcnt(4)
    v_mfma_f32_16x16x32_bf16 v[48:51], v[252:255], v[168:171], v[48:51]
    ds_read_b64_tr_b16 v[248:249], v6 offset:4608
    v_mfma_f32_16x16x32_bf16 v[52:55], v[252:255], v[172:175], v[52:55]
    ds_read_b64_tr_b16 v[250:251], v6 offset:6656
    s_waitcnt lgkmcnt(4)
    v_mfma_f32_16x16x32_bf16 v[56:59], v[240:243], v[168:171], v[56:59]
    ds_read_b64_tr_b16 v[252:253], v6 offset:12800
    v_mfma_f32_16x16x32_bf16 v[60:63], v[240:243], v[172:175], v[60:63]
    ds_read_b64_tr_b16 v[254:255], v6 offset:14848
    s_add_u32 s9, s46, 0xa47000
    buffer_load_dwordx4 v[212:215], v13, s[12:15], s9 offen offset:256 sc1
    s_waitcnt lgkmcnt(4)
    v_mfma_f32_16x16x32_bf16 v[64:67], v[244:247], v[168:171], v[64:67]
    ds_read_b64_tr_b16 v[240:241], v5 offset:16384
    s_waitcnt vmcnt(13)
    v_mfma_f32_16x16x32_bf16 v[68:71], v[244:247], v[172:175], v[68:71]
    ds_read_b64_tr_b16 v[242:243], v5 offset:18432
    v_max_u32 v15, v176, v177
    s_waitcnt lgkmcnt(4)
    v_mfma_f32_16x16x32_bf16 v[72:75], v[248:251], v[168:171], v[72:75]
    ds_read_b64_tr_b16 v[244:245], v5 offset:24576
    v_max3_u32 v15, v178, v179, v15
    v_mfma_f32_16x16x32_bf16 v[76:79], v[248:251], v[172:175], v[76:79]
    ds_read_b64_tr_b16 v[246:247], v5 offset:26624
    v_max3_u32 v15, v180, v181, v15
    s_waitcnt lgkmcnt(4)
    v_mfma_f32_16x16x32_bf16 v[80:83], v[252:255], v[168:171], v[80:83]
    ds_read_b64_tr_b16 v[248:249], v6 offset:16384
    v_max3_u32 v15, v182, v183, v15
    v_mfma_f32_16x16x32_bf16 v[84:87], v[252:255], v[172:175], v[84:87]
    ds_read_b64_tr_b16 v[250:251], v6 offset:18432
    v_cmp_eq_u32 vcc, -1, v15
    s_cbranch_vccnz sequential_preLN__sliding_block__glu_gated_bilinear__prompt_kernel_retry72
sequential_preLN__sliding_block__glu_gated_bilinear__prompt_kernel_ok73:
    s_waitcnt lgkmcnt(4)
    v_mfma_f32_16x16x32_bf16 v[24:27], v[240:243], v[176:179], v[24:27]
    ds_read_b64_tr_b16 v[252:253], v6 offset:24576
    v_mfma_f32_16x16x32_bf16 v[28:31], v[240:243], v[180:183], v[28:31]
    ds_read_b64_tr_b16 v[254:255], v6 offset:26624
    s_add_u32 s9, s46, 0xa47000
    buffer_load_dwordx4 v[216:219], v13, s[12:15], s9 offen offset:2048 sc1
    s_waitcnt lgkmcnt(4)
    v_mfma_f32_16x16x32_bf16 v[32:35], v[244:247], v[176:179], v[32:35]
    ds_read_b64_tr_b16 v[240:241], v5 offset:16896
    v_mfma_f32_16x16x32_bf16 v[36:39], v[244:247], v[180:183], v[36:39]
    ds_read_b64_tr_b16 v[242:243], v5 offset:18944
    s_waitcnt lgkmcnt(4)
    v_mfma_f32_16x16x32_bf16 v[40:43], v[248:251], v[176:179], v[40:43]
    ds_read_b64_tr_b16 v[244:245], v5 offset:25088
    v_mfma_f32_16x16x32_bf16 v[44:47], v[248:251], v[180:183], v[44:47]
    ds_read_b64_tr_b16 v[246:247], v5 offset:27136
    s_waitcnt lgkmcnt(4)
    v_mfma_f32_16x16x32_bf16 v[48:51], v[252:255], v[176:179], v[48:51]
    ds_read_b64_tr_b16 v[248:249], v6 offset:16896
    v_mfma_f32_16x16x32_bf16 v[52:55], v[252:255], v[180:183], v[52:55]
    ds_read_b64_tr_b16 v[250:251], v6 offset:18944
    s_add_u32 s9, s46, 0xa47000
    buffer_load_dwordx4 v[220:223], v13, s[12:15], s9 offen offset:2304 sc1
    s_waitcnt lgkmcnt(4)
    v_mfma_f32_16x16x32_bf16 v[56:59], v[240:243], v[176:179], v[56:59]
    ds_read_b64_tr_b16 v[252:253], v6 offset:25088
    v_mfma_f32_16x16x32_bf16 v[60:63], v[240:243], v[180:183], v[60:63]
    ds_read_b64_tr_b16 v[254:255], v6 offset:27136
    s_waitcnt lgkmcnt(4)
    v_mfma_f32_16x16x32_bf16 v[64:67], v[244:247], v[176:179], v[64:67]
    ds_read_b64_tr_b16 v[240:241], v5 offset:20480
    s_waitcnt vmcnt(12)
    v_mfma_f32_16x16x32_bf16 v[68:71], v[244:247], v[180:183], v[68:71]
    ds_read_b64_tr_b16 v[242:243], v5 offset:22528
    v_max_u32 v15, v184, v185
    s_waitcnt lgkmcnt(4)
    v_mfma_f32_16x16x32_bf16 v[72:75], v[248:251], v[176:179], v[72:75]
    ds_read_b64_tr_b16 v[244:245], v5 offset:28672
    s_add_u32 s9, s46, 0xa48000
    buffer_load_dwordx4 v[224:227], v13, s[12:15], s9 offen offset:0 sc1
    s_cmp_ge_u32 s36, 4
    s_cbranch_scc1 sequential_preLN__sliding_block__glu_gated_bilinear__prompt_kernel_r274
    s_add_u32 s9, s53, 32768
    s_add_u32 m0, s41, 131072
    s_nop 0
    buffer_load_dwordx4 v10, s[12:15], s9 offen sc1 lds
sequential_preLN__sliding_block__glu_gated_bilinear__prompt_kernel_r274:
    v_mfma_f32_16x16x32_bf16 v[76:79], v[248:251], v[180:183], v[76:79]
    ds_read_b64_tr_b16 v[246:247], v5 offset:30720
    v_max3_u32 v15, v186, v187, v15
    v_max3_u32 v15, v188, v189, v15
    s_waitcnt lgkmcnt(4)
    v_mfma_f32_16x16x32_bf16 v[80:83], v[252:255], v[176:179], v[80:83]
    ds_read_b64_tr_b16 v[248:249], v6 offset:20480
    v_max3_u32 v15, v190, v191, v15
    v_mfma_f32_16x16x32_bf16 v[84:87], v[252:255], v[180:183], v[84:87]
    ds_read_b64_tr_b16 v[250:251], v6 offset:22528
    v_cmp_eq_u32 vcc, -1, v15
    s_cbranch_vccnz sequential_preLN__sliding_block__glu_gated_bilinear__prompt_kernel_retry75
sequential_preLN__sliding_block__glu_gated_bilinear__prompt_kernel_ok76:
    s_waitcnt lgkmcnt(4)
    v_mfma_f32_16x16x32_bf16 v[24:27], v[240:243], v[184:187], v[24:27]
    ds_read_b64_tr_b16 v[252:253], v6 offset:28672
    v_mfma_f32_16x16x32_bf16 v[28:31], v[240:243], v[188:191], v[28:31]
    ds_read_b64_tr_b16 v[254:255], v6 offset:30720
    s_waitcnt lgkmcnt(4)
    v_mfma_f32_16x16x32_bf16 v[32:35], v[244:247], v[184:187], v[32:35]
    ds_read_b64_tr_b16 v[240:241], v5 offset:20992
    v_mfma_f32_16x16x32_bf16 v[36:39], v[244:247], v[188:191], v[36:39]
    ds_read_b64_tr_b16 v[242:243], v5 offset:23040
    s_waitcnt lgkmcnt(4)
    v_mfma_f32_16x16x32_bf16 v[40:43], v[248:251], v[184:187], v[40:43]
    ds_read_b64_tr_b16 v[244:245], v5 offset:29184
    s_add_u32 s9, s46, 0xa48000
    buffer_load_dwordx4 v[228:231], v13, s[12:15], s9 offen offset:256 sc1
    v_mfma_f32_16x16x32_bf16 v[44:47], v[248:251], v[188:191], v[44:47]
    ds_read_b64_tr_b16 v[246:247], v5 offset:31232
    s_add_u32 s9, s53, 0
    s_add_u32 m0, s41, 98304
    s_nop 0
    buffer_load_dwordx4 v10, s[12:15], s9 offen sc1 lds
    s_waitcnt lgkmcnt(4)
    v_mfma_f32_16x16x32_bf16 v[48:51], v[252:255], v[184:187], v[48:51]
    ds_read_b64_tr_b16 v[248:249], v6 offset:20992
    v_mfma_f32_16x16x32_bf16 v[52:55], v[252:255], v[188:191], v[52:55]
    ds_read_b64_tr_b16 v[250:251], v6 offset:23040
    s_waitcnt lgkmcnt(4)
    v_mfma_f32_16x16x32_bf16 v[56:59], v[240:243], v[184:187], v[56:59]
    ds_read_b64_tr_b16 v[252:253], v6 offset:29184
    v_mfma_f32_16x16x32_bf16 v[60:63], v[240:243], v[188:191], v[60:63]
    ds_read_b64_tr_b16 v[254:255], v6 offset:31232
    s_waitcnt lgkmcnt(4)
    v_mfma_f32_16x16x32_bf16 v[64:67], v[244:247], v[184:187], v[64:67]
    s_add_u32 s9, s46, 0xa48000
    buffer_load_dwordx4 v[232:235], v13, s[12:15], s9 offen offset:2048 sc1
    v_mfma_f32_16x16x32_bf16 v[68:71], v[244:247], v[188:191], v[68:71]
    s_waitcnt vmcnt(8)
    s_barrier
    ds_read_b64_tr_b16 v[240:241], v3 offset:0
    ds_read_b64_tr_b16 v[242:243], v3 offset:2048
    s_waitcnt vmcnt(12)
    v_max_u32 v15, v192, v193
    s_waitcnt lgkmcnt(4)
    v_mfma_f32_16x16x32_bf16 v[72:75], v[248:251], v[184:187], v[72:75]
    ds_read_b64_tr_b16 v[244:245], v3 offset:8192
    s_add_u32 s9, s53, 8192
    s_add_u32 m0, s41, 106496
    s_nop 0
    buffer_load_dwordx4 v10, s[12:15], s9 offen sc1 lds
    v_mfma_f32_16x16x32_bf16 v[76:79], v[248:251], v[188:191], v[76:79]
    ds_read_b64_tr_b16 v[246:247], v3 offset:10240
    v_max3_u32 v15, v194, v195, v15
    v_max3_u32 v15, v196, v197, v15
    s_waitcnt lgkmcnt(4)
    v_mfma_f32_16x16x32_bf16 v[80:83], v[252:255], v[184:187], v[80:83]
    ds_read_b64_tr_b16 v[248:249], v4 offset:0
    v_max3_u32 v15, v198, v199, v15
    v_mfma_f32_16x16x32_bf16 v[84:87], v[252:255], v[188:191], v[84:87]
    ds_read_b64_tr_b16 v[250:251], v4 offset:2048
    v_cmp_eq_u32 vcc, -1, v15
    s_cbranch_vccnz sequential_preLN__sliding_block__glu_gated_bilinear__prompt_kernel_retry77
sequential_preLN__sliding_block__glu_gated_bilinear__prompt_kernel_ok78:
    s_waitcnt lgkmcnt(4)
    v_mfma_f32_16x16x32_bf16 v[24:27], v[240:243], v[192:195], v[24:27]
    ds_read_b64_tr_b16 v[252:253], v4 offset:8192
    v_mfma_f32_16x16x32_bf16 v[28:31], v[240:243], v[196:199], v[28:31]
    ds_read_b64_tr_b16 v[254:255], v4 offset:10240
    s_add_u32 s9, s46, 0xa48000
    buffer_load_dwordx4 v[236:239], v13, s[12:15], s9 offen offset:2304 sc1
    s_waitcnt lgkmcnt(4)
    v_mfma_f32_16x16x32_bf16 v[32:35], v[244:247], v[192:195], v[32:35]
    ds_read_b64_tr_b16 v[240:241], v3 offset:512
    v_mfma_f32_16x16x32_bf16 v[36:39], v[244:247], v[196:199], v[36:39]
    ds_read_b64_tr_b16 v[242:243], v3 offset:2560
    s_waitcnt lgkmcnt(4)
    v_mfma_f32_16x16x32_bf16 v[40:43], v[248:251], v[192:195], v[40:43]
    ds_read_b64_tr_b16 v[244:245], v3 offset:8704
    v_mfma_f32_16x16x32_bf16 v[44:47], v[248:251], v[196:199], v[44:47]
    ds_read_b64_tr_b16 v[246:247], v3 offset:10752
    s_add_u32 s9, s53, 16384
    s_add_u32 m0, s41, 114688
    s_nop 0
    buffer_load_dwordx4 v10, s[12:15], s9 offen sc1 lds
    s_waitcnt lgkmcnt(4)
    v_mfma_f32_16x16x32_bf16 v[48:51], v[252:255], v[192:195], v[48:51]
    ds_read_b64_tr_b16 v[248:249], v4 offset:512
    v_mfma_f32_16x16x32_bf16 v[52:55], v[252:255], v[196:199], v[52:55]
    ds_read_b64_tr_b16 v[250:251], v4 offset:2560
    s_waitcnt lgkmcnt(4)
    v_mfma_f32_16x16x32_bf16 v[56:59], v[240:243], v[192:195], v[56:59]
    ds_read_b64_tr_b16 v[252:253], v4 offset:8704
    v_mfma_f32_16x16x32_bf16 v[60:63], v[240:243], v[196:199], v[60:63]
    ds_read_b64_tr_b16 v[254:255], v4 offset:10752
    s_lshr_b32 s9, s2, 3
    s_lshl_b32 s9, s9, 3
    s_add_u32 s9, s9, s36
    s_mul_i32 s9, s9, 2688
    s_mul_i32 s8, s37, 663552
    s_add_u32 s9, s9, s8
    v_lshlrev_b32 v0, 7, v2
    s_mov_b64 exec, 0x1fffff
    buffer_load_dword v17, v0, s[24:27], s9 offen
    s_mov_b64 exec, -1
    s_waitcnt lgkmcnt(4)
    v_mfma_f32_16x16x32_bf16 v[64:67], v[244:247], v[192:195], v[64:67]
    ds_read_b64_tr_b16 v[240:241], v3 offset:4096
    s_waitcnt vmcnt(13)
    v_mfma_f32_16x16x32_bf16 v[68:71], v[244:247], v[196:199], v[68:71]
    ds_read_b64_tr_b16 v[242:243], v3 offset:6144
    v_max_u32 v15, v200, v201
    s_waitcnt lgkmcnt(4)
    v_mfma_f32_16x16x32_bf16 v[72:75], v[248:251], v[192:195], v[72:75]
    ds_read_b64_tr_b16 v[244:245], v3 offset:12288
    s_add_u32 s9, s53, 24576
    s_add_u32 m0, s41, 122880
    s_nop 0
    buffer_load_dwordx4 v10, s[12:15], s9 offen sc1 lds
    v_mfma_f32_16x16x32_bf16 v[76:79], v[248:251], v[196:199], v[76:79]
    ds_read_b64_tr_b16 v[246:247], v3 offset:14336
    v_max3_u32 v15, v202, v203, v15
    v_max3_u32 v15, v204, v205, v15
    s_waitcnt lgkmcnt(4)
    v_mfma_f32_16x16x32_bf16 v[80:83], v[252:255], v[192:195], v[80:83]
    ds_read_b64_tr_b16 v[248:249], v4 offset:4096
    v_max3_u32 v15, v206, v207, v15
    v_mfma_f32_16x16x32_bf16 v[84:87], v[252:255], v[196:199], v[84:87]
    ds_read_b64_tr_b16 v[250:251], v4 offset:6144
    v_cmp_eq_u32 vcc, -1, v15
    s_cbranch_vccnz sequential_preLN__sliding_block__glu_gated_bilinear__prompt_kernel_retry79
sequential_preLN__sliding_block__glu_gated_bilinear__prompt_kernel_ok80:
    s_waitcnt lgkmcnt(4)
    v_mfma_f32_16x16x32_bf16 v[24:27], v[240:243], v[200:203], v[24:27]
    ds_read_b64_tr_b16 v[252:253], v4 offset:12288
    v_mfma_f32_16x16x32_bf16 v[28:31], v[240:243], v[204:207], v[28:31]
    ds_read_b64_tr_b16 v[254:255], v4 offset:14336
    s_waitcnt lgkmcnt(4)
    v_mfma_f32_16x16x32_bf16 v[32:35], v[244:247], v[200:203], v[32:35]
    ds_read_b64_tr_b16 v[240:241], v3 offset:4608
    v_mfma_f32_16x16x32_bf16 v[36:39], v[244:247], v[204:207], v[36:39]
    ds_read_b64_tr_b16 v[242:243], v3 offset:6656
    s_waitcnt lgkmcnt(4)
    v_mfma_f32_16x16x32_bf16 v[40:43], v[248:251], v[200:203], v[40:43]
    ds_read_b64_tr_b16 v[244:245], v3 offset:12800
    v_mfma_f32_16x16x32_bf16 v[44:47], v[248:251], v[204:207], v[44:47]
    ds_read_b64_tr_b16 v[246:247], v3 offset:14848
    s_waitcnt lgkmcnt(4)
    v_mfma_f32_16x16x32_bf16 v[48:51], v[252:255], v[200:203], v[48:51]
    ds_read_b64_tr_b16 v[248:249], v4 offset:4608
    v_mfma_f32_16x16x32_bf16 v[52:55], v[252:255], v[204:207], v[52:55]
    ds_read_b64_tr_b16 v[250:251], v4 offset:6656
    s_waitcnt lgkmcnt(4)
    v_mfma_f32_16x16x32_bf16 v[56:59], v[240:243], v[200:203], v[56:59]
    ds_read_b64_tr_b16 v[252:253], v4 offset:12800
    v_mfma_f32_16x16x32_bf16 v[60:63], v[240:243], v[204:207], v[60:63]
    ds_read_b64_tr_b16 v[254:255], v4 offset:14848
    s_waitcnt lgkmcnt(4)
    v_mfma_f32_16x16x32_bf16 v[64:67], v[244:247], v[200:203], v[64:67]
    ds_read_b64_tr_b16 v[240:241], v3 offset:16384
    s_waitcnt vmcnt(11)
    v_mfma_f32_16x16x32_bf16 v[68:71], v[244:247], v[204:207], v[68:71]
    ds_read_b64_tr_b16 v[242:243], v3 offset:18432
    v_max_u32 v15, v208, v209
    s_waitcnt lgkmcnt(4)
    v_mfma_f32_16x16x32_bf16 v[72:75], v[248:251], v[200:203], v[72:75]
    ds_read_b64_tr_b16 v[244:245], v3 offset:24576
    s_add_u32 s9, s43, 128
    s_add_u32 m0, s42, 49152
    s_nop 0
    buffer_load_dwordx4 v8, s[16:19], s9 offen  lds
    v_mfma_f32_16x16x32_bf16 v[76:79], v[248:251], v[204:207], v[76:79]
    ds_read_b64_tr_b16 v[246:247], v3 offset:26624
    v_max3_u32 v15, v210, v211, v15
    v_max3_u32 v15, v212, v213, v15
    s_waitcnt lgkmcnt(4)
    v_mfma_f32_16x16x32_bf16 v[80:83], v[252:255], v[200:203], v[80:83]
    ds_read_b64_tr_b16 v[248:249], v4 offset:16384
    v_max3_u32 v15, v214, v215, v15
    v_mfma_f32_16x16x32_bf16 v[84:87], v[252:255], v[204:207], v[84:87]
    ds_read_b64_tr_b16 v[250:251], v4 offset:18432
    v_cmp_eq_u32 vcc, -1, v15
    s_cbranch_vccnz sequential_preLN__sliding_block__glu_gated_bilinear__prompt_kernel_retry81
sequential_preLN__sliding_block__glu_gated_bilinear__prompt_kernel_ok82:
    s_waitcnt lgkmcnt(4)
    v_mfma_f32_16x16x32_bf16 v[24:27], v[240:243], v[208:211], v[24:27]
    ds_read_b64_tr_b16 v[252:253], v4 offset:24576
    v_mfma_f32_16x16x32_bf16 v[28:31], v[240:243], v[212:215], v[28:31]
    ds_read_b64_tr_b16 v[254:255], v4 offset:26624
    s_waitcnt lgkmcnt(4)
    v_mfma_f32_16x16x32_bf16 v[32:35], v[244:247], v[208:211], v[32:35]
    ds_read_b64_tr_b16 v[240:241], v3 offset:16896
    v_mfma_f32_16x16x32_bf16 v[36:39], v[244:247], v[212:215], v[36:39]
    ds_read_b64_tr_b16 v[242:243], v3 offset:18944
    s_waitcnt lgkmcnt(4)
    v_mfma_f32_16x16x32_bf16 v[40:43], v[248:251], v[208:211], v[40:43]
    ds_read_b64_tr_b16 v[244:245], v3 offset:25088
    v_mfma_f32_16x16x32_bf16 v[44:47], v[248:251], v[212:215], v[44:47]
    ds_read_b64_tr_b16 v[246:247], v3 offset:27136
    s_waitcnt lgkmcnt(4)
    v_mfma_f32_16x16x32_bf16 v[48:51], v[252:255], v[208:211], v[48:51]
    ds_read_b64_tr_b16 v[248:249], v4 offset:16896
    v_mfma_f32_16x16x32_bf16 v[52:55], v[252:255], v[212:215], v[52:55]
    ds_read_b64_tr_b16 v[250:251], v4 offset:18944
    s_add_u32 s9, s43, 128
    s_add_u32 m0, s42, 57344
    s_nop 0
    buffer_load_dwordx4 v8, s[20:23], s9 offen  lds
    s_waitcnt lgkmcnt(4)
    v_mfma_f32_16x16x32_bf16 v[56:59], v[240:243], v[208:211], v[56:59]
    ds_read_b64_tr_b16 v[252:253], v4 offset:25088
    v_mfma_f32_16x16x32_bf16 v[60:63], v[240:243], v[212:215], v[60:63]
    ds_read_b64_tr_b16 v[254:255], v4 offset:27136
    s_waitcnt lgkmcnt(4)
    v_mfma_f32_16x16x32_bf16 v[64:67], v[244:247], v[208:211], v[64:67]
    ds_read_b64_tr_b16 v[240:241], v3 offset:20480
    s_waitcnt vmcnt(11)
    v_mfma_f32_16x16x32_bf16 v[68:71], v[244:247], v[212:215], v[68:71]
    ds_read_b64_tr_b16 v[242:243], v3 offset:22528
    v_max_u32 v15, v216, v217
    s_waitcnt lgkmcnt(4)
    v_mfma_f32_16x16x32_bf16 v[72:75], v[248:251], v[208:211], v[72:75]
    ds_read_b64_tr_b16 v[244:245], v3 offset:28672
    v_max3_u32 v15, v218, v219, v15
    v_mfma_f32_16x16x32_bf16 v[76:79], v[248:251], v[212:215], v[76:79]
    ds_read_b64_tr_b16 v[246:247], v3 offset:30720
    v_max3_u32 v15, v220, v221, v15
    s_waitcnt lgkmcnt(4)
    v_mfma_f32_16x16x32_bf16 v[80:83], v[252:255], v[208:211], v[80:83]
    ds_read_b64_tr_b16 v[248:249], v4 offset:20480
    v_max3_u32 v15, v222, v223, v15
    v_mfma_f32_16x16x32_bf16 v[84:87], v[252:255], v[212:215], v[84:87]
    ds_read_b64_tr_b16 v[250:251], v4 offset:22528
    v_cmp_eq_u32 vcc, -1, v15
    s_cbranch_vccnz sequential_preLN__sliding_block__glu_gated_bilinear__prompt_kernel_retry83
sequential_preLN__sliding_block__glu_gated_bilinear__prompt_kernel_ok84:
    s_waitcnt lgkmcnt(4)
    v_mfma_f32_16x16x32_bf16 v[24:27], v[240:243], v[216:219], v[24:27]
    ds_read_b64_tr_b16 v[252:253], v4 offset:28672
    v_mfma_f32_16x16x32_bf16 v[28:31], v[240:243], v[220:223], v[28:31]
    ds_read_b64_tr_b16 v[254:255], v4 offset:30720
    s_add_u32 s9, s43, 589952
    s_add_u32 m0, s42, 65536
    s_nop 0
    buffer_load_dwordx4 v8, s[16:19], s9 offen  lds
    s_waitcnt lgkmcnt(4)
    v_mfma_f32_16x16x32_bf16 v[32:35], v[244:247], v[216:219], v[32:35]
    ds_read_b64_tr_b16 v[240:241], v3 offset:20992
    v_mfma_f32_16x16x32_bf16 v[36:39], v[244:247], v[220:223], v[36:39]
    ds_read_b64_tr_b16 v[242:243], v3 offset:23040
    s_waitcnt lgkmcnt(4)
    v_mfma_f32_16x16x32_bf16 v[40:43], v[248:251], v[216:219], v[40:43]
    ds_read_b64_tr_b16 v[244:245], v3 offset:29184
    s_waitcnt vmcnt(10)
    v_mfma_f32_16x16x32_bf16 v[44:47], v[248:251], v[220:223], v[44:47]
    ds_read_b64_tr_b16 v[246:247], v3 offset:31232
    v_max_u32 v15, v224, v225
    s_waitcnt lgkmcnt(4)
    v_mfma_f32_16x16x32_bf16 v[48:51], v[252:255], v[216:219], v[48:51]
    ds_read_b64_tr_b16 v[248:249], v4 offset:20992
    v_max3_u32 v15, v226, v227, v15
    v_mfma_f32_16x16x32_bf16 v[52:55], v[252:255], v[220:223], v[52:55]
    ds_read_b64_tr_b16 v[250:251], v4 offset:23040
    v_max3_u32 v15, v228, v229, v15
    s_waitcnt lgkmcnt(4)
    v_mfma_f32_16x16x32_bf16 v[56:59], v[240:243], v[216:219], v[56:59]
    ds_read_b64_tr_b16 v[252:253], v4 offset:29184
    v_max3_u32 v15, v230, v231, v15
    v_mfma_f32_16x16x32_bf16 v[60:63], v[240:243], v[220:223], v[60:63]
    ds_read_b64_tr_b16 v[254:255], v4 offset:31232
    v_cmp_eq_u32 vcc, -1, v15
    s_cbranch_vccnz sequential_preLN__sliding_block__glu_gated_bilinear__prompt_kernel_retry85
sequential_preLN__sliding_block__glu_gated_bilinear__prompt_kernel_ok86:
    s_waitcnt lgkmcnt(4)
    v_mfma_f32_16x16x32_bf16 v[64:67], v[244:247], v[216:219], v[64:67]
    ds_read_b64_tr_b16 v[240:241], v3 offset:32768
    s_add_u32 s9, s43, 589952
    s_add_u32 m0, s42, 73728
    s_nop 0
    buffer_load_dwordx4 v8, s[20:23], s9 offen  lds
    v_mfma_f32_16x16x32_bf16 v[68:71], v[244:247], v[220:223], v[68:71]
    ds_read_b64_tr_b16 v[242:243], v3 offset:34816
    s_waitcnt vmcnt(7)
    v_max_u32 v15, v232, v233
    s_waitcnt lgkmcnt(4)
    v_mfma_f32_16x16x32_bf16 v[72:75], v[248:251], v[216:219], v[72:75]
    ds_read_b64_tr_b16 v[244:245], v3 offset:40960
    v_max3_u32 v15, v234, v235, v15
    v_mfma_f32_16x16x32_bf16 v[76:79], v[248:251], v[220:223], v[76:79]
    ds_read_b64_tr_b16 v[246:247], v3 offset:43008
    v_max3_u32 v15, v236, v237, v15
    s_waitcnt lgkmcnt(4)
    v_mfma_f32_16x16x32_bf16 v[80:83], v[252:255], v[216:219], v[80:83]
pg_a:
    s_cbranch_execz pf_ret
    ds_read_b64_tr_b16 v[248:249], v4 offset:32768
    v_max3_u32 v15, v238, v239, v15
    v_mfma_f32_16x16x32_bf16 v[84:87], v[252:255], v[220:223], v[84:87]
    ds_read_b64_tr_b16 v[250:251], v4 offset:34816
    v_cmp_eq_u32 vcc, -1, v15
    s_cbranch_vccnz sequential_preLN__sliding_block__glu_gated_bilinear__prompt_kernel_retry87
sequential_preLN__sliding_block__glu_gated_bilinear__prompt_kernel_ok88:
    s_waitcnt lgkmcnt(4)
    v_mfma_f32_16x16x32_bf16 v[24:27], v[240:243], v[224:227], v[24:27]
    ds_read_b64_tr_b16 v[252:253], v4 offset:40960
    v_mfma_f32_16x16x32_bf16 v[28:31], v[240:243], v[228:231], v[28:31]
    ds_read_b64_tr_b16 v[254:255], v4 offset:43008
    s_waitcnt lgkmcnt(4)
    v_mfma_f32_16x16x32_bf16 v[32:35], v[244:247], v[224:227], v[32:35]
    ds_read_b64_tr_b16 v[240:241], v3 offset:36864
    v_mfma_f32_16x16x32_bf16 v[36:39], v[244:247], v[228:231], v[36:39]
    ds_read_b64_tr_b16 v[242:243], v3 offset:38912
    s_waitcnt lgkmcnt(4)
    v_mfma_f32_16x16x32_bf16 v[40:43], v[248:251], v[224:227], v[40:43]
    ds_read_b64_tr_b16 v[244:245], v3 offset:45056
    v_mfma_f32_16x16x32_bf16 v[44:47], v[248:251], v[228:231], v[44:47]
    ds_read_b64_tr_b16 v[246:247], v3 offset:47104
    s_add_u32 s9, s43, 1179776
    s_add_u32 m0, s42, 81920
    s_nop 0
    buffer_load_dwordx4 v8, s[16:19], s9 offen  lds
    s_waitcnt lgkmcnt(4)
    v_mfma_f32_16x16x32_bf16 v[48:51], v[252:255], v[224:227], v[48:51]
    ds_read_b64_tr_b16 v[248:249], v4 offset:36864
    v_mfma_f32_16x16x32_bf16 v[52:55], v[252:255], v[228:231], v[52:55]
    ds_read_b64_tr_b16 v[250:251], v4 offset:38912
    s_waitcnt lgkmcnt(4)
    v_mfma_f32_16x16x32_bf16 v[24:27], v[240:243], v[232:235], v[24:27]
    ds_read_b64_tr_b16 v[252:253], v4 offset:45056
    v_mfma_f32_16x16x32_bf16 v[28:31], v[240:243], v[236:239], v[28:31]
    ds_read_b64_tr_b16 v[254:255], v4 offset:47104
    s_waitcnt lgkmcnt(4)
    v_mfma_f32_16x16x32_bf16 v[32:35], v[244:247], v[232:235], v[32:35]
    ds_read_b64_tr_b16 v[240:241], v3 offset:33280
    v_mfma_f32_16x16x32_bf16 v[36:39], v[244:247], v[236:239], v[36:39]
    ds_read_b64_tr_b16 v[242:243], v3 offset:35328
    s_waitcnt lgkmcnt(4)
    v_mfma_f32_16x16x32_bf16 v[40:43], v[248:251], v[232:235], v[40:43]
    ds_read_b64_tr_b16 v[244:245], v3 offset:41472
    v_mfma_f32_16x16x32_bf16 v[44:47], v[248:251], v[236:239], v[44:47]
    ds_read_b64_tr_b16 v[246:247], v3 offset:43520
    s_waitcnt lgkmcnt(4)
    v_mfma_f32_16x16x32_bf16 v[48:51], v[252:255], v[232:235], v[48:51]
    ds_read_b64_tr_b16 v[248:249], v4 offset:33280
    v_mfma_f32_16x16x32_bf16 v[52:55], v[252:255], v[236:239], v[52:55]
    ds_read_b64_tr_b16 v[250:251], v4 offset:35328
    s_add_u32 s9, s43, 1179776
    s_add_u32 m0, s42, 90112
    s_nop 0
    buffer_load_dwordx4 v8, s[20:23], s9 offen  lds
    s_waitcnt lgkmcnt(4)
    v_mfma_f32_16x16x32_bf16 v[56:59], v[240:243], v[224:227], v[56:59]
    ds_read_b64_tr_b16 v[252:253], v4 offset:41472
    v_mfma_f32_16x16x32_bf16 v[60:63], v[240:243], v[228:231], v[60:63]
    ds_read_b64_tr_b16 v[254:255], v4 offset:43520
    s_waitcnt lgkmcnt(4)
    v_mfma_f32_16x16x32_bf16 v[64:67], v[244:247], v[224:227], v[64:67]
    ds_read_b64_tr_b16 v[240:241], v3 offset:37376
    v_mul_f32 v32, v32, v24
    v_mul_f32 v33, v33, v25
    v_mfma_f32_16x16x32_bf16 v[68:71], v[244:247], v[228:231], v[68:71]
    ds_read_b64_tr_b16 v[242:243], v3 offset:39424
    v_mul_f32 v34, v34, v26
    v_mul_f32 v35, v35, v27
    s_waitcnt lgkmcnt(4)
    v_mfma_f32_16x16x32_bf16 v[72:75], v[248:251], v[224:227], v[72:75]
    ds_read_b64_tr_b16 v[244:245], v3 offset:45568
    v_mul_f32 v48, v48, v40
    v_mul_f32 v49, v49, v41
    v_mfma_f32_16x16x32_bf16 v[76:79], v[248:251], v[228:231], v[76:79]
    ds_read_b64_tr_b16 v[246:247], v3 offset:47616
    v_mul_f32 v50, v50, v42
    v_mul_f32 v51, v51, v43
    s_waitcnt lgkmcnt(4)
    v_mfma_f32_16x16x32_bf16 v[80:83], v[252:255], v[224:227], v[80:83]
    ds_read_b64_tr_b16 v[248:249], v4 offset:37376
    v_cvt_pk_bf16_f32 v24, v32, v33
    v_cvt_pk_bf16_f32 v25, v34, v35
    v_mfma_f32_16x16x32_bf16 v[84:87], v[252:255], v[228:231], v[84:87]
    ds_read_b64_tr_b16 v[250:251], v4 offset:39424
    v_cvt_pk_bf16_f32 v26, v48, v49
    v_cvt_pk_bf16_f32 v27, v50, v51
    s_waitcnt lgkmcnt(4)
    v_mfma_f32_16x16x32_bf16 v[56:59], v[240:243], v[232:235], v[56:59]
    ds_read_b64_tr_b16 v[252:253], v4 offset:45568
    v_and_b32 v24, -2, v24
    v_mfma_f32_16x16x32_bf16 v[60:63], v[240:243], v[236:239], v[60:63]
    ds_read_b64_tr_b16 v[254:255], v4 offset:47616
    v_mul_f32 v36, v36, v28
    v_mul_f32 v37, v37, v29
    s_waitcnt lgkmcnt(4)
    v_mfma_f32_16x16x32_bf16 v[64:67], v[244:247], v[232:235], v[64:67]
    v_mul_f32 v38, v38, v30
    v_mul_f32 v39, v39, v31
    v_mfma_f32_16x16x32_bf16 v[68:71], v[244:247], v[236:239], v[68:71]
    s_waitcnt vmcnt(6)
    s_barrier
    ds_read_b64_tr_b16 v[240:241], v7 offset:0
    ds_read_b64_tr_b16 v[242:243], v7 offset:512
    v_mul_f32 v52, v52, v44
    v_mul_f32 v53, v53, v45
    s_waitcnt lgkmcnt(4)
    v_mfma_f32_16x16x32_bf16 v[72:75], v[248:251], v[232:235], v[72:75]
    ds_read_b64_tr_b16 v[244:245], v7 offset:18432
    s_add_u32 s9, s43, 1769600
    s_add_u32 m0, s42, 0
    s_nop 0
    buffer_load_dwordx4 v8, s[16:19], s9 offen  lds
    v_mul_f32 v54, v54, v46
    v_mul_f32 v55, v55, v47
    v_mfma_f32_16x16x32_bf16 v[76:79], v[248:251], v[236:239], v[76:79]
    ds_read_b64_tr_b16 v[246:247], v7 offset:18944
    v_cvt_pk_bf16_f32 v28, v36, v37
    v_cvt_pk_bf16_f32 v29, v38, v39
    s_xor_b32 s9, s48, 0x0
    buffer_store_dwordx4 v[24:27], v12, s[12:15], s9 offen sc1
    s_waitcnt lgkmcnt(4)
    v_mfma_f32_16x16x32_bf16 v[80:83], v[252:255], v[232:235], v[80:83]
    ds_read_b64_tr_b16 v[248:249], v7 offset:1024
    v_cvt_pk_bf16_f32 v30, v52, v53
    v_mfma_f32_16x16x32_bf16 v[84:87], v[252:255], v[236:239], v[84:87]
    ds_read_b64_tr_b16 v[250:251], v7 offset:1536
    v_cvt_pk_bf16_f32 v31, v54, v55
    v_and_b32 v28, -2, v28
    s_waitcnt lgkmcnt(4)
    v_mfma_f32_16x16x32_bf16 v[40:43], v[240:243], v[96:99], 0
    ds_read_b64_tr_b16 v[252:253], v7 offset:19456
    v_mfma_f32_16x16x32_bf16 v[44:47], v[240:243], v[100:103], 0
    ds_read_b64_tr_b16 v[254:255], v7 offset:19968
    s_waitcnt lgkmcnt(4)
    v_mfma_f32_16x16x32_bf16 v[48:51], v[244:247], v[96:99], 0
    ds_read_b64_tr_b16 v[240:241], v7 offset:2048
    v_mul_f32 v64, v64, v56
    v_mfma_f32_16x16x32_bf16 v[52:55], v[244:247], v[100:103], 0
    ds_read_b64_tr_b16 v[242:243], v7 offset:2560
    v_mul_f32 v65, v65, v57
    v_mul_f32 v66, v66, v58
    s_waitcnt lgkmcnt(4)
    v_mfma_f32_16x16x32_bf16 v[40:43], v[248:251], v[104:107], v[40:43]
    ds_read_b64_tr_b16 v[244:245], v7 offset:20480
    v_mul_f32 v67, v67, v59
    v_mfma_f32_16x16x32_bf16 v[44:47], v[248:251], v[108:111], v[44:47]
    ds_read_b64_tr_b16 v[246:247], v7 offset:20992
    v_mul_f32 v80, v80, v72
    s_lshl_b32 s9, s39, 7
    s_add_u32 s9, s9, 0xc80000
    buffer_load_dword v20, v11, s[12:15], s9 offen sc1
    s_lshl_b32 s9, s39, 9
    s_add_u32 s9, s9, 0xc82000
    v_lshlrev_b32 v0, 2, v11
    buffer_load_dwordx4 v[88:91], v0, s[12:15], s9 offen sc1
    s_waitcnt lgkmcnt(4)
    v_mfma_f32_16x16x32_bf16 v[48:51], v[252:255], v[104:107], v[48:51]
    ds_read_b64_tr_b16 v[248:249], v7 offset:3072
    s_add_u32 s9, s43, 1769600
    s_add_u32 m0, s42, 8192
    s_nop 0
    buffer_load_dwordx4 v8, s[20:23], s9 offen  lds
    v_mul_f32 v81, v81, v73
    v_mfma_f32_16x16x32_bf16 v[52:55], v[252:255], v[108:111], v[52:55]
    ds_read_b64_tr_b16 v[250:251], v7 offset:3584
    v_mul_f32 v82, v82, v74
    v_mul_f32 v83, v83, v75
    s_waitcnt lgkmcnt(4)
    v_mfma_f32_16x16x32_bf16 v[40:43], v[240:243], v[112:115], v[40:43]
    ds_read_b64_tr_b16 v[252:253], v7 offset:21504
    v_cvt_pk_bf16_f32 v56, v64, v65
    v_mfma_f32_16x16x32_bf16 v[44:47], v[240:243], v[116:119], v[44:47]
    ds_read_b64_tr_b16 v[254:255], v7 offset:22016
    v_cvt_pk_bf16_f32 v57, v66, v67
    s_waitcnt lgkmcnt(4)
    v_mfma_f32_16x16x32_bf16 v[48:51], v[244:247], v[112:115], v[48:51]
    ds_read_b64_tr_b16 v[240:241], v7 offset:4096
    v_cvt_pk_bf16_f32 v58, v80, v81
    v_mfma_f32_16x16x32_bf16 v[52:55], v[244:247], v[116:119], v[52:55]
    ds_read_b64_tr_b16 v[242:243], v7 offset:4608
    v_cvt_pk_bf16_f32 v59, v82, v83
    s_waitcnt lgkmcnt(4)
    v_mfma_f32_16x16x32_bf16 v[40:43], v[248:251], v[120:123], v[40:43]
    ds_read_b64_tr_b16 v[244:245], v7 offset:22528
    v_and_b32 v56, -2, v56
    v_mfma_f32_16x16x32_bf16 v[44:47], v[248:251], v[124:127], v[44:47]
    ds_read_b64_tr_b16 v[246:247], v7 offset:23040
    v_mul_f32 v68, v68, v60
    v_mul_f32 v69, v69, v61
    s_waitcnt lgkmcnt(4)
    v_mfma_f32_16x16x32_bf16 v[48:51], v[252:255], v[120:123], v[48:51]
    ds_read_b64_tr_b16 v[248:249], v7 offset:5120
    v_mul_f32 v70, v70, v62
    v_mfma_f32_16x16x32_bf16 v[52:55], v[252:255], v[124:127], v[52:55]
    ds_read_b64_tr_b16 v[250:251], v7 offset:5632
    v_mul_f32 v71, v71, v63
    s_waitcnt lgkmcnt(4)
    v_mfma_f32_16x16x32_bf16 v[40:43], v[240:243], v[128:131], v[40:43]
    ds_read_b64_tr_b16 v[252:253], v7 offset:23552
    v_mul_f32 v84, v84, v76
    v_mfma_f32_16x16x32_bf16 v[44:47], v[240:243], v[132:135], v[44:47]
    ds_read_b64_tr_b16 v[254:255], v7 offset:24064
    v_mul_f32 v85, v85, v77
    s_waitcnt lgkmcnt(4)
    v_mfma_f32_16x16x32_bf16 v[48:51], v[244:247], v[128:131], v[48:51]
    ds_read_b64_tr_b16 v[240:241], v7 offset:6144
    s_add_u32 s9, s43, 2359424
    s_add_u32 m0, s42, 16384
    s_nop 0
    buffer_load_dwordx4 v8, s[16:19], s9 offen  lds
    v_mul_f32 v86, v86, v78
    v_mfma_f32_16x16x32_bf16 v[52:55], v[244:247], v[132:135], v[52:55]
    ds_read_b64_tr_b16 v[242:243], v7 offset:6656
    v_mul_f32 v87, v87, v79
    v_cvt_pk_bf16_f32 v60, v68, v69
    s_xor_b32 s9, s48, 0x2000
    buffer_store_dwordx4 v[28:31], v12, s[12:15], s9 offen sc1
    s_waitcnt lgkmcnt(4)
    v_mfma_f32_16x16x32_bf16 v[40:43], v[248:251], v[136:139], v[40:43]
    ds_read_b64_tr_b16 v[244:245], v7 offset:24576
    v_cvt_pk_bf16_f32 v61, v70, v71
    v_mfma_f32_16x16x32_bf16 v[44:47], v[248:251], v[140:143], v[44:47]
    ds_read_b64_tr_b16 v[246:247], v7 offset:25088
    v_cvt_pk_bf16_f32 v62, v84, v85
    s_waitcnt lgkmcnt(4)
    v_mfma_f32_16x16x32_bf16 v[48:51], v[252:255], v[136:139], v[48:51]
    ds_read_b64_tr_b16 v[248:249], v7 offset:7168
    v_cvt_pk_bf16_f32 v63, v86, v87
    v_mfma_f32_16x16x32_bf16 v[52:55], v[252:255], v[140:143], v[52:55]
    ds_read_b64_tr_b16 v[250:251], v7 offset:7680
    v_and_b32 v60, -2, v60
    s_waitcnt lgkmcnt(4)
    v_mfma_f32_16x16x32_bf16 v[40:43], v[240:243], v[144:147], v[40:43]
    ds_read_b64_tr_b16 v[252:253], v7 offset:25600
    v_mfma_f32_16x16x32_bf16 v[44:47], v[240:243], v[148:151], v[44:47]
    ds_read_b64_tr_b16 v[254:255], v7 offset:26112
    s_waitcnt lgkmcnt(4)
    v_mfma_f32_16x16x32_bf16 v[48:51], v[244:247], v[144:147], v[48:51]
    ds_read_b64_tr_b16 v[240:241], v7 offset:8192
    v_mfma_f32_16x16x32_bf16 v[52:55], v[244:247], v[148:151], v[52:55]
    ds_read_b64_tr_b16 v[242:243], v7 offset:8704
    s_waitcnt lgkmcnt(4)
    v_mfma_f32_16x16x32_bf16 v[40:43], v[248:251], v[152:155], v[40:43]
    ds_read_b64_tr_b16 v[244:245], v7 offset:26624
    v_mfma_f32_16x16x32_bf16 v[44:47], v[248:251], v[156:159], v[44:47]
    ds_read_b64_tr_b16 v[246:247], v7 offset:27136
    s_waitcnt lgkmcnt(4)
    v_mfma_f32_16x16x32_bf16 v[48:51], v[252:255], v[152:155], v[48:51]
    ds_read_b64_tr_b16 v[248:249], v7 offset:9216
    v_mfma_f32_16x16x32_bf16 v[52:55], v[252:255], v[156:159], v[52:55]
    ds_read_b64_tr_b16 v[250:251], v7 offset:9728
    s_add_u32 s9, s43, 2359424
    s_add_u32 m0, s42, 24576
    s_nop 0
    buffer_load_dwordx4 v8, s[20:23], s9 offen  lds
    s_waitcnt lgkmcnt(4)
    v_mfma_f32_16x16x32_bf16 v[40:43], v[240:243], v[160:163], v[40:43]
    ds_read_b64_tr_b16 v[252:253], v7 offset:27648
    v_mfma_f32_16x16x32_bf16 v[44:47], v[240:243], v[164:167], v[44:47]
    ds_read_b64_tr_b16 v[254:255], v7 offset:28160
    s_waitcnt lgkmcnt(4)
    v_mfma_f32_16x16x32_bf16 v[48:51], v[244:247], v[160:163], v[48:51]
    ds_read_b64_tr_b16 v[240:241], v7 offset:10240
    v_mfma_f32_16x16x32_bf16 v[52:55], v[244:247], v[164:167], v[52:55]
    ds_read_b64_tr_b16 v[242:243], v7 offset:10752
    s_waitcnt lgkmcnt(4)
    v_mfma_f32_16x16x32_bf16 v[40:43], v[248:251], v[168:171], v[40:43]
    ds_read_b64_tr_b16 v[244:245], v7 offset:28672
    v_mfma_f32_16x16x32_bf16 v[44:47], v[248:251], v[172:175], v[44:47]
    ds_read_b64_tr_b16 v[246:247], v7 offset:29184
    s_waitcnt lgkmcnt(4)
    v_mfma_f32_16x16x32_bf16 v[48:51], v[252:255], v[168:171], v[48:51]
    ds_read_b64_tr_b16 v[248:249], v7 offset:11264
    v_mfma_f32_16x16x32_bf16 v[52:55], v[252:255], v[172:175], v[52:55]
    ds_read_b64_tr_b16 v[250:251], v7 offset:11776
    s_waitcnt lgkmcnt(4)
    v_mfma_f32_16x16x32_bf16 v[40:43], v[240:243], v[176:179], v[40:43]
    ds_read_b64_tr_b16 v[252:253], v7 offset:29696
    s_add_u32 s9, s43, 2949248
    s_add_u32 m0, s42, 32768
    s_nop 0
    buffer_load_dwordx4 v8, s[16:19], s9 offen  lds
    v_mfma_f32_16x16x32_bf16 v[44:47], v[240:243], v[180:183], v[44:47]
    ds_read_b64_tr_b16 v[254:255], v7 offset:30208
    s_xor_b32 s9, s48, 0x4000
    buffer_store_dwordx4 v[56:59], v12, s[12:15], s9 offen sc1
    s_waitcnt lgkmcnt(4)
    v_mfma_f32_16x16x32_bf16 v[48:51], v[244:247], v[176:179], v[48:51]
    ds_read_b64_tr_b16 v[240:241], v7 offset:12288
    v_mfma_f32_16x16x32_bf16 v[52:55], v[244:247], v[180:183], v[52:55]
    ds_read_b64_tr_b16 v[242:243], v7 offset:12800
    s_waitcnt lgkmcnt(4)
    v_mfma_f32_16x16x32_bf16 v[40:43], v[248:251], v[184:187], v[40:43]
    ds_read_b64_tr_b16 v[244:245], v7 offset:30720
    v_mfma_f32_16x16x32_bf16 v[44:47], v[248:251], v[188:191], v[44:47]
    ds_read_b64_tr_b16 v[246:247], v7 offset:31232
    s_waitcnt lgkmcnt(4)
    v_mfma_f32_16x16x32_bf16 v[48:51], v[252:255], v[184:187], v[48:51]
    ds_read_b64_tr_b16 v[248:249], v7 offset:13312
    v_mfma_f32_16x16x32_bf16 v[52:55], v[252:255], v[188:191], v[52:55]
    ds_read_b64_tr_b16 v[250:251], v7 offset:13824
    s_waitcnt lgkmcnt(4)
    v_mfma_f32_16x16x32_bf16 v[40:43], v[240:243], v[192:195], v[40:43]
    ds_read_b64_tr_b16 v[252:253], v7 offset:31744
    v_mfma_f32_16x16x32_bf16 v[44:47], v[240:243], v[196:199], v[44:47]
    ds_read_b64_tr_b16 v[254:255], v7 offset:32256
    s_waitcnt lgkmcnt(4)
    v_mfma_f32_16x16x32_bf16 v[48:51], v[244:247], v[192:195], v[48:51]
    ds_read_b64_tr_b16 v[240:241], v7 offset:14336
    v_mfma_f32_16x16x32_bf16 v[52:55], v[244:247], v[196:199], v[52:55]
    ds_read_b64_tr_b16 v[242:243], v7 offset:14848
    s_waitcnt lgkmcnt(4)
    v_mfma_f32_16x16x32_bf16 v[40:43], v[248:251], v[200:203], v[40:43]
    ds_read_b64_tr_b16 v[244:245], v7 offset:32768
    v_mfma_f32_16x16x32_bf16 v[44:47], v[248:251], v[204:207], v[44:47]
    ds_read_b64_tr_b16 v[246:247], v7 offset:33280
    s_add_u32 s9, s43, 2949248
    s_add_u32 m0, s42, 40960
    s_nop 0
    buffer_load_dwordx4 v8, s[20:23], s9 offen  lds
    s_waitcnt lgkmcnt(4)
    v_mfma_f32_16x16x32_bf16 v[48:51], v[252:255], v[200:203], v[48:51]
    ds_read_b64_tr_b16 v[248:249], v7 offset:15360
    v_mfma_f32_16x16x32_bf16 v[52:55], v[252:255], v[204:207], v[52:55]
    ds_read_b64_tr_b16 v[250:251], v7 offset:15872
    s_waitcnt lgkmcnt(4)
    v_mfma_f32_16x16x32_bf16 v[40:43], v[240:243], v[208:211], v[40:43]
    ds_read_b64_tr_b16 v[252:253], v7 offset:33792
    v_mfma_f32_16x16x32_bf16 v[44:47], v[240:243], v[212:215], v[44:47]
    ds_read_b64_tr_b16 v[254:255], v7 offset:34304
    s_waitcnt lgkmcnt(4)
    v_mfma_f32_16x16x32_bf16 v[48:51], v[244:247], v[208:211], v[48:51]
    ds_read_b64_tr_b16 v[240:241], v7 offset:16384
    v_mfma_f32_16x16x32_bf16 v[52:55], v[244:247], v[212:215], v[52:55]
    ds_read_b64_tr_b16 v[242:243], v7 offset:16896
    s_waitcnt lgkmcnt(4)
    v_mfma_f32_16x16x32_bf16 v[40:43], v[248:251], v[216:219], v[40:43]
    ds_read_b64_tr_b16 v[244:245], v7 offset:34816
    v_mfma_f32_16x16x32_bf16 v[44:47], v[248:251], v[220:223], v[44:47]
    ds_read_b64_tr_b16 v[246:247], v7 offset:35328
    s_waitcnt lgkmcnt(4)
    v_mfma_f32_16x16x32_bf16 v[48:51], v[252:255], v[216:219], v[48:51]
    ds_read_b64_tr_b16 v[248:249], v7 offset:17408
    v_mfma_f32_16x16x32_bf16 v[52:55], v[252:255], v[220:223], v[52:55]
    ds_read_b64_tr_b16 v[250:251], v7 offset:17920
    s_xor_b32 s9, s48, 0x6000
    buffer_store_dwordx4 v[60:63], v12, s[12:15], s9 offen sc1
    s_waitcnt lgkmcnt(4)
    v_mfma_f32_16x16x32_bf16 v[40:43], v[240:243], v[224:227], v[40:43]
    ds_read_b64_tr_b16 v[252:253], v7 offset:35840
    v_mfma_f32_16x16x32_bf16 v[44:47], v[240:243], v[228:231], v[44:47]
    ds_read_b64_tr_b16 v[254:255], v7 offset:36352
    s_waitcnt lgkmcnt(4)
    v_mfma_f32_16x16x32_bf16 v[48:51], v[244:247], v[224:227], v[48:51]
    v_mfma_f32_16x16x32_bf16 v[52:55], v[244:247], v[228:231], v[52:55]
    s_waitcnt vmcnt(12)
    s_barrier
    ds_read_b64_tr_b16 v[240:241], v3 offset:49664
    ds_read_b64_tr_b16 v[242:243], v3 offset:51712
    s_waitcnt lgkmcnt(4)
    v_mfma_f32_16x16x32_bf16 v[40:43], v[248:251], v[232:235], v[40:43]
    ds_read_b64_tr_b16 v[244:245], v3 offset:57856
    v_mfma_f32_16x16x32_bf16 v[44:47], v[248:251], v[236:239], v[44:47]
    ds_read_b64_tr_b16 v[246:247], v3 offset:59904
    s_add_u32 s9, s44, s60
    s_add_u32 m0, s41, 98304
    s_nop 0
    buffer_load_dwordx4 v9, s[24:27], s9 offen  lds
    s_waitcnt lgkmcnt(4)
    v_mfma_f32_16x16x32_bf16 v[48:51], v[252:255], v[232:235], v[48:51]
    ds_read_b64_tr_b16 v[248:249], v4 offset:49664
    v_mfma_f32_16x16x32_bf16 v[52:55], v[252:255], v[236:239], v[52:55]
    ds_read_b64_tr_b16 v[250:251], v4 offset:51712
    s_waitcnt lgkmcnt(4)
    v_mfma_f32_16x16x32_bf16 v[56:59], v[240:243], v[96:99], 0
    ds_read_b64_tr_b16 v[252:253], v4 offset:57856
    v_mfma_f32_16x16x32_bf16 v[60:63], v[240:243], v[100:103], 0
    ds_read_b64_tr_b16 v[254:255], v4 offset:59904
    s_waitcnt lgkmcnt(4)
    v_mfma_f32_16x16x32_bf16 v[64:67], v[244:247], v[96:99], 0
    ds_read_b64_tr_b16 v[240:241], v3 offset:53760
    v_mul_f32 v48, v48, v40
    v_mfma_f32_16x16x32_bf16 v[68:71], v[244:247], v[100:103], 0
    ds_read_b64_tr_b16 v[242:243], v3 offset:55808
    v_mul_f32 v49, v49, v41
    s_waitcnt lgkmcnt(4)
    v_mfma_f32_16x16x32_bf16 v[72:75], v[248:251], v[96:99], 0
    ds_read_b64_tr_b16 v[244:245], v3 offset:61952
    v_mul_f32 v50, v50, v42
    v_mfma_f32_16x16x32_bf16 v[76:79], v[248:251], v[100:103], 0
    ds_read_b64_tr_b16 v[246:247], v3 offset:64000
    v_mul_f32 v51, v51, v43
    s_waitcnt lgkmcnt(4)
    v_mfma_f32_16x16x32_bf16 v[80:83], v[252:255], v[96:99], 0
    ds_read_b64_tr_b16 v[248:249], v4 offset:53760
    s_add_u32 s9, s45, s60
    s_add_u32 m0, s41, 106496
    s_nop 0
    buffer_load_dwordx4 v9, s[24:27], s9 offen  lds
    v_mfma_f32_16x16x32_bf16 v[84:87], v[252:255], v[100:103], 0
    ds_read_b64_tr_b16 v[250:251], v4 offset:55808
    v_mul_f32 v52, v52, v44
    v_mul_f32 v53, v53, v45
    s_waitcnt lgkmcnt(4)
    v_mfma_f32_16x16x32_bf16 v[56:59], v[240:243], v[104:107], v[56:59]
    ds_read_b64_tr_b16 v[252:253], v4 offset:61952
    v_mul_f32 v54, v54, v46
    v_mfma_f32_16x16x32_bf16 v[60:63], v[240:243], v[108:111], v[60:63]
    ds_read_b64_tr_b16 v[254:255], v4 offset:64000
    v_mul_f32 v55, v55, v47
    s_waitcnt lgkmcnt(4)
    v_mfma_f32_16x16x32_bf16 v[64:67], v[244:247], v[104:107], v[64:67]
    ds_read_b64_tr_b16 v[240:241], v3 offset:49152
    v_cvt_pk_bf16_f32 v40, v48, v49
    v_mfma_f32_16x16x32_bf16 v[68:71], v[244:247], v[108:111], v[68:71]
    ds_read_b64_tr_b16 v[242:243], v3 offset:51200
    v_cvt_pk_bf16_f32 v41, v50, v51
    s_waitcnt lgkmcnt(4)
    v_mfma_f32_16x16x32_bf16 v[72:75], v[248:251], v[104:107], v[72:75]
    ds_read_b64_tr_b16 v[244:245], v3 offset:57344
    v_cvt_pk_bf16_f32 v42, v52, v53
    v_mfma_f32_16x16x32_bf16 v[76:79], v[248:251], v[108:111], v[76:79]
    ds_read_b64_tr_b16 v[246:247], v3 offset:59392
    v_cvt_pk_bf16_f32 v43, v54, v55
    s_waitcnt lgkmcnt(4)
    v_mfma_f32_16x16x32_bf16 v[80:83], v[252:255], v[104:107], v[80:83]
    ds_read_b64_tr_b16 v[248:249], v4 offset:49152
    v_mfma_f32_16x16x32_bf16 v[84:87], v[252:255], v[108:111], v[84:87]
    ds_read_b64_tr_b16 v[250:251], v4 offset:51200
    s_lshl_b32 s9, s38, 13
    s_add_u32 s9, s9, s47
    buffer_store_dwordx4 v[40:43], v12, s[12:15], s9 offen sc1
    s_waitcnt lgkmcnt(4)
    v_mfma_f32_16x16x32_bf16 v[24:27], v[240:243], v[96:99], 0
    ds_read_b64_tr_b16 v[252:253], v4 offset:57344
    v_mfma_f32_16x16x32_bf16 v[28:31], v[240:243], v[100:103], 0
    ds_read_b64_tr_b16 v[254:255], v4 offset:59392
    s_waitcnt lgkmcnt(4)
    v_mfma_f32_16x16x32_bf16 v[32:35], v[244:247], v[96:99], 0
    ds_read_b64_tr_b16 v[240:241], v3 offset:53248
    v_mfma_f32_16x16x32_bf16 v[36:39], v[244:247], v[100:103], 0
    ds_read_b64_tr_b16 v[242:243], v3 offset:55296
    s_add_u32 s9, s44, s61
    s_add_u32 m0, s41, 114688
    s_nop 0
    buffer_load_dwordx4 v9, s[24:27], s9 offen  lds
    s_waitcnt lgkmcnt(4)
    v_mfma_f32_16x16x32_bf16 v[40:43], v[248:251], v[96:99], 0
    ds_read_b64_tr_b16 v[244:245], v3 offset:61440
    v_mfma_f32_16x16x32_bf16 v[44:47], v[248:251], v[100:103], 0
    ds_read_b64_tr_b16 v[246:247], v3 offset:63488
    s_waitcnt lgkmcnt(4)
    v_mfma_f32_16x16x32_bf16 v[48:51], v[252:255], v[96:99], 0
    ds_read_b64_tr_b16 v[248:249], v4 offset:53248
    v_mfma_f32_16x16x32_bf16 v[52:55], v[252:255], v[100:103], 0
    ds_read_b64_tr_b16 v[250:251], v4 offset:55296
    s_waitcnt lgkmcnt(4)
    v_mfma_f32_16x16x32_bf16 v[24:27], v[240:243], v[104:107], v[24:27]
    ds_read_b64_tr_b16 v[252:253], v4 offset:61440
    v_mfma_f32_16x16x32_bf16 v[28:31], v[240:243], v[108:111], v[28:31]
    ds_read_b64_tr_b16 v[254:255], v4 offset:63488
    s_waitcnt lgkmcnt(4)
    v_mfma_f32_16x16x32_bf16 v[32:35], v[244:247], v[104:107], v[32:35]
    ds_read_b64_tr_b16 v[240:241], v5 offset:0
    v_mfma_f32_16x16x32_bf16 v[36:39], v[244:247], v[108:111], v[36:39]
    ds_read_b64_tr_b16 v[242:243], v5 offset:2048
    s_waitcnt lgkmcnt(4)
    v_mfma_f32_16x16x32_bf16 v[40:43], v[248:251], v[104:107], v[40:43]
    ds_read_b64_tr_b16 v[244:245], v5 offset:8192
    v_mfma_f32_16x16x32_bf16 v[44:47], v[248:251], v[108:111], v[44:47]
    ds_read_b64_tr_b16 v[246:247], v5 offset:10240
    s_waitcnt lgkmcnt(4)
    v_mfma_f32_16x16x32_bf16 v[48:51], v[252:255], v[104:107], v[48:51]
    ds_read_b64_tr_b16 v[248:249], v6 offset:0
    v_mfma_f32_16x16x32_bf16 v[52:55], v[252:255], v[108:111], v[52:55]
    ds_read_b64_tr_b16 v[250:251], v6 offset:2048
    s_add_u32 s9, s45, s61
    s_add_u32 m0, s41, 122880
    s_nop 0
    buffer_load_dwordx4 v9, s[24:27], s9 offen  lds
    s_waitcnt lgkmcnt(4)
    v_mfma_f32_16x16x32_bf16 v[24:27], v[240:243], v[112:115], v[24:27]
    ds_read_b64_tr_b16 v[252:253], v6 offset:8192
    v_mfma_f32_16x16x32_bf16 v[28:31], v[240:243], v[116:119], v[28:31]
    ds_read_b64_tr_b16 v[254:255], v6 offset:10240
    s_waitcnt lgkmcnt(4)
    v_mfma_f32_16x16x32_bf16 v[32:35], v[244:247], v[112:115], v[32:35]
    ds_read_b64_tr_b16 v[240:241], v5 offset:512
    v_mfma_f32_16x16x32_bf16 v[36:39], v[244:247], v[116:119], v[36:39]
    ds_read_b64_tr_b16 v[242:243], v5 offset:2560
    s_waitcnt lgkmcnt(4)
    v_mfma_f32_16x16x32_bf16 v[40:43], v[248:251], v[112:115], v[40:43]
    ds_read_b64_tr_b16 v[244:245], v5 offset:8704
    v_mfma_f32_16x16x32_bf16 v[44:47], v[248:251], v[116:119], v[44:47]
    ds_read_b64_tr_b16 v[246:247], v5 offset:10752
    s_waitcnt lgkmcnt(4)
    v_mfma_f32_16x16x32_bf16 v[48:51], v[252:255], v[112:115], v[48:51]
    ds_read_b64_tr_b16 v[248:249], v6 offset:512
    v_mfma_f32_16x16x32_bf16 v[52:55], v[252:255], v[116:119], v[52:55]
    ds_read_b64_tr_b16 v[250:251], v6 offset:2560
    s_waitcnt lgkmcnt(4)
    v_mfma_f32_16x16x32_bf16 v[56:59], v[240:243], v[112:115], v[56:59]
    ds_read_b64_tr_b16 v[252:253], v6 offset:8704
    v_mfma_f32_16x16x32_bf16 v[60:63], v[240:243], v[116:119], v[60:63]
    ds_read_b64_tr_b16 v[254:255], v6 offset:10752
    s_cmp_ge_u32 s36, 2
    s_cbranch_scc1 sequential_preLN__sliding_block__glu_gated_bilinear__prompt_kernel_r289
    s_add_u32 s9, s53, 53248
    s_add_u32 m0, s41, 161792
    s_nop 0
    buffer_load_dwordx4 v12, s[12:15], s9 offen sc1 lds
sequential_preLN__sliding_block__glu_gated_bilinear__prompt_kernel_r289:
    s_waitcnt lgkmcnt(4)
    v_mfma_f32_16x16x32_bf16 v[64:67], v[244:247], v[112:115], v[64:67]
    ds_read_b64_tr_b16 v[240:241], v5 offset:4096
    v_mfma_f32_16x16x32_bf16 v[68:71], v[244:247], v[116:119], v[68:71]
    ds_read_b64_tr_b16 v[242:243], v5 offset:6144
    s_waitcnt lgkmcnt(4)
    v_mfma_f32_16x16x32_bf16 v[72:75], v[248:251], v[112:115], v[72:75]
    ds_read_b64_tr_b16 v[244:245], v5 offset:12288
    v_mfma_f32_16x16x32_bf16 v[76:79], v[248:251], v[116:119], v[76:79]
    ds_read_b64_tr_b16 v[246:247], v5 offset:14336
    s_waitcnt lgkmcnt(4)
    v_mfma_f32_16x16x32_bf16 v[80:83], v[252:255], v[112:115], v[80:83]
    ds_read_b64_tr_b16 v[248:249], v6 offset:4096
    v_mfma_f32_16x16x32_bf16 v[84:87], v[252:255], v[116:119], v[84:87]
    ds_read_b64_tr_b16 v[250:251], v6 offset:6144
    s_waitcnt lgkmcnt(4)
    v_mfma_f32_16x16x32_bf16 v[24:27], v[240:243], v[120:123], v[24:27]
    ds_read_b64_tr_b16 v[252:253], v6 offset:12288
    v_mfma_f32_16x16x32_bf16 v[28:31], v[240:243], v[124:127], v[28:31]
    ds_read_b64_tr_b16 v[254:255], v6 offset:14336
    s_waitcnt lgkmcnt(4)
    v_mfma_f32_16x16x32_bf16 v[32:35], v[244:247], v[120:123], v[32:35]
    ds_read_b64_tr_b16 v[240:241], v5 offset:4608
    v_mfma_f32_16x16x32_bf16 v[36:39], v[244:247], v[124:127], v[36:39]
    ds_read_b64_tr_b16 v[242:243], v5 offset:6656
    s_waitcnt lgkmcnt(4)
    v_mfma_f32_16x16x32_bf16 v[40:43], v[248:251], v[120:123], v[40:43]
    ds_read_b64_tr_b16 v[244:245], v5 offset:12800
    s_xor_b32 s9, s54, 0
    s_add_u32 s9, s9, s52
    s_add_u32 m0, s41, 145408
    s_nop 0
    buffer_load_dwordx4 v12, s[12:15], s9 offen sc1 lds
    v_mfma_f32_16x16x32_bf16 v[44:47], v[248:251], v[124:127], v[44:47]
    ds_read_b64_tr_b16 v[246:247], v5 offset:14848
    s_waitcnt vmcnt(3)
    v_mov_b32 v1, 1
    s_mov_b64 exec, 1
    buffer_store_dword v1, off, s[12:15], s50 sc1
    buffer_store_dword v1, off, s[12:15], s57 sc1
    s_mov_b64 exec, -1
    s_waitcnt lgkmcnt(4)
    v_mfma_f32_16x16x32_bf16 v[48:51], v[252:255], v[120:123], v[48:51]
    ds_read_b64_tr_b16 v[248:249], v6 offset:4608
    v_mfma_f32_16x16x32_bf16 v[52:55], v[252:255], v[124:127], v[52:55]
    ds_read_b64_tr_b16 v[250:251], v6 offset:6656
    s_waitcnt lgkmcnt(4)
    v_mfma_f32_16x16x32_bf16 v[56:59], v[240:243], v[120:123], v[56:59]
    ds_read_b64_tr_b16 v[252:253], v6 offset:12800
    v_mfma_f32_16x16x32_bf16 v[60:63], v[240:243], v[124:127], v[60:63]
    ds_read_b64_tr_b16 v[254:255], v6 offset:14848
    s_waitcnt lgkmcnt(4)
    v_mfma_f32_16x16x32_bf16 v[64:67], v[244:247], v[120:123], v[64:67]
    ds_read_b64_tr_b16 v[240:241], v5 offset:16384
    v_mfma_f32_16x16x32_bf16 v[68:71], v[244:247], v[124:127], v[68:71]
    ds_read_b64_tr_b16 v[242:243], v5 offset:18432
    s_waitcnt lgkmcnt(4)
    v_mfma_f32_16x16x32_bf16 v[72:75], v[248:251], v[120:123], v[72:75]
    ds_read_b64_tr_b16 v[244:245], v5 offset:24576
    v_mfma_f32_16x16x32_bf16 v[76:79], v[248:251], v[124:127], v[76:79]
    ds_read_b64_tr_b16 v[246:247], v5 offset:26624
    s_waitcnt lgkmcnt(4)
    v_mfma_f32_16x16x32_bf16 v[80:83], v[252:255], v[120:123], v[80:83]
    ds_read_b64_tr_b16 v[248:249], v6 offset:16384
    v_mfma_f32_16x16x32_bf16 v[84:87], v[252:255], v[124:127], v[84:87]
    ds_read_b64_tr_b16 v[250:251], v6 offset:18432
    s_waitcnt lgkmcnt(4)
    v_mfma_f32_16x16x32_bf16 v[24:27], v[240:243], v[128:131], v[24:27]
    ds_read_b64_tr_b16 v[252:253], v6 offset:24576
    v_mfma_f32_16x16x32_bf16 v[28:31], v[240:243], v[132:135], v[28:31]
    ds_read_b64_tr_b16 v[254:255], v6 offset:26624
    s_xor_b32 s9, s54, 8192
    s_add_u32 s9, s9, s52
    s_add_u32 m0, s41, 153600
    s_nop 0
    buffer_load_dwordx4 v12, s[12:15], s9 offen sc1 lds
    s_waitcnt lgkmcnt(4)
    v_mfma_f32_16x16x32_bf16 v[32:35], v[244:247], v[128:131], v[32:35]
    ds_read_b64_tr_b16 v[240:241], v5 offset:16896
    v_mfma_f32_16x16x32_bf16 v[36:39], v[244:247], v[132:135], v[36:39]
    ds_read_b64_tr_b16 v[242:243], v5 offset:18944
    s_waitcnt lgkmcnt(4)
    v_mfma_f32_16x16x32_bf16 v[40:43], v[248:251], v[128:131], v[40:43]
    ds_read_b64_tr_b16 v[244:245], v5 offset:25088
    v_mfma_f32_16x16x32_bf16 v[44:47], v[248:251], v[132:135], v[44:47]
    ds_read_b64_tr_b16 v[246:247], v5 offset:27136
    s_waitcnt lgkmcnt(4)
pg_b:
    s_cbranch_execz pf_ret
    v_mfma_f32_16x16x32_bf16 v[48:51], v[252:255], v[128:131], v[48:51]
    ds_read_b64_tr_b16 v[248:249], v6 offset:16896
    v_mfma_f32_16x16x32_bf16 v[52:55], v[252:255], v[132:135], v[52:55]
    ds_read_b64_tr_b16 v[250:251], v6 offset:18944
    s_waitcnt lgkmcnt(4)
    v_mfma_f32_16x16x32_bf16 v[56:59], v[240:243], v[128:131], v[56:59]
    ds_read_b64_tr_b16 v[252:253], v6 offset:25088
    v_mfma_f32_16x16x32_bf16 v[60:63], v[240:243], v[132:135], v[60:63]
    ds_read_b64_tr_b16 v[254:255], v6 offset:27136
    s_waitcnt lgkmcnt(4)
    v_mfma_f32_16x16x32_bf16 v[64:67], v[244:247], v[128:131], v[64:67]
    ds_read_b64_tr_b16 v[240:241], v5 offset:20480
    v_mfma_f32_16x16x32_bf16 v[68:71], v[244:247], v[132:135], v[68:71]
    ds_read_b64_tr_b16 v[242:243], v5 offset:22528
    s_waitcnt lgkmcnt(4)
    v_mfma_f32_16x16x32_bf16 v[72:75], v[248:251], v[128:131], v[72:75]
    ds_read_b64_tr_b16 v[244:245], v5 offset:28672
    v_mfma_f32_16x16x32_bf16 v[76:79], v[248:251], v[132:135], v[76:79]
    ds_read_b64_tr_b16 v[246:247], v5 offset:30720
    buffer_load_dword v15, v14, s[12:15], s49 offen sc1
    s_waitcnt lgkmcnt(4)
    v_mfma_f32_16x16x32_bf16 v[80:83], v[252:255], v[128:131], v[80:83]
    ds_read_b64_tr_b16 v[248:249], v6 offset:20480
    v_mfma_f32_16x16x32_bf16 v[84:87], v[252:255], v[132:135], v[84:87]
    ds_read_b64_tr_b16 v[250:251], v6 offset:22528
    s_waitcnt lgkmcnt(4)
    v_mfma_f32_16x16x32_bf16 v[24:27], v[240:243], v[136:139], v[24:27]
    ds_read_b64_tr_b16 v[252:253], v6 offset:28672
    v_mfma_f32_16x16x32_bf16 v[28:31], v[240:243], v[140:143], v[28:31]
    ds_read_b64_tr_b16 v[254:255], v6 offset:30720
    s_waitcnt lgkmcnt(4)
    v_mfma_f32_16x16x32_bf16 v[32:35], v[244:247], v[136:139], v[32:35]
    ds_read_b64_tr_b16 v[240:241], v5 offset:20992
    v_mfma_f32_16x16x32_bf16 v[36:39], v[244:247], v[140:143], v[36:39]
    ds_read_b64_tr_b16 v[242:243], v5 offset:23040
    s_waitcnt lgkmcnt(4)
    v_mfma_f32_16x16x32_bf16 v[40:43], v[248:251], v[136:139], v[40:43]
    ds_read_b64_tr_b16 v[244:245], v5 offset:29184
    v_mfma_f32_16x16x32_bf16 v[44:47], v[248:251], v[140:143], v[44:47]
    ds_read_b64_tr_b16 v[246:247], v5 offset:31232
    s_waitcnt lgkmcnt(4)
    v_mfma_f32_16x16x32_bf16 v[48:51], v[252:255], v[136:139], v[48:51]
    ds_read_b64_tr_b16 v[248:249], v6 offset:20992
    v_mfma_f32_16x16x32_bf16 v[52:55], v[252:255], v[140:143], v[52:55]
    ds_read_b64_tr_b16 v[250:251], v6 offset:23040
    s_waitcnt lgkmcnt(4)
    v_mfma_f32_16x16x32_bf16 v[56:59], v[240:243], v[136:139], v[56:59]
    ds_read_b64_tr_b16 v[252:253], v6 offset:29184
    v_mfma_f32_16x16x32_bf16 v[60:63], v[240:243], v[140:143], v[60:63]
    ds_read_b64_tr_b16 v[254:255], v6 offset:31232
    s_waitcnt lgkmcnt(4)
    v_mfma_f32_16x16x32_bf16 v[64:67], v[244:247], v[136:139], v[64:67]
    v_mfma_f32_16x16x32_bf16 v[68:71], v[244:247], v[140:143], v[68:71]
    s_waitcnt vmcnt(11)
    s_barrier
    ds_read_b64_tr_b16 v[240:241], v3 offset:0
    ds_read_b64_tr_b16 v[242:243], v3 offset:2048
    s_waitcnt lgkmcnt(4)
    v_mfma_f32_16x16x32_bf16 v[72:75], v[248:251], v[136:139], v[72:75]
    ds_read_b64_tr_b16 v[244:245], v3 offset:8192
    v_mfma_f32_16x16x32_bf16 v[76:79], v[248:251], v[140:143], v[76:79]
    ds_read_b64_tr_b16 v[246:247], v3 offset:10240
    s_add_u32 s9, s43, 3539072
    s_add_u32 m0, s42, 49152
    s_nop 0
    buffer_load_dwordx4 v8, s[16:19], s9 offen  lds
    s_waitcnt lgkmcnt(4)
    v_mfma_f32_16x16x32_bf16 v[80:83], v[252:255], v[136:139], v[80:83]
    ds_read_b64_tr_b16 v[248:249], v4 offset:0
    v_mfma_f32_16x16x32_bf16 v[84:87], v[252:255], v[140:143], v[84:87]
    ds_read_b64_tr_b16 v[250:251], v4 offset:2048
    s_waitcnt lgkmcnt(4)
    v_mfma_f32_16x16x32_bf16 v[24:27], v[240:243], v[144:147], v[24:27]
    ds_read_b64_tr_b16 v[252:253], v4 offset:8192
    v_mfma_f32_16x16x32_bf16 v[28:31], v[240:243], v[148:151], v[28:31]
    ds_read_b64_tr_b16 v[254:255], v4 offset:10240
    s_waitcnt vmcnt(1)
    v_cmp_gt_i32 vcc, 1, v15
    s_nop 0
    s_and_b32 vcc_lo, vcc_lo, 15
    s_cbranch_scc1 sequential_preLN__sliding_block__glu_gated_bilinear__prompt_kernel_spin90
sequential_preLN__sliding_block__glu_gated_bilinear__prompt_kernel_go91:
    s_waitcnt lgkmcnt(4)
    v_mfma_f32_16x16x32_bf16 v[32:35], v[244:247], v[144:147], v[32:35]
    ds_read_b64_tr_b16 v[240:241], v3 offset:512
    v_mfma_f32_16x16x32_bf16 v[36:39], v[244:247], v[148:151], v[36:39]
    ds_read_b64_tr_b16 v[242:243], v3 offset:2560
    s_xor_b32 s9, s48, 0x0
    buffer_load_dwordx4 v[96:99], v12, s[12:15], s9 offen sc1
    s_waitcnt lgkmcnt(4)
    v_mfma_f32_16x16x32_bf16 v[40:43], v[248:251], v[144:147], v[40:43]
    ds_read_b64_tr_b16 v[244:245], v3 offset:8704
    v_mfma_f32_16x16x32_bf16 v[44:47], v[248:251], v[148:151], v[44:47]
    ds_read_b64_tr_b16 v[246:247], v3 offset:10752
    s_waitcnt vmcnt(20)
    v_max_u32 v15, v20, v20
    v_max3_u32 v15, v88, v89, v15
    v_max3_u32 v15, v90, v91, v15
    v_cmp_eq_u32 vcc, -1, v15
    s_cbranch_vccnz sequential_preLN__sliding_block__glu_gated_bilinear__prompt_kernel_retry92
sequential_preLN__sliding_block__glu_gated_bilinear__prompt_kernel_ok93:
    s_waitcnt lgkmcnt(4)
    v_mfma_f32_16x16x32_bf16 v[48:51], v[252:255], v[144:147], v[48:51]
    ds_read_b64_tr_b16 v[248:249], v4 offset:512
    s_add_u32 s9, s43, 3539072
    s_add_u32 m0, s42, 57344
    s_nop 0
    buffer_load_dwordx4 v8, s[20:23], s9 offen  lds
    v_mfma_f32_16x16x32_bf16 v[52:55], v[252:255], v[148:151], v[52:55]
    ds_read_b64_tr_b16 v[250:251], v4 offset:2560
    v_add_f32 v88, v88, v89
    s_waitcnt lgkmcnt(4)
    v_mfma_f32_16x16x32_bf16 v[56:59], v[240:243], v[144:147], v[56:59]
    ds_read_b64_tr_b16 v[252:253], v4 offset:8704
    s_xor_b32 s9, s48, 0x2000
    buffer_load_dwordx4 v[100:103], v12, s[12:15], s9 offen sc1
    v_mfma_f32_16x16x32_bf16 v[60:63], v[240:243], v[148:151], v[60:63]
    ds_read_b64_tr_b16 v[254:255], v4 offset:10752
    v_add_f32 v90, v90, v91
    s_waitcnt lgkmcnt(4)
    v_mfma_f32_16x16x32_bf16 v[64:67], v[244:247], v[144:147], v[64:67]
    ds_read_b64_tr_b16 v[240:241], v3 offset:4096
    v_mfma_f32_16x16x32_bf16 v[68:71], v[244:247], v[148:151], v[68:71]
    ds_read_b64_tr_b16 v[242:243], v3 offset:6144
    v_add_f32 v88, v88, v90
    s_waitcnt lgkmcnt(4)
    v_mfma_f32_16x16x32_bf16 v[72:75], v[248:251], v[144:147], v[72:75]
    ds_read_b64_tr_b16 v[244:245], v3 offset:12288
    v_mfma_f32_16x16x32_bf16 v[76:79], v[248:251], v[148:151], v[76:79]
    ds_read_b64_tr_b16 v[246:247], v3 offset:14336
    v_mov_b32 v89, 0x3727c5ac
    s_waitcnt lgkmcnt(4)
    v_mfma_f32_16x16x32_bf16 v[80:83], v[252:255], v[144:147], v[80:83]
    ds_read_b64_tr_b16 v[248:249], v4 offset:4096
    v_mfma_f32_16x16x32_bf16 v[84:87], v[252:255], v[148:151], v[84:87]
    ds_read_b64_tr_b16 v[250:251], v4 offset:6144
    v_fmac_f32 v89, 0x3ae38e39, v88
    s_waitcnt lgkmcnt(4)
    v_mfma_f32_16x16x32_bf16 v[24:27], v[240:243], v[152:155], v[24:27]
    ds_read_b64_tr_b16 v[252:253], v4 offset:12288
    s_add_u32 s9, s43, 4128896
    s_add_u32 m0, s42, 65536
    s_nop 0
    buffer_load_dwordx4 v8, s[16:19], s9 offen  lds
    v_mfma_f32_16x16x32_bf16 v[28:31], v[240:243], v[156:159], v[28:31]
    ds_read_b64_tr_b16 v[254:255], v4 offset:14336
    s_xor_b32 s9, s48, 0x4000
    buffer_load_dwordx4 v[104:107], v12, s[12:15], s9 offen sc1
    s_waitcnt lgkmcnt(4)
    v_mfma_f32_16x16x32_bf16 v[32:35], v[244:247], v[152:155], v[32:35]
    ds_read_b64_tr_b16 v[240:241], v3 offset:4608
    v_mfma_f32_16x16x32_bf16 v[36:39], v[244:247], v[156:159], v[36:39]
    ds_read_b64_tr_b16 v[242:243], v3 offset:6656
    v_rcp_f32 v16, v89
    s_waitcnt lgkmcnt(4)
    v_mfma_f32_16x16x32_bf16 v[40:43], v[248:251], v[152:155], v[40:43]
    ds_read_b64_tr_b16 v[244:245], v3 offset:12800
    v_mfma_f32_16x16x32_bf16 v[44:47], v[248:251], v[156:159], v[44:47]
    ds_read_b64_tr_b16 v[246:247], v3 offset:14848
    v_mul_f32 v20, v20, v89
    s_waitcnt lgkmcnt(4)
    v_mfma_f32_16x16x32_bf16 v[48:51], v[252:255], v[152:155], v[48:51]
    ds_read_b64_tr_b16 v[248:249], v4 offset:4608
    v_mfma_f32_16x16x32_bf16 v[52:55], v[252:255], v[156:159], v[52:55]
    ds_read_b64_tr_b16 v[250:251], v4 offset:6656
    v_mov_b32 v17, v16
    s_waitcnt lgkmcnt(4)
    v_mfma_f32_16x16x32_bf16 v[56:59], v[240:243], v[152:155], v[56:59]
    ds_read_b64_tr_b16 v[252:253], v4 offset:12800
    s_xor_b32 s9, s48, 0x6000
    buffer_load_dwordx4 v[108:111], v12, s[12:15], s9 offen sc1
    v_mfma_f32_16x16x32_bf16 v[60:63], v[240:243], v[156:159], v[60:63]
    ds_read_b64_tr_b16 v[254:255], v4 offset:14848
    v_mov_b32 v21, v20
    s_waitcnt lgkmcnt(4)
    v_mfma_f32_16x16x32_bf16 v[64:67], v[244:247], v[152:155], v[64:67]
    ds_read_b64_tr_b16 v[240:241], v3 offset:16384
    s_add_u32 s9, s43, 4128896
    s_add_u32 m0, s42, 73728
    s_nop 0
    buffer_load_dwordx4 v8, s[20:23], s9 offen  lds
    v_mfma_f32_16x16x32_bf16 v[68:71], v[244:247], v[156:159], v[68:71]
    ds_read_b64_tr_b16 v[242:243], v3 offset:18432
    v_permlane32_swap_b32 v16, v17
    s_waitcnt lgkmcnt(4)
    v_mfma_f32_16x16x32_bf16 v[72:75], v[248:251], v[152:155], v[72:75]
    ds_read_b64_tr_b16 v[244:245], v3 offset:24576
    v_mfma_f32_16x16x32_bf16 v[76:79], v[248:251], v[156:159], v[76:79]
    ds_read_b64_tr_b16 v[246:247], v3 offset:26624
    v_permlane32_swap_b32 v20, v21
    s_waitcnt lgkmcnt(4)
    v_mfma_f32_16x16x32_bf16 v[80:83], v[252:255], v[152:155], v[80:83]
    ds_read_b64_tr_b16 v[248:249], v4 offset:16384
    v_mfma_f32_16x16x32_bf16 v[84:87], v[252:255], v[156:159], v[84:87]
    ds_read_b64_tr_b16 v[250:251], v4 offset:18432
    s_waitcnt lgkmcnt(4)
    v_mfma_f32_16x16x32_bf16 v[24:27], v[240:243], v[160:163], v[24:27]
    ds_read_b64_tr_b16 v[252:253], v4 offset:24576
    v_mfma_f32_16x16x32_bf16 v[28:31], v[240:243], v[164:167], v[28:31]
    ds_read_b64_tr_b16 v[254:255], v4 offset:26624
    s_xor_b32 s9, s48, 0x10000
    buffer_load_dwordx4 v[112:115], v12, s[12:15], s9 offen sc1
    s_waitcnt lgkmcnt(4)
    v_mfma_f32_16x16x32_bf16 v[32:35], v[244:247], v[160:163], v[32:35]
    ds_read_b64_tr_b16 v[240:241], v3 offset:16896
    v_mfma_f32_16x16x32_bf16 v[36:39], v[244:247], v[164:167], v[36:39]
    ds_read_b64_tr_b16 v[242:243], v3 offset:18944
    s_waitcnt lgkmcnt(4)
    v_mfma_f32_16x16x32_bf16 v[40:43], v[248:251], v[160:163], v[40:43]
    ds_read_b64_tr_b16 v[244:245], v3 offset:25088
    v_mfma_f32_16x16x32_bf16 v[44:47], v[248:251], v[164:167], v[44:47]
    ds_read_b64_tr_b16 v[246:247], v3 offset:27136
    s_add_u32 s9, s43, 4718720
    s_add_u32 m0, s42, 81920
    s_nop 0
    buffer_load_dwordx4 v8, s[16:19], s9 offen  lds
    s_waitcnt lgkmcnt(4)
    v_mfma_f32_16x16x32_bf16 v[48:51], v[252:255], v[160:163], v[48:51]
    ds_read_b64_tr_b16 v[248:249], v4 offset:16896
    v_mfma_f32_16x16x32_bf16 v[52:55], v[252:255], v[164:167], v[52:55]
    ds_read_b64_tr_b16 v[250:251], v4 offset:18944
    s_xor_b32 s9, s48, 0x12000
    buffer_load_dwordx4 v[116:119], v12, s[12:15], s9 offen sc1
    s_waitcnt lgkmcnt(4)
    v_mfma_f32_16x16x32_bf16 v[56:59], v[240:243], v[160:163], v[56:59]
    ds_read_b64_tr_b16 v[252:253], v4 offset:25088
    v_mfma_f32_16x16x32_bf16 v[60:63], v[240:243], v[164:167], v[60:63]
    ds_read_b64_tr_b16 v[254:255], v4 offset:27136
    s_waitcnt lgkmcnt(4)
    v_mfma_f32_16x16x32_bf16 v[64:67], v[244:247], v[160:163], v[64:67]
    ds_read_b64_tr_b16 v[240:241], v3 offset:20480
    v_mfma_f32_16x16x32_bf16 v[68:71], v[244:247], v[164:167], v[68:71]
    ds_read_b64_tr_b16 v[242:243], v3 offset:22528
    s_waitcnt lgkmcnt(4)
    v_mfma_f32_16x16x32_bf16 v[72:75], v[248:251], v[160:163], v[72:75]
    ds_read_b64_tr_b16 v[244:245], v3 offset:28672
    v_mfma_f32_16x16x32_bf16 v[76:79], v[248:251], v[164:167], v[76:79]
    ds_read_b64_tr_b16 v[246:247], v3 offset:30720
    s_waitcnt lgkmcnt(4)
    v_mfma_f32_16x16x32_bf16 v[80:83], v[252:255], v[160:163], v[80:83]
    ds_read_b64_tr_b16 v[248:249], v4 offset:20480
    s_add_u32 s9, s43, 4718720
    s_add_u32 m0, s42, 90112
    s_nop 0
    buffer_load_dwordx4 v8, s[20:23], s9 offen  lds
    v_mfma_f32_16x16x32_bf16 v[84:87], v[252:255], v[164:167], v[84:87]
    ds_read_b64_tr_b16 v[250:251], v4 offset:22528
    s_xor_b32 s9, s48, 0x14000
    buffer_load_dwordx4 v[120:123], v12, s[12:15], s9 offen sc1
    s_waitcnt lgkmcnt(4)
    v_mfma_f32_16x16x32_bf16 v[24:27], v[240:243], v[168:171], v[24:27]
    ds_read_b64_tr_b16 v[252:253], v4 offset:28672
    v_mfma_f32_16x16x32_bf16 v[28:31], v[240:243], v[172:175], v[28:31]
    ds_read_b64_tr_b16 v[254:255], v4 offset:30720
    s_waitcnt lgkmcnt(4)
    v_mfma_f32_16x16x32_bf16 v[32:35], v[244:247], v[168:171], v[32:35]
    ds_read_b64_tr_b16 v[240:241], v3 offset:20992
    v_mfma_f32_16x16x32_bf16 v[36:39], v[244:247], v[172:175], v[36:39]
    ds_read_b64_tr_b16 v[242:243], v3 offset:23040
    s_waitcnt lgkmcnt(4)
    v_mfma_f32_16x16x32_bf16 v[40:43], v[248:251], v[168:171], v[40:43]
    ds_read_b64_tr_b16 v[244:245], v3 offset:29184
    v_mfma_f32_16x16x32_bf16 v[44:47], v[248:251], v[172:175], v[44:47]
    ds_read_b64_tr_b16 v[246:247], v3 offset:31232
    s_waitcnt lgkmcnt(4)
    v_mfma_f32_16x16x32_bf16 v[48:51], v[252:255], v[168:171], v[48:51]
    ds_read_b64_tr_b16 v[248:249], v4 offset:20992
    v_mfma_f32_16x16x32_bf16 v[52:55], v[252:255], v[172:175], v[52:55]
    ds_read_b64_tr_b16 v[250:251], v4 offset:23040
    s_xor_b32 s9, s48, 0x16000
    buffer_load_dwordx4 v[124:127], v12, s[12:15], s9 offen sc1
    s_waitcnt lgkmcnt(4)
    v_mfma_f32_16x16x32_bf16 v[56:59], v[240:243], v[168:171], v[56:59]
    ds_read_b64_tr_b16 v[252:253], v4 offset:29184
    v_mfma_f32_16x16x32_bf16 v[60:63], v[240:243], v[172:175], v[60:63]
    ds_read_b64_tr_b16 v[254:255], v4 offset:31232
    s_waitcnt lgkmcnt(4)
    v_mfma_f32_16x16x32_bf16 v[64:67], v[244:247], v[168:171], v[64:67]
    ds_read_b64_tr_b16 v[240:241], v3 offset:32768
    v_mfma_f32_16x16x32_bf16 v[68:71], v[244:247], v[172:175], v[68:71]
    ds_read_b64_tr_b16 v[242:243], v3 offset:34816
    s_waitcnt lgkmcnt(4)
    v_mfma_f32_16x16x32_bf16 v[72:75], v[248:251], v[168:171], v[72:75]
    ds_read_b64_tr_b16 v[244:245], v3 offset:40960
    v_mfma_f32_16x16x32_bf16 v[76:79], v[248:251], v[172:175], v[76:79]
    ds_read_b64_tr_b16 v[246:247], v3 offset:43008
    s_waitcnt lgkmcnt(4)
    v_mfma_f32_16x16x32_bf16 v[80:83], v[252:255], v[168:171], v[80:83]
    ds_read_b64_tr_b16 v[248:249], v4 offset:32768
    v_mfma_f32_16x16x32_bf16 v[84:87], v[252:255], v[172:175], v[84:87]
    ds_read_b64_tr_b16 v[250:251], v4 offset:34816
    s_xor_b32 s9, s48, 0x20000
    buffer_load_dwordx4 v[128:131], v12, s[12:15], s9 offen sc1
    s_waitcnt lgkmcnt(4)
    v_mfma_f32_16x16x32_bf16 v[24:27], v[240:243], v[176:179], v[24:27]
    ds_read_b64_tr_b16 v[252:253], v4 offset:40960
    v_mfma_f32_16x16x32_bf16 v[28:31], v[240:243], v[180:183], v[28:31]
    ds_read_b64_tr_b16 v[254:255], v4 offset:43008
    s_waitcnt lgkmcnt(4)
    v_mfma_f32_16x16x32_bf16 v[32:35], v[244:247], v[176:179], v[32:35]
    ds_read_b64_tr_b16 v[240:241], v3 offset:33280
    v_mfma_f32_16x16x32_bf16 v[36:39], v[244:247], v[180:183], v[36:39]
    ds_read_b64_tr_b16 v[242:243], v3 offset:35328
    s_waitcnt lgkmcnt(4)
    v_mfma_f32_16x16x32_bf16 v[40:43], v[248:251], v[176:179], v[40:43]
    ds_read_b64_tr_b16 v[244:245], v3 offset:41472
    v_mfma_f32_16x16x32_bf16 v[44:47], v[248:251], v[180:183], v[44:47]
    ds_read_b64_tr_b16 v[246:247], v3 offset:43520
    s_xor_b32 s9, s48, 0x22000
    buffer_load_dwordx4 v[132:135], v12, s[12:15], s9 offen sc1
    s_waitcnt lgkmcnt(4)
    v_mfma_f32_16x16x32_bf16 v[48:51], v[252:255], v[176:179], v[48:51]
    ds_read_b64_tr_b16 v[248:249], v4 offset:33280
    v_mfma_f32_16x16x32_bf16 v[52:55], v[252:255], v[180:183], v[52:55]
    ds_read_b64_tr_b16 v[250:251], v4 offset:35328
    s_waitcnt lgkmcnt(4)
    v_mfma_f32_16x16x32_bf16 v[56:59], v[240:243], v[176:179], v[56:59]
    ds_read_b64_tr_b16 v[252:253], v4 offset:41472
    v_mfma_f32_16x16x32_bf16 v[60:63], v[240:243], v[180:183], v[60:63]
    ds_read_b64_tr_b16 v[254:255], v4 offset:43520
    s_waitcnt lgkmcnt(4)
    v_mfma_f32_16x16x32_bf16 v[64:67], v[244:247], v[176:179], v[64:67]
    ds_read_b64_tr_b16 v[240:241], v3 offset:36864
    v_mfma_f32_16x16x32_bf16 v[68:71], v[244:247], v[180:183], v[68:71]
    ds_read_b64_tr_b16 v[242:243], v3 offset:38912
    s_waitcnt lgkmcnt(4)
    v_mfma_f32_16x16x32_bf16 v[72:75], v[248:251], v[176:179], v[72:75]
    ds_read_b64_tr_b16 v[244:245], v3 offset:45056
    v_mfma_f32_16x16x32_bf16 v[76:79], v[248:251], v[180:183], v[76:79]
    ds_read_b64_tr_b16 v[246:247], v3 offset:47104
    s_xor_b32 s9, s48, 0x24000
    buffer_load_dwordx4 v[136:139], v12, s[12:15], s9 offen sc1
    s_waitcnt lgkmcnt(4)
    v_mfma_f32_16x16x32_bf16 v[80:83], v[252:255], v[176:179], v[80:83]
    ds_read_b64_tr_b16 v[248:249], v4 offset:36864
    v_mfma_f32_16x16x32_bf16 v[84:87], v[252:255], v[180:183], v[84:87]
    ds_read_b64_tr_b16 v[250:251], v4 offset:38912
    s_waitcnt lgkmcnt(4)
    v_mfma_f32_16x16x32_bf16 v[24:27], v[240:243], v[184:187], v[24:27]
    ds_read_b64_tr_b16 v[252:253], v4 offset:45056
    v_mfma_f32_16x16x32_bf16 v[28:31], v[240:243], v[188:191], v[28:31]
    ds_read_b64_tr_b16 v[254:255], v4 offset:47104
    s_waitcnt lgkmcnt(4)
    v_mfma_f32_16x16x32_bf16 v[32:35], v[244:247], v[184:187], v[32:35]
    ds_read_b64_tr_b16 v[240:241], v3 offset:37376
    v_mfma_f32_16x16x32_bf16 v[36:39], v[244:247], v[188:191], v[36:39]
    ds_read_b64_tr_b16 v[242:243], v3 offset:39424
    s_waitcnt lgkmcnt(4)
    v_mfma_f32_16x16x32_bf16 v[40:43], v[248:251], v[184:187], v[40:43]
    ds_read_b64_tr_b16 v[244:245], v3 offset:45568
    v_mfma_f32_16x16x32_bf16 v[44:47], v[248:251], v[188:191], v[44:47]
    ds_read_b64_tr_b16 v[246:247], v3 offset:47616
    s_xor_b32 s9, s48, 0x26000
    buffer_load_dwordx4 v[140:143], v12, s[12:15], s9 offen sc1
    s_waitcnt lgkmcnt(4)
    v_mfma_f32_16x16x32_bf16 v[48:51], v[252:255], v[184:187], v[48:51]
    ds_read_b64_tr_b16 v[248:249], v4 offset:37376
    v_mfma_f32_16x16x32_bf16 v[52:55], v[252:255], v[188:191], v[52:55]
    ds_read_b64_tr_b16 v[250:251], v4 offset:39424
    s_waitcnt lgkmcnt(4)
    v_mfma_f32_16x16x32_bf16 v[56:59], v[240:243], v[184:187], v[56:59]
    ds_read_b64_tr_b16 v[252:253], v4 offset:45568
    v_mfma_f32_16x16x32_bf16 v[60:63], v[240:243], v[188:191], v[60:63]
    ds_read_b64_tr_b16 v[254:255], v4 offset:47616
    s_waitcnt lgkmcnt(4)
    v_mfma_f32_16x16x32_bf16 v[64:67], v[244:247], v[184:187], v[64:67]
    v_mfma_f32_16x16x32_bf16 v[68:71], v[244:247], v[188:191], v[68:71]
    s_waitcnt vmcnt(6)
    s_barrier
    ds_read_b64_tr_b16 v[240:241], v3 offset:49152
    ds_read_b64_tr_b16 v[242:243], v3 offset:51200
    s_waitcnt lgkmcnt(4)
    v_mfma_f32_16x16x32_bf16 v[72:75], v[248:251], v[184:187], v[72:75]
    ds_read_b64_tr_b16 v[244:245], v3 offset:57344
    s_add_u32 s9, s44, s62
    s_add_u32 m0, s41, 0
    s_nop 0
    buffer_load_dwordx4 v9, s[24:27], s9 offen  lds
    v_mfma_f32_16x16x32_bf16 v[76:79], v[248:251], v[188:191], v[76:79]
    ds_read_b64_tr_b16 v[246:247], v3 offset:59392
    s_xor_b32 s9, s48, 0x30000
    buffer_load_dwordx4 v[144:147], v12, s[12:15], s9 offen sc1
    s_waitcnt lgkmcnt(4)
    v_mfma_f32_16x16x32_bf16 v[80:83], v[252:255], v[184:187], v[80:83]
    ds_read_b64_tr_b16 v[248:249], v4 offset:49152
    v_mfma_f32_16x16x32_bf16 v[84:87], v[252:255], v[188:191], v[84:87]
    ds_read_b64_tr_b16 v[250:251], v4 offset:51200
    s_waitcnt lgkmcnt(4)
    v_mfma_f32_16x16x32_bf16 v[24:27], v[240:243], v[192:195], v[24:27]
    ds_read_b64_tr_b16 v[252:253], v4 offset:57344
    v_mfma_f32_16x16x32_bf16 v[28:31], v[240:243], v[196:199], v[28:31]
    ds_read_b64_tr_b16 v[254:255], v4 offset:59392
    s_waitcnt lgkmcnt(4)
    v_mfma_f32_16x16x32_bf16 v[32:35], v[244:247], v[192:195], v[32:35]
    ds_read_b64_tr_b16 v[240:241], v3 offset:53248
    v_mfma_f32_16x16x32_bf16 v[36:39], v[244:247], v[196:199], v[36:39]
    ds_read_b64_tr_b16 v[242:243], v3 offset:55296
    s_xor_b32 s9, s48, 0x32000
    buffer_load_dwordx4 v[148:151], v12, s[12:15], s9 offen sc1
    s_waitcnt lgkmcnt(4)
    v_mfma_f32_16x16x32_bf16 v[40:43], v[248:251], v[192:195], v[40:43]
    ds_read_b64_tr_b16 v[244:245], v3 offset:61440
    v_mfma_f32_16x16x32_bf16 v[44:47], v[248:251], v[196:199], v[44:47]
    ds_read_b64_tr_b16 v[246:247], v3 offset:63488
    s_waitcnt lgkmcnt(4)
    v_mfma_f32_16x16x32_bf16 v[48:51], v[252:255], v[192:195], v[48:51]
    ds_read_b64_tr_b16 v[248:249], v4 offset:53248
    v_mfma_f32_16x16x32_bf16 v[52:55], v[252:255], v[196:199], v[52:55]
    ds_read_b64_tr_b16 v[250:251], v4 offset:55296
    s_add_u32 s9, s45, s62
    s_add_u32 m0, s41, 8192
    s_nop 0
    buffer_load_dwordx4 v9, s[24:27], s9 offen  lds
    s_waitcnt lgkmcnt(4)
    v_mfma_f32_16x16x32_bf16 v[24:27], v[240:243], v[200:203], v[24:27]
    ds_read_b64_tr_b16 v[252:253], v4 offset:61440
    v_mfma_f32_16x16x32_bf16 v[28:31], v[240:243], v[204:207], v[28:31]
    ds_read_b64_tr_b16 v[254:255], v4 offset:63488
    s_waitcnt lgkmcnt(4)
    v_mfma_f32_16x16x32_bf16 v[32:35], v[244:247], v[200:203], v[32:35]
    ds_read_b64_tr_b16 v[240:241], v5 offset:0
    v_mfma_f32_16x16x32_bf16 v[36:39], v[244:247], v[204:207], v[36:39]
    ds_read_b64_tr_b16 v[242:243], v5 offset:2048
    s_xor_b32 s9, s48, 0x34000
    buffer_load_dwordx4 v[152:155], v12, s[12:15], s9 offen sc1
    s_waitcnt lgkmcnt(4)
    v_mfma_f32_16x16x32_bf16 v[40:43], v[248:251], v[200:203], v[40:43]
    ds_read_b64_tr_b16 v[244:245], v5 offset:8192
    v_mfma_f32_16x16x32_bf16 v[44:47], v[248:251], v[204:207], v[44:47]
    ds_read_b64_tr_b16 v[246:247], v5 offset:10240
    s_waitcnt lgkmcnt(4)
    v_mfma_f32_16x16x32_bf16 v[48:51], v[252:255], v[200:203], v[48:51]
    ds_read_b64_tr_b16 v[248:249], v6 offset:0
    v_mfma_f32_16x16x32_bf16 v[52:55], v[252:255], v[204:207], v[52:55]
    ds_read_b64_tr_b16 v[250:251], v6 offset:2048
    s_waitcnt lgkmcnt(4)
    v_mfma_f32_16x16x32_bf16 v[24:27], v[240:243], v[208:211], v[24:27]
    ds_read_b64_tr_b16 v[252:253], v6 offset:8192
    v_mfma_f32_16x16x32_bf16 v[28:31], v[240:243], v[212:215], v[28:31]
    ds_read_b64_tr_b16 v[254:255], v6 offset:10240
    s_add_u32 s9, s44, s63
    s_add_u32 m0, s41, 16384
    s_nop 0
    buffer_load_dwordx4 v9, s[24:27], s9 offen  lds
    s_waitcnt lgkmcnt(4)
    v_mfma_f32_16x16x32_bf16 v[32:35], v[244:247], v[208:211], v[32:35]
    ds_read_b64_tr_b16 v[240:241], v5 offset:4096
    v_mfma_f32_16x16x32_bf16 v[36:39], v[244:247], v[212:215], v[36:39]
    ds_read_b64_tr_b16 v[242:243], v5 offset:6144
    s_xor_b32 s9, s48, 0x36000
    buffer_load_dwordx4 v[156:159], v12, s[12:15], s9 offen sc1
    s_waitcnt lgkmcnt(4)
    v_mfma_f32_16x16x32_bf16 v[40:43], v[248:251], v[208:211], v[40:43]
    ds_read_b64_tr_b16 v[244:245], v5 offset:12288
    v_mfma_f32_16x16x32_bf16 v[44:47], v[248:251], v[212:215], v[44:47]
    ds_read_b64_tr_b16 v[246:247], v5 offset:14336
    s_waitcnt lgkmcnt(4)
    v_mfma_f32_16x16x32_bf16 v[48:51], v[252:255], v[208:211], v[48:51]
    ds_read_b64_tr_b16 v[248:249], v6 offset:4096
    v_mfma_f32_16x16x32_bf16 v[52:55], v[252:255], v[212:215], v[52:55]
    ds_read_b64_tr_b16 v[250:251], v6 offset:6144
    s_waitcnt lgkmcnt(4)
    v_mfma_f32_16x16x32_bf16 v[24:27], v[240:243], v[216:219], v[24:27]
    ds_read_b64_tr_b16 v[252:253], v6 offset:12288
    v_mfma_f32_16x16x32_bf16 v[28:31], v[240:243], v[220:223], v[28:31]
    ds_read_b64_tr_b16 v[254:255], v6 offset:14336
    s_waitcnt lgkmcnt(4)
    v_mfma_f32_16x16x32_bf16 v[32:35], v[244:247], v[216:219], v[32:35]
    ds_read_b64_tr_b16 v[240:241], v5 offset:16384
    s_add_u32 s9, s45, s63
    s_add_u32 m0, s41, 24576
    s_nop 0
    buffer_load_dwordx4 v9, s[24:27], s9 offen  lds
    v_mfma_f32_16x16x32_bf16 v[36:39], v[244:247], v[220:223], v[36:39]
    ds_read_b64_tr_b16 v[242:243], v5 offset:18432
    s_add_u32 s9, s47, 0
    buffer_load_dwordx4 v[160:163], v12, s[12:15], s9 offen sc1
    s_waitcnt lgkmcnt(4)
    v_mfma_f32_16x16x32_bf16 v[40:43], v[248:251], v[216:219], v[40:43]
    ds_read_b64_tr_b16 v[244:245], v5 offset:24576
    v_mfma_f32_16x16x32_bf16 v[44:47], v[248:251], v[220:223], v[44:47]
    ds_read_b64_tr_b16 v[246:247], v5 offset:26624
    s_waitcnt lgkmcnt(4)
    v_mfma_f32_16x16x32_bf16 v[48:51], v[252:255], v[216:219], v[48:51]
    ds_read_b64_tr_b16 v[248:249], v6 offset:16384
    v_mfma_f32_16x16x32_bf16 v[52:55], v[252:255], v[220:223], v[52:55]
    ds_read_b64_tr_b16 v[250:251], v6 offset:18432
    s_waitcnt lgkmcnt(4)
    v_mfma_f32_16x16x32_bf16 v[24:27], v[240:243], v[224:227], v[24:27]
    ds_read_b64_tr_b16 v[252:253], v6 offset:24576
    v_mfma_f32_16x16x32_bf16 v[28:31], v[240:243], v[228:231], v[28:31]
    ds_read_b64_tr_b16 v[254:255], v6 offset:26624
    s_add_u32 s9, s47, 8192
    buffer_load_dwordx4 v[164:167], v12, s[12:15], s9 offen sc1
    s_waitcnt lgkmcnt(4)
    v_mfma_f32_16x16x32_bf16 v[32:35], v[244:247], v[224:227], v[32:35]
    ds_read_b64_tr_b16 v[240:241], v5 offset:20480
    v_mfma_f32_16x16x32_bf16 v[36:39], v[244:247], v[228:231], v[36:39]
    ds_read_b64_tr_b16 v[242:243], v5 offset:22528
    s_waitcnt lgkmcnt(4)
    v_mfma_f32_16x16x32_bf16 v[40:43], v[248:251], v[224:227], v[40:43]
    ds_read_b64_tr_b16 v[244:245], v5 offset:28672
    v_mfma_f32_16x16x32_bf16 v[44:47], v[248:251], v[228:231], v[44:47]
    ds_read_b64_tr_b16 v[246:247], v5 offset:30720
    s_add_u32 s9, s44, 589824
    s_add_u32 m0, s41, 32768
    s_nop 0
    buffer_load_dwordx4 v9, s[24:27], s9 offen  lds
    s_waitcnt lgkmcnt(4)
    v_mfma_f32_16x16x32_bf16 v[48:51], v[252:255], v[224:227], v[48:51]
    ds_read_b64_tr_b16 v[248:249], v6 offset:20480
    v_mfma_f32_16x16x32_bf16 v[52:55], v[252:255], v[228:231], v[52:55]
    ds_read_b64_tr_b16 v[250:251], v6 offset:22528
    s_waitcnt lgkmcnt(4)
    v_mfma_f32_16x16x32_bf16 v[24:27], v[240:243], v[232:235], v[24:27]
    ds_read_b64_tr_b16 v[252:253], v6 offset:28672
    v_mfma_f32_16x16x32_bf16 v[28:31], v[240:243], v[236:239], v[28:31]
    ds_read_b64_tr_b16 v[254:255], v6 offset:30720
    s_add_u32 s9, s47, 16384
    buffer_load_dwordx4 v[168:171], v12, s[12:15], s9 offen sc1
    s_waitcnt lgkmcnt(4)
    v_mfma_f32_16x16x32_bf16 v[32:35], v[244:247], v[232:235], v[32:35]
    ds_read_b64_tr_b16 v[240:241], v3 offset:49664
    v_mfma_f32_16x16x32_bf16 v[36:39], v[244:247], v[236:239], v[36:39]
    ds_read_b64_tr_b16 v[242:243], v3 offset:51712
    s_waitcnt lgkmcnt(4)
    v_mfma_f32_16x16x32_bf16 v[40:43], v[248:251], v[232:235], v[40:43]
    ds_read_b64_tr_b16 v[244:245], v3 offset:57856
    v_mfma_f32_16x16x32_bf16 v[44:47], v[248:251], v[236:239], v[44:47]
    ds_read_b64_tr_b16 v[246:247], v3 offset:59904
    s_waitcnt lgkmcnt(4)
    v_mfma_f32_16x16x32_bf16 v[48:51], v[252:255], v[232:235], v[48:51]
    ds_read_b64_tr_b16 v[248:249], v4 offset:49664
    s_add_u32 s9, s45, 589824
    s_add_u32 m0, s41, 40960
    s_nop 0
    buffer_load_dwordx4 v9, s[24:27], s9 offen  lds
    v_mul_f32 v32, v32, v24
    v_mfma_f32_16x16x32_bf16 v[52:55], v[252:255], v[236:239], v[52:55]
    ds_read_b64_tr_b16 v[250:251], v4 offset:51712
    v_mul_f32 v33, v33, v25
    v_mul_f32 v34, v34, v26
    s_waitcnt lgkmcnt(4)
    v_mfma_f32_16x16x32_bf16 v[56:59], v[240:243], v[192:195], v[56:59]
    ds_read_b64_tr_b16 v[252:253], v4 offset:57856
    v_mul_f32 v35, v35, v27
    v_mfma_f32_16x16x32_bf16 v[60:63], v[240:243], v[196:199], v[60:63]
    ds_read_b64_tr_b16 v[254:255], v4 offset:59904
    v_mul_f32 v48, v48, v40
    s_add_u32 s9, s47, 24576
    buffer_load_dwordx4 v[172:175], v12, s[12:15], s9 offen sc1
    s_waitcnt lgkmcnt(4)
    v_mfma_f32_16x16x32_bf16 v[64:67], v[244:247], v[192:195], v[64:67]
    ds_read_b64_tr_b16 v[240:241], v3 offset:53760
    v_mul_f32 v49, v49, v41
    v_mfma_f32_16x16x32_bf16 v[68:71], v[244:247], v[196:199], v[68:71]
    ds_read_b64_tr_b16 v[242:243], v3 offset:55808
    v_mul_f32 v50, v50, v42
    s_waitcnt lgkmcnt(4)
    v_mfma_f32_16x16x32_bf16 v[72:75], v[248:251], v[192:195], v[72:75]
    ds_read_b64_tr_b16 v[244:245], v3 offset:61952
    v_mul_f32 v51, v51, v43
    v_mfma_f32_16x16x32_bf16 v[76:79], v[248:251], v[196:199], v[76:79]
    ds_read_b64_tr_b16 v[246:247], v3 offset:64000
    v_cvt_pk_bf16_f32 v176, v32, v33
    s_waitcnt lgkmcnt(4)
    v_mfma_f32_16x16x32_bf16 v[80:83], v[252:255], v[192:195], v[80:83]
    ds_read_b64_tr_b16 v[248:249], v4 offset:53760
    v_cvt_pk_bf16_f32 v177, v34, v35
    v_mfma_f32_16x16x32_bf16 v[84:87], v[252:255], v[196:199], v[84:87]
    ds_read_b64_tr_b16 v[250:251], v4 offset:55808
    v_cvt_pk_bf16_f32 v178, v48, v49
    v_cvt_pk_bf16_f32 v179, v50, v51
    s_waitcnt lgkmcnt(4)
    v_mfma_f32_16x16x32_bf16 v[56:59], v[240:243], v[200:203], v[56:59]
    ds_read_b64_tr_b16 v[252:253], v4 offset:61952
    v_and_b32 v176, -2, v176
    v_mfma_f32_16x16x32_bf16 v[60:63], v[240:243], v[204:207], v[60:63]
    ds_read_b64_tr_b16 v[254:255], v4 offset:64000
    s_xor_b32 s9, s48, 0x8000
    buffer_store_dwordx4 v[176:179], v12, s[12:15], s9 offen sc1
    s_waitcnt lgkmcnt(4)
    v_mfma_f32_16x16x32_bf16 v[64:67], v[244:247], v[200:203], v[64:67]
    ds_read_b64_tr_b16 v[240:241], v5 offset:512
pg_c:
    s_cbranch_execz pf_ret
    v_mul_f32 v36, v36, v28
    v_mfma_f32_16x16x32_bf16 v[68:71], v[244:247], v[204:207], v[68:71]
    ds_read_b64_tr_b16 v[242:243], v5 offset:2560
    v_mul_f32 v37, v37, v29
    s_waitcnt lgkmcnt(4)
    v_mfma_f32_16x16x32_bf16 v[72:75], v[248:251], v[200:203], v[72:75]
    ds_read_b64_tr_b16 v[244:245], v5 offset:8704
    v_mul_f32 v38, v38, v30
    v_mfma_f32_16x16x32_bf16 v[76:79], v[248:251], v[204:207], v[76:79]
    ds_read_b64_tr_b16 v[246:247], v5 offset:10752
    v_mul_f32 v39, v39, v31
    s_waitcnt lgkmcnt(4)
    v_mfma_f32_16x16x32_bf16 v[80:83], v[252:255], v[200:203], v[80:83]
    ds_read_b64_tr_b16 v[248:249], v6 offset:512
    v_mul_f32 v52, v52, v44
    v_mfma_f32_16x16x32_bf16 v[84:87], v[252:255], v[204:207], v[84:87]
    ds_read_b64_tr_b16 v[250:251], v6 offset:2560
    v_mul_f32 v53, v53, v45
    v_mul_f32 v54, v54, v46
    s_waitcnt lgkmcnt(4)
    v_mfma_f32_16x16x32_bf16 v[56:59], v[240:243], v[208:211], v[56:59]
    ds_read_b64_tr_b16 v[252:253], v6 offset:8704
    v_mul_f32 v55, v55, v47
    v_mfma_f32_16x16x32_bf16 v[60:63], v[240:243], v[212:215], v[60:63]
    ds_read_b64_tr_b16 v[254:255], v6 offset:10752
    v_cvt_pk_bf16_f32 v180, v36, v37
    s_waitcnt lgkmcnt(4)
    v_mfma_f32_16x16x32_bf16 v[64:67], v[244:247], v[208:211], v[64:67]
    ds_read_b64_tr_b16 v[240:241], v5 offset:4608
    v_cvt_pk_bf16_f32 v181, v38, v39
    v_mfma_f32_16x16x32_bf16 v[68:71], v[244:247], v[212:215], v[68:71]
    ds_read_b64_tr_b16 v[242:243], v5 offset:6656
    v_cvt_pk_bf16_f32 v182, v52, v53
    s_waitcnt lgkmcnt(4)
    v_mfma_f32_16x16x32_bf16 v[72:75], v[248:251], v[208:211], v[72:75]
    ds_read_b64_tr_b16 v[244:245], v5 offset:12800
    v_cvt_pk_bf16_f32 v183, v54, v55
    v_mfma_f32_16x16x32_bf16 v[76:79], v[248:251], v[212:215], v[76:79]
    ds_read_b64_tr_b16 v[246:247], v5 offset:14848
    v_and_b32 v180, -2, v180
    s_waitcnt lgkmcnt(4)
    v_mfma_f32_16x16x32_bf16 v[80:83], v[252:255], v[208:211], v[80:83]
    ds_read_b64_tr_b16 v[248:249], v6 offset:4608
    v_mul_f32 v88, s58, v20
    v_mfma_f32_16x16x32_bf16 v[84:87], v[252:255], v[212:215], v[84:87]
    ds_read_b64_tr_b16 v[250:251], v6 offset:6656
    v_mul_f32 v89, s58, v20
    s_waitcnt lgkmcnt(4)
    v_mfma_f32_16x16x32_bf16 v[56:59], v[240:243], v[216:219], v[56:59]
    ds_read_b64_tr_b16 v[252:253], v6 offset:12800
    v_mul_f32 v90, s58, v20
    v_mfma_f32_16x16x32_bf16 v[60:63], v[240:243], v[220:223], v[60:63]
    ds_read_b64_tr_b16 v[254:255], v6 offset:14848
    v_mul_f32 v91, s58, v20
    s_waitcnt lgkmcnt(4)
    v_mfma_f32_16x16x32_bf16 v[64:67], v[244:247], v[216:219], v[64:67]
    ds_read_b64_tr_b16 v[240:241], v5 offset:16896
    v_mul_f32 v92, s58, v21
    v_mfma_f32_16x16x32_bf16 v[68:71], v[244:247], v[220:223], v[68:71]
    ds_read_b64_tr_b16 v[242:243], v5 offset:18944
    v_mul_f32 v93, s58, v21
    s_waitcnt lgkmcnt(4)
    v_mfma_f32_16x16x32_bf16 v[72:75], v[248:251], v[216:219], v[72:75]
    ds_read_b64_tr_b16 v[244:245], v5 offset:25088
    s_xor_b32 s9, s48, 0xa000
    buffer_store_dwordx4 v[180:183], v12, s[12:15], s9 offen sc1
    v_mfma_f32_16x16x32_bf16 v[76:79], v[248:251], v[220:223], v[76:79]
    ds_read_b64_tr_b16 v[246:247], v5 offset:27136
    v_mul_f32 v94, s58, v21
    v_mul_f32 v95, s58, v21
    s_waitcnt lgkmcnt(4)
    v_mfma_f32_16x16x32_bf16 v[80:83], v[252:255], v[216:219], v[80:83]
    ds_read_b64_tr_b16 v[248:249], v6 offset:16896
    v_mov_b32 v24, v20
    v_mfma_f32_16x16x32_bf16 v[84:87], v[252:255], v[220:223], v[84:87]
    ds_read_b64_tr_b16 v[250:251], v6 offset:18944
    v_mov_b32 v25, v20
    s_waitcnt lgkmcnt(4)
    v_mfma_f32_16x16x32_bf16 v[56:59], v[240:243], v[224:227], v[56:59]
    ds_read_b64_tr_b16 v[252:253], v6 offset:25088
    v_mfma_f32_16x16x32_bf16 v[60:63], v[240:243], v[228:231], v[60:63]
    ds_read_b64_tr_b16 v[254:255], v6 offset:27136
    v_mov_b32 v26, v20
    s_waitcnt lgkmcnt(4)
    v_mfma_f32_16x16x32_bf16 v[64:67], v[244:247], v[224:227], v[64:67]
    ds_read_b64_tr_b16 v[240:241], v5 offset:20992
    v_mfma_f32_16x16x32_bf16 v[68:71], v[244:247], v[228:231], v[68:71]
    ds_read_b64_tr_b16 v[242:243], v5 offset:23040
    v_mov_b32 v27, v20
    s_waitcnt lgkmcnt(4)
    v_mfma_f32_16x16x32_bf16 v[72:75], v[248:251], v[224:227], v[72:75]
    ds_read_b64_tr_b16 v[244:245], v5 offset:29184
    v_mfma_f32_16x16x32_bf16 v[76:79], v[248:251], v[228:231], v[76:79]
    ds_read_b64_tr_b16 v[246:247], v5 offset:31232
    v_mov_b32 v28, v21
    s_waitcnt lgkmcnt(4)
    v_mfma_f32_16x16x32_bf16 v[80:83], v[252:255], v[224:227], v[80:83]
    ds_read_b64_tr_b16 v[248:249], v6 offset:20992
    v_mfma_f32_16x16x32_bf16 v[84:87], v[252:255], v[228:231], v[84:87]
    ds_read_b64_tr_b16 v[250:251], v6 offset:23040
    v_mov_b32 v29, v21
    s_waitcnt lgkmcnt(4)
    v_mfma_f32_16x16x32_bf16 v[56:59], v[240:243], v[232:235], v[56:59]
    ds_read_b64_tr_b16 v[252:253], v6 offset:29184
    v_mfma_f32_16x16x32_bf16 v[60:63], v[240:243], v[236:239], v[60:63]
    ds_read_b64_tr_b16 v[254:255], v6 offset:31232
    v_mov_b32 v30, v21
    s_waitcnt lgkmcnt(4)
    v_mfma_f32_16x16x32_bf16 v[64:67], v[244:247], v[232:235], v[64:67]
    v_mfma_f32_16x16x32_bf16 v[68:71], v[244:247], v[236:239], v[68:71]
    s_waitcnt vmcnt(35)
    s_barrier
    ds_read_b64_tr_b16 v[240:241], v7 offset:47104
    ds_read_b64_tr_b16 v[242:243], v7 offset:47616
    v_mov_b32 v31, v21
    s_waitcnt lgkmcnt(4)
    v_mfma_f32_16x16x32_bf16 v[72:75], v[248:251], v[232:235], v[72:75]
    ds_read_b64_tr_b16 v[244:245], v5 offset:32768
    v_mfma_f32_16x16x32_bf16 v[76:79], v[248:251], v[236:239], v[76:79]
    ds_read_b64_tr_b16 v[246:247], v5 offset:34816
    s_waitcnt lgkmcnt(4)
    v_mfma_f32_16x16x32_bf16 v[80:83], v[252:255], v[232:235], v[80:83]
    ds_read_b64_tr_b16 v[248:249], v6 offset:32768
    v_mfma_f32_16x16x32_bf16 v[84:87], v[252:255], v[236:239], v[84:87]
    ds_read_b64_tr_b16 v[250:251], v6 offset:34816
    s_waitcnt vmcnt(30) lgkmcnt(4)
    v_mfma_f32_16x16x32_bf16 v[88:91], v[240:243], v[96:99], v[88:91]
    ds_read_b64_tr_b16 v[252:253], v5 offset:33280
    v_mfma_f32_16x16x32_bf16 v[92:95], v[240:243], v[100:103], v[92:95]
    ds_read_b64_tr_b16 v[254:255], v5 offset:35328
    s_waitcnt lgkmcnt(4)
    v_mfma_f32_16x16x32_bf16 v[24:27], v[244:247], v[96:99], v[24:27]
    ds_read_b64_tr_b16 v[240:241], v6 offset:33280
    v_mul_f32 v64, v64, v56
    v_mul_f32 v65, v65, v57
    v_mfma_f32_16x16x32_bf16 v[28:31], v[244:247], v[100:103], v[28:31]
    ds_read_b64_tr_b16 v[242:243], v6 offset:35328
    v_mul_f32 v66, v66, v58
    v_mul_f32 v67, v67, v59
    s_waitcnt lgkmcnt(4)
    v_mfma_f32_16x16x32_bf16 v[32:35], v[248:251], v[96:99], 0
    ds_read_b64_tr_b16 v[244:245], v7 offset:48128
    v_mul_f32 v80, v80, v72
    v_mfma_f32_16x16x32_bf16 v[36:39], v[248:251], v[100:103], 0
    ds_read_b64_tr_b16 v[246:247], v7 offset:48640
    v_mul_f32 v81, v81, v73
    v_mul_f32 v82, v82, v74
    s_waitcnt lgkmcnt(4)
    v_mfma_f32_16x16x32_bf16 v[40:43], v[252:255], v[96:99], 0
    ds_read_b64_tr_b16 v[248:249], v5 offset:36864
    v_mul_f32 v83, v83, v75
    v_mfma_f32_16x16x32_bf16 v[44:47], v[252:255], v[100:103], 0
    ds_read_b64_tr_b16 v[250:251], v5 offset:38912
    v_cvt_pk_bf16_f32 v184, v64, v65
    v_cvt_pk_bf16_f32 v185, v66, v67
    s_waitcnt lgkmcnt(4)
    v_mfma_f32_16x16x32_bf16 v[48:51], v[240:243], v[96:99], 0
    ds_read_b64_tr_b16 v[252:253], v6 offset:36864
    v_cvt_pk_bf16_f32 v186, v80, v81
    v_mfma_f32_16x16x32_bf16 v[52:55], v[240:243], v[100:103], 0
    ds_read_b64_tr_b16 v[254:255], v6 offset:38912
    v_cvt_pk_bf16_f32 v187, v82, v83
    v_and_b32 v184, -2, v184
    s_waitcnt vmcnt(27) lgkmcnt(4)
    v_mfma_f32_16x16x32_bf16 v[88:91], v[244:247], v[104:107], v[88:91]
    ds_read_b64_tr_b16 v[240:241], v5 offset:37376
    s_xor_b32 s9, s48, 0xc000
    buffer_store_dwordx4 v[184:187], v12, s[12:15], s9 offen sc1
    v_mfma_f32_16x16x32_bf16 v[92:95], v[244:247], v[108:111], v[92:95]
    ds_read_b64_tr_b16 v[242:243], v5 offset:39424
    v_mul_f32 v68, v68, v60
    v_mul_f32 v69, v69, v61
    s_waitcnt lgkmcnt(4)
    v_mfma_f32_16x16x32_bf16 v[24:27], v[248:251], v[104:107], v[24:27]
    ds_read_b64_tr_b16 v[244:245], v6 offset:37376
    s_add_u32 s9, s44, s60
    s_add_u32 s9, s9, 73728
    s_add_u32 m0, s41, 49152
    s_nop 0
    buffer_load_dwordx4 v9, s[24:27], s9 offen  lds
    v_mul_f32 v70, v70, v62
    v_mfma_f32_16x16x32_bf16 v[28:31], v[248:251], v[108:111], v[28:31]
    ds_read_b64_tr_b16 v[246:247], v6 offset:39424
    v_mul_f32 v71, v71, v63
    v_mul_f32 v84, v84, v76
    s_waitcnt lgkmcnt(4)
    v_mfma_f32_16x16x32_bf16 v[32:35], v[252:255], v[104:107], v[32:35]
    ds_read_b64_tr_b16 v[248:249], v5 offset:40960
    v_mul_f32 v85, v85, v77
    v_mfma_f32_16x16x32_bf16 v[36:39], v[252:255], v[108:111], v[36:39]
    ds_read_b64_tr_b16 v[250:251], v5 offset:43008
    v_mul_f32 v86, v86, v78
    v_mul_f32 v87, v87, v79
    s_waitcnt lgkmcnt(4)
    v_mfma_f32_16x16x32_bf16 v[40:43], v[240:243], v[104:107], v[40:43]
    ds_read_b64_tr_b16 v[252:253], v6 offset:40960
    v_cvt_pk_bf16_f32 v188, v68, v69
    v_mfma_f32_16x16x32_bf16 v[44:47], v[240:243], v[108:111], v[44:47]
    ds_read_b64_tr_b16 v[254:255], v6 offset:43008
    v_cvt_pk_bf16_f32 v189, v70, v71
    v_cvt_pk_bf16_f32 v190, v84, v85
    s_waitcnt lgkmcnt(4)
    v_mfma_f32_16x16x32_bf16 v[48:51], v[244:247], v[104:107], v[48:51]
    ds_read_b64_tr_b16 v[240:241], v5 offset:41472
    s_add_u32 s9, s45, s60
    s_add_u32 s9, s9, 73728
    s_add_u32 m0, s41, 57344
    s_nop 0
    buffer_load_dwordx4 v9, s[24:27], s9 offen  lds
    v_cvt_pk_bf16_f32 v191, v86, v87
    v_mfma_f32_16x16x32_bf16 v[52:55], v[244:247], v[108:111], v[52:55]
    ds_read_b64_tr_b16 v[242:243], v5 offset:43520
    v_and_b32 v188, -2, v188
    s_xor_b32 s9, s48, 0xe000
    buffer_store_dwordx4 v[188:191], v12, s[12:15], s9 offen sc1
    s_waitcnt lgkmcnt(4)
    v_mfma_f32_16x16x32_bf16 v[56:59], v[248:251], v[96:99], 0
    ds_read_b64_tr_b16 v[244:245], v6 offset:41472
    v_mfma_f32_16x16x32_bf16 v[60:63], v[248:251], v[100:103], 0
    ds_read_b64_tr_b16 v[246:247], v6 offset:43520
    s_waitcnt lgkmcnt(4)
    v_mfma_f32_16x16x32_bf16 v[64:67], v[252:255], v[96:99], 0
    ds_read_b64_tr_b16 v[248:249], v5 offset:45056
    v_mfma_f32_16x16x32_bf16 v[68:71], v[252:255], v[100:103], 0
    ds_read_b64_tr_b16 v[250:251], v5 offset:47104
    s_waitcnt lgkmcnt(4)
    v_mfma_f32_16x16x32_bf16 v[72:75], v[240:243], v[96:99], 0
    ds_read_b64_tr_b16 v[252:253], v6 offset:45056
    s_waitcnt vmcnt(6)
    v_mfma_f32_16x16x32_bf16 v[76:79], v[240:243], v[100:103], 0
    ds_read_b64_tr_b16 v[254:255], v6 offset:47104
    v_swap_b32 v162, v164
    s_waitcnt lgkmcnt(4)
    v_mfma_f32_16x16x32_bf16 v[80:83], v[244:247], v[96:99], 0
    ds_read_b64_tr_b16 v[240:241], v5 offset:45568
    s_add_u32 s9, s44, s61
    s_add_u32 s9, s9, 73728
    s_add_u32 m0, s41, 65536
    s_nop 0
    buffer_load_dwordx4 v9, s[24:27], s9 offen  lds
    v_mfma_f32_16x16x32_bf16 v[84:87], v[244:247], v[100:103], 0
    ds_read_b64_tr_b16 v[242:243], v5 offset:47616
    v_swap_b32 v163, v165
    s_waitcnt vmcnt(7)
    v_mov_b32 v1, 2
    s_mov_b64 exec, 1
    buffer_store_dword v1, off, s[12:15], s50 sc1
    s_mov_b64 exec, -1
    s_waitcnt lgkmcnt(4)
    v_mfma_f32_16x16x32_bf16 v[56:59], v[248:251], v[104:107], v[56:59]
    ds_read_b64_tr_b16 v[244:245], v6 offset:45568
    s_xor_b32 s9, s48, 0x18000
    buffer_load_dwordx4 v[192:195], v12, s[12:15], s9 offen sc1
    v_mfma_f32_16x16x32_bf16 v[60:63], v[248:251], v[108:111], v[60:63]
    ds_read_b64_tr_b16 v[246:247], v6 offset:47616
    v_swap_b32 v170, v172
    s_waitcnt lgkmcnt(4)
    v_mfma_f32_16x16x32_bf16 v[64:67], v[252:255], v[104:107], v[64:67]
    v_mfma_f32_16x16x32_bf16 v[68:71], v[252:255], v[108:111], v[68:71]
    s_waitcnt vmcnt(10)
    s_barrier
    ds_read_b64_tr_b16 v[248:249], v7 offset:51200
    ds_read_b64_tr_b16 v[250:251], v7 offset:51712
    v_swap_b32 v171, v173
    s_waitcnt lgkmcnt(4)
    v_mfma_f32_16x16x32_bf16 v[72:75], v[240:243], v[104:107], v[72:75]
    ds_read_b64_tr_b16 v[252:253], v6 offset:57856
    v_mfma_f32_16x16x32_bf16 v[76:79], v[240:243], v[108:111], v[76:79]
    ds_read_b64_tr_b16 v[254:255], v6 offset:59904
    s_xor_b32 s9, s48, 0x1a000
    buffer_load_dwordx4 v[196:199], v12, s[12:15], s9 offen sc1
    s_waitcnt lgkmcnt(4)
    v_mfma_f32_16x16x32_bf16 v[80:83], v[244:247], v[104:107], v[80:83]
    ds_read_b64_tr_b16 v[240:241], v5 offset:57856
    v_mfma_f32_16x16x32_bf16 v[84:87], v[244:247], v[108:111], v[84:87]
    ds_read_b64_tr_b16 v[242:243], v5 offset:59904
    s_add_u32 s9, s45, s61
    s_add_u32 s9, s9, 73728
    s_add_u32 m0, s41, 73728
    s_nop 0
    buffer_load_dwordx4 v9, s[24:27], s9 offen  lds
    s_waitcnt vmcnt(32) lgkmcnt(4)
    v_mfma_f32_16x16x32_bf16 v[88:91], v[248:251], v[112:115], v[88:91]
    ds_read_b64_tr_b16 v[244:245], v6 offset:57344
    v_mfma_f32_16x16x32_bf16 v[92:95], v[248:251], v[116:119], v[92:95]
    ds_read_b64_tr_b16 v[246:247], v6 offset:59392
    s_xor_b32 s9, s48, 0x28000
    buffer_load_dwordx4 v[200:203], v12, s[12:15], s9 offen sc1
    s_waitcnt lgkmcnt(4)
    v_mfma_f32_16x16x32_bf16 v[80:83], v[252:255], v[112:115], v[80:83]
    ds_read_b64_tr_b16 v[248:249], v5 offset:57344
    v_mfma_f32_16x16x32_bf16 v[84:87], v[252:255], v[116:119], v[84:87]
    ds_read_b64_tr_b16 v[250:251], v5 offset:59392
    s_waitcnt lgkmcnt(4)
    v_mfma_f32_16x16x32_bf16 v[72:75], v[240:243], v[112:115], v[72:75]
    ds_read_b64_tr_b16 v[252:253], v6 offset:49664
    s_add_u32 s9, s44, s62
    s_add_u32 s9, s9, 73728
    s_add_u32 m0, s41, 81920
    s_nop 0
    buffer_load_dwordx4 v9, s[24:27], s9 offen  lds
    v_mfma_f32_16x16x32_bf16 v[76:79], v[240:243], v[116:119], v[76:79]
    ds_read_b64_tr_b16 v[254:255], v6 offset:51712
    s_xor_b32 s9, s48, 0x2a000
    buffer_load_dwordx4 v[204:207], v12, s[12:15], s9 offen sc1
    s_waitcnt lgkmcnt(4)
    v_mfma_f32_16x16x32_bf16 v[64:67], v[244:247], v[112:115], v[64:67]
    ds_read_b64_tr_b16 v[240:241], v5 offset:49664
    v_mfma_f32_16x16x32_bf16 v[68:71], v[244:247], v[116:119], v[68:71]
    ds_read_b64_tr_b16 v[242:243], v5 offset:51712
    s_waitcnt lgkmcnt(4)
    v_mfma_f32_16x16x32_bf16 v[56:59], v[248:251], v[112:115], v[56:59]
    ds_read_b64_tr_b16 v[244:245], v6 offset:49152
    v_mfma_f32_16x16x32_bf16 v[60:63], v[248:251], v[116:119], v[60:63]
    ds_read_b64_tr_b16 v[246:247], v6 offset:51200
    s_xor_b32 s9, s48, 0x38000
    buffer_load_dwordx4 v[208:211], v12, s[12:15], s9 offen sc1
    s_waitcnt lgkmcnt(4)
    v_mfma_f32_16x16x32_bf16 v[48:51], v[252:255], v[112:115], v[48:51]
    ds_read_b64_tr_b16 v[248:249], v7 offset:52224
    v_mfma_f32_16x16x32_bf16 v[52:55], v[252:255], v[116:119], v[52:55]
    ds_read_b64_tr_b16 v[250:251], v7 offset:52736
    s_waitcnt lgkmcnt(4)
    v_mfma_f32_16x16x32_bf16 v[40:43], v[240:243], v[112:115], v[40:43]
    ds_read_b64_tr_b16 v[252:253], v6 offset:61952
    s_add_u32 s9, s45, s62
    s_add_u32 s9, s9, 73728
    s_add_u32 m0, s41, 90112
    s_nop 0
    buffer_load_dwordx4 v9, s[24:27], s9 offen  lds
    v_mfma_f32_16x16x32_bf16 v[44:47], v[240:243], v[116:119], v[44:47]
    ds_read_b64_tr_b16 v[254:255], v6 offset:64000
    s_xor_b32 s9, s48, 0x3a000
    buffer_load_dwordx4 v[212:215], v12, s[12:15], s9 offen sc1
    s_waitcnt lgkmcnt(4)
    v_mfma_f32_16x16x32_bf16 v[32:35], v[244:247], v[112:115], v[32:35]
    ds_read_b64_tr_b16 v[240:241], v5 offset:61952
    v_mfma_f32_16x16x32_bf16 v[36:39], v[244:247], v[116:119], v[36:39]
    ds_read_b64_tr_b16 v[242:243], v5 offset:64000
    s_waitcnt vmcnt(35) lgkmcnt(4)
    v_mfma_f32_16x16x32_bf16 v[88:91], v[248:251], v[120:123], v[88:91]
    ds_read_b64_tr_b16 v[244:245], v6 offset:61440
    v_mfma_f32_16x16x32_bf16 v[92:95], v[248:251], v[124:127], v[92:95]
    ds_read_b64_tr_b16 v[246:247], v6 offset:63488
    s_waitcnt lgkmcnt(4)
    v_mfma_f32_16x16x32_bf16 v[80:83], v[252:255], v[120:123], v[80:83]
    ds_read_b64_tr_b16 v[248:249], v5 offset:61440
    v_mfma_f32_16x16x32_bf16 v[84:87], v[252:255], v[124:127], v[84:87]
    ds_read_b64_tr_b16 v[250:251], v5 offset:63488
    s_waitcnt lgkmcnt(4)
    v_mfma_f32_16x16x32_bf16 v[72:75], v[240:243], v[120:123], v[72:75]
    ds_read_b64_tr_b16 v[252:253], v6 offset:53760
    s_add_u32 s9, s44, s63
    s_add_u32 s9, s9, 73728
    s_add_u32 m0, s41, 98304
    s_nop 0
    buffer_load_dwordx4 v9, s[24:27], s9 offen  lds
    v_mfma_f32_16x16x32_bf16 v[76:79], v[240:243], v[124:127], v[76:79]
    ds_read_b64_tr_b16 v[254:255], v6 offset:55808
    buffer_load_dword v22, v14, s[12:15], s56 offen sc1
    s_waitcnt lgkmcnt(4)
    v_mfma_f32_16x16x32_bf16 v[64:67], v[244:247], v[120:123], v[64:67]
    ds_read_b64_tr_b16 v[240:241], v5 offset:53760
    v_mfma_f32_16x16x32_bf16 v[68:71], v[244:247], v[124:127], v[68:71]
    ds_read_b64_tr_b16 v[242:243], v5 offset:55808
    s_waitcnt lgkmcnt(4)
    v_mfma_f32_16x16x32_bf16 v[56:59], v[248:251], v[120:123], v[56:59]
    ds_read_b64_tr_b16 v[244:245], v6 offset:53248
    v_mfma_f32_16x16x32_bf16 v[60:63], v[248:251], v[124:127], v[60:63]
    ds_read_b64_tr_b16 v[246:247], v6 offset:55296
    s_waitcnt lgkmcnt(4)
    v_mfma_f32_16x16x32_bf16 v[48:51], v[252:255], v[120:123], v[48:51]
    ds_read_b64_tr_b16 v[248:249], v7 offset:55296
    v_mfma_f32_16x16x32_bf16 v[52:55], v[252:255], v[124:127], v[52:55]
    ds_read_b64_tr_b16 v[250:251], v7 offset:55808
    s_add_u32 s9, s45, s63
    s_add_u32 s9, s9, 73728
    s_add_u32 m0, s41, 106496
    s_nop 0
    buffer_load_dwordx4 v9, s[24:27], s9 offen  lds
    s_waitcnt lgkmcnt(4)
    v_mfma_f32_16x16x32_bf16 v[40:43], v[240:243], v[120:123], v[40:43]
    ds_read_b64_tr_b16 v[252:253], v4 offset:8704
    v_mfma_f32_16x16x32_bf16 v[44:47], v[240:243], v[124:127], v[44:47]
    ds_read_b64_tr_b16 v[254:255], v4 offset:10752
    s_waitcnt lgkmcnt(4)
    v_mfma_f32_16x16x32_bf16 v[32:35], v[244:247], v[120:123], v[32:35]
    ds_read_b64_tr_b16 v[240:241], v3 offset:8704
    v_mfma_f32_16x16x32_bf16 v[36:39], v[244:247], v[124:127], v[36:39]
    ds_read_b64_tr_b16 v[242:243], v3 offset:10752
    s_waitcnt vmcnt(36) lgkmcnt(4)
    v_mfma_f32_16x16x32_bf16 v[88:91], v[248:251], v[128:131], v[88:91]
    ds_read_b64_tr_b16 v[244:245], v4 offset:8192
    v_mfma_f32_16x16x32_bf16 v[92:95], v[248:251], v[132:135], v[92:95]
    ds_read_b64_tr_b16 v[246:247], v4 offset:10240
    s_waitcnt lgkmcnt(4)
    v_mfma_f32_16x16x32_bf16 v[80:83], v[252:255], v[128:131], v[80:83]
    ds_read_b64_tr_b16 v[248:249], v3 offset:8192
    v_mfma_f32_16x16x32_bf16 v[84:87], v[252:255], v[132:135], v[84:87]
    ds_read_b64_tr_b16 v[250:251], v3 offset:10240
    s_waitcnt lgkmcnt(4)
    v_mfma_f32_16x16x32_bf16 v[72:75], v[240:243], v[128:131], v[72:75]
    ds_read_b64_tr_b16 v[252:253], v4 offset:512
    v_mfma_f32_16x16x32_bf16 v[76:79], v[240:243], v[132:135], v[76:79]
    ds_read_b64_tr_b16 v[254:255], v4 offset:2560
    s_waitcnt lgkmcnt(4)
    v_mfma_f32_16x16x32_bf16 v[64:67], v[244:247], v[128:131], v[64:67]
    ds_read_b64_tr_b16 v[240:241], v3 offset:512
    v_mfma_f32_16x16x32_bf16 v[68:71], v[244:247], v[132:135], v[68:71]
    ds_read_b64_tr_b16 v[242:243], v3 offset:2560
    s_waitcnt lgkmcnt(4)
    v_mfma_f32_16x16x32_bf16 v[56:59], v[248:251], v[128:131], v[56:59]
    ds_read_b64_tr_b16 v[244:245], v4 offset:0
    v_mfma_f32_16x16x32_bf16 v[60:63], v[248:251], v[132:135], v[60:63]
    ds_read_b64_tr_b16 v[246:247], v4 offset:2048
    s_waitcnt lgkmcnt(4)
    v_mfma_f32_16x16x32_bf16 v[48:51], v[252:255], v[128:131], v[48:51]
    ds_read_b64_tr_b16 v[248:249], v7 offset:56320
    v_mfma_f32_16x16x32_bf16 v[52:55], v[252:255], v[132:135], v[52:55]
    ds_read_b64_tr_b16 v[250:251], v7 offset:56832
    s_waitcnt lgkmcnt(4)
    v_mfma_f32_16x16x32_bf16 v[40:43], v[240:243], v[128:131], v[40:43]
    ds_read_b64_tr_b16 v[252:253], v4 offset:12800
    v_mfma_f32_16x16x32_bf16 v[44:47], v[240:243], v[132:135], v[44:47]
    ds_read_b64_tr_b16 v[254:255], v4 offset:14848
    s_waitcnt lgkmcnt(4)
    v_mfma_f32_16x16x32_bf16 v[32:35], v[244:247], v[128:131], v[32:35]
    ds_read_b64_tr_b16 v[240:241], v3 offset:12800
    v_mfma_f32_16x16x32_bf16 v[36:39], v[244:247], v[132:135], v[36:39]
    ds_read_b64_tr_b16 v[242:243], v3 offset:14848
    s_waitcnt vmcnt(34) lgkmcnt(4)
    v_mfma_f32_16x16x32_bf16 v[88:91], v[248:251], v[136:139], v[88:91]
    ds_read_b64_tr_b16 v[244:245], v4 offset:12288
    v_mfma_f32_16x16x32_bf16 v[92:95], v[248:251], v[140:143], v[92:95]
    ds_read_b64_tr_b16 v[246:247], v4 offset:14336
    s_waitcnt lgkmcnt(4)
    v_mfma_f32_16x16x32_bf16 v[80:83], v[252:255], v[136:139], v[80:83]
    ds_read_b64_tr_b16 v[248:249], v3 offset:12288
    v_mfma_f32_16x16x32_bf16 v[84:87], v[252:255], v[140:143], v[84:87]
    ds_read_b64_tr_b16 v[250:251], v3 offset:14336
    s_waitcnt vmcnt(1)
    v_cmp_gt_i32 vcc, 1, v22
    s_nop 0
    s_and_b32 vcc_lo, vcc_lo, 255
    s_cbranch_scc1 sequential_preLN__sliding_block__glu_gated_bilinear__prompt_kernel_spin94
sequential_preLN__sliding_block__glu_gated_bilinear__prompt_kernel_go95:
    s_waitcnt lgkmcnt(4)
    v_mfma_f32_16x16x32_bf16 v[72:75], v[240:243], v[136:139], v[72:75]
    ds_read_b64_tr_b16 v[252:253], v4 offset:4608
    v_mfma_f32_16x16x32_bf16 v[76:79], v[240:243], v[140:143], v[76:79]
    ds_read_b64_tr_b16 v[254:255], v4 offset:6656
    s_xor_b32 s9, s48, 0x1c000
    buffer_load_dwordx4 v[216:219], v12, s[12:15], s9 offen sc1
    s_waitcnt lgkmcnt(4)
    v_mfma_f32_16x16x32_bf16 v[64:67], v[244:247], v[136:139], v[64:67]
    ds_read_b64_tr_b16 v[240:241], v3 offset:4608
    v_mfma_f32_16x16x32_bf16 v[68:71], v[244:247], v[140:143], v[68:71]
    ds_read_b64_tr_b16 v[242:243], v3 offset:6656
    s_waitcnt lgkmcnt(4)
    v_mfma_f32_16x16x32_bf16 v[56:59], v[248:251], v[136:139], v[56:59]
    ds_read_b64_tr_b16 v[244:245], v4 offset:4096
    v_mfma_f32_16x16x32_bf16 v[60:63], v[248:251], v[140:143], v[60:63]
    ds_read_b64_tr_b16 v[246:247], v4 offset:6144
    s_xor_b32 s9, s48, 0x1e000
    buffer_load_dwordx4 v[220:223], v12, s[12:15], s9 offen sc1
    s_waitcnt lgkmcnt(4)
    v_mfma_f32_16x16x32_bf16 v[48:51], v[252:255], v[136:139], v[48:51]
    ds_read_b64_tr_b16 v[248:249], v7 offset:59392
    v_mfma_f32_16x16x32_bf16 v[52:55], v[252:255], v[140:143], v[52:55]
    ds_read_b64_tr_b16 v[250:251], v7 offset:59904
    s_waitcnt lgkmcnt(4)
    v_mfma_f32_16x16x32_bf16 v[40:43], v[240:243], v[136:139], v[40:43]
    ds_read_b64_tr_b16 v[252:253], v4 offset:25088
    v_mfma_f32_16x16x32_bf16 v[44:47], v[240:243], v[140:143], v[44:47]
    ds_read_b64_tr_b16 v[254:255], v4 offset:27136
    s_xor_b32 s9, s48, 0x2c000
    buffer_load_dwordx4 v[224:227], v12, s[12:15], s9 offen sc1
    s_waitcnt lgkmcnt(4)
    v_mfma_f32_16x16x32_bf16 v[32:35], v[244:247], v[136:139], v[32:35]
    ds_read_b64_tr_b16 v[240:241], v3 offset:25088
    v_mfma_f32_16x16x32_bf16 v[36:39], v[244:247], v[140:143], v[36:39]
    ds_read_b64_tr_b16 v[242:243], v3 offset:27136
    s_waitcnt vmcnt(34) lgkmcnt(4)
    v_mfma_f32_16x16x32_bf16 v[88:91], v[248:251], v[144:147], v[88:91]
    ds_read_b64_tr_b16 v[244:245], v4 offset:24576
    v_mfma_f32_16x16x32_bf16 v[92:95], v[248:251], v[148:151], v[92:95]
    ds_read_b64_tr_b16 v[246:247], v4 offset:26624
    s_xor_b32 s9, s48, 0x2e000
    buffer_load_dwordx4 v[228:231], v12, s[12:15], s9 offen sc1
    s_waitcnt lgkmcnt(4)
    v_mfma_f32_16x16x32_bf16 v[80:83], v[252:255], v[144:147], v[80:83]
    ds_read_b64_tr_b16 v[248:249], v3 offset:24576
    v_mfma_f32_16x16x32_bf16 v[84:87], v[252:255], v[148:151], v[84:87]
    ds_read_b64_tr_b16 v[250:251], v3 offset:26624
    s_waitcnt lgkmcnt(4)
    v_mfma_f32_16x16x32_bf16 v[72:75], v[240:243], v[144:147], v[72:75]
    ds_read_b64_tr_b16 v[252:253], v4 offset:16896
    v_mfma_f32_16x16x32_bf16 v[76:79], v[240:243], v[148:151], v[76:79]
    ds_read_b64_tr_b16 v[254:255], v4 offset:18944
    s_xor_b32 s9, s48, 0x3c000
    buffer_load_dwordx4 v[232:235], v12, s[12:15], s9 offen sc1
    s_waitcnt lgkmcnt(4)
    v_mfma_f32_16x16x32_bf16 v[64:67], v[244:247], v[144:147], v[64:67]
    ds_read_b64_tr_b16 v[240:241], v3 offset:16896
    v_mfma_f32_16x16x32_bf16 v[68:71], v[244:247], v[148:151], v[68:71]
    ds_read_b64_tr_b16 v[242:243], v3 offset:18944
    s_waitcnt lgkmcnt(4)
    v_mfma_f32_16x16x32_bf16 v[56:59], v[248:251], v[144:147], v[56:59]
    ds_read_b64_tr_b16 v[244:245], v4 offset:16384
    v_mfma_f32_16x16x32_bf16 v[60:63], v[248:251], v[148:151], v[60:63]
    ds_read_b64_tr_b16 v[246:247], v4 offset:18432
    s_xor_b32 s9, s48, 0x3e000
    buffer_load_dwordx4 v[236:239], v12, s[12:15], s9 offen sc1
    s_waitcnt lgkmcnt(4)
    v_mfma_f32_16x16x32_bf16 v[48:51], v[252:255], v[144:147], v[48:51]
    ds_read_b64_tr_b16 v[248:249], v7 offset:60416
    v_mfma_f32_16x16x32_bf16 v[52:55], v[252:255], v[148:151], v[52:55]
    ds_read_b64_tr_b16 v[250:251], v7 offset:60928
    s_waitcnt lgkmcnt(4)
    v_mfma_f32_16x16x32_bf16 v[40:43], v[240:243], v[144:147], v[40:43]
    ds_read_b64_tr_b16 v[252:253], v4 offset:29184
    v_mfma_f32_16x16x32_bf16 v[44:47], v[240:243], v[148:151], v[44:47]
    ds_read_b64_tr_b16 v[254:255], v4 offset:31232
    s_waitcnt lgkmcnt(4)
    v_mfma_f32_16x16x32_bf16 v[32:35], v[244:247], v[144:147], v[32:35]
    ds_read_b64_tr_b16 v[240:241], v3 offset:29184
    v_mfma_f32_16x16x32_bf16 v[36:39], v[244:247], v[148:151], v[36:39]
    ds_read_b64_tr_b16 v[242:243], v3 offset:31232
    s_waitcnt vmcnt(33) lgkmcnt(4)
    v_mfma_f32_16x16x32_bf16 v[88:91], v[248:251], v[152:155], v[88:91]
    ds_read_b64_tr_b16 v[244:245], v4 offset:28672
    v_mfma_f32_16x16x32_bf16 v[92:95], v[248:251], v[156:159], v[92:95]
    ds_read_b64_tr_b16 v[246:247], v4 offset:30720
    buffer_load_dword v22, v14, s[12:15], s49 offen sc1
    s_waitcnt lgkmcnt(4)
    v_mfma_f32_16x16x32_bf16 v[80:83], v[252:255], v[152:155], v[80:83]
    ds_read_b64_tr_b16 v[248:249], v3 offset:28672
    v_mfma_f32_16x16x32_bf16 v[84:87], v[252:255], v[156:159], v[84:87]
    ds_read_b64_tr_b16 v[250:251], v3 offset:30720
    s_waitcnt lgkmcnt(4)
    v_mfma_f32_16x16x32_bf16 v[72:75], v[240:243], v[152:155], v[72:75]
    ds_read_b64_tr_b16 v[252:253], v4 offset:20992
    v_mfma_f32_16x16x32_bf16 v[76:79], v[240:243], v[156:159], v[76:79]
    ds_read_b64_tr_b16 v[254:255], v4 offset:23040
    s_waitcnt lgkmcnt(4)
    v_mfma_f32_16x16x32_bf16 v[64:67], v[244:247], v[152:155], v[64:67]
    ds_read_b64_tr_b16 v[240:241], v3 offset:20992
    v_mfma_f32_16x16x32_bf16 v[68:71], v[244:247], v[156:159], v[68:71]
    ds_read_b64_tr_b16 v[242:243], v3 offset:23040
    s_waitcnt lgkmcnt(4)
    v_mfma_f32_16x16x32_bf16 v[56:59], v[248:251], v[152:155], v[56:59]
    ds_read_b64_tr_b16 v[244:245], v4 offset:20480
    v_and_b32 v0, 15, v2
    v_mul_u32_u24 v19, 1152, v0
    v_lshrrev_b32 v1, 4, v2
    v_mfma_f32_16x16x32_bf16 v[60:63], v[248:251], v[156:159], v[60:63]
    ds_read_b64_tr_b16 v[246:247], v4 offset:22528
    v_lshl_add_u32 v19, v1, 3, v19
    v_and_b32 v13, 0x3ff, v13
    v_lshrrev_b32 v1, 5, v2
    v_lshl_add_u32 v13, v1, 3, v13
    s_waitcnt lgkmcnt(4)
    v_mfma_f32_16x16x32_bf16 v[48:51], v[252:255], v[152:155], v[48:51]
    v_mfma_f32_16x16x32_bf16 v[52:55], v[252:255], v[156:159], v[52:55]
    s_waitcnt vmcnt(7)
    s_barrier
    ds_read_b64_tr_b16 v[248:249], v7 offset:63488
    ds_read_b64_tr_b16 v[250:251], v7 offset:64000
    s_waitcnt lgkmcnt(4)
    v_mfma_f32_16x16x32_bf16 v[40:43], v[240:243], v[152:155], v[40:43]
    ds_read_b64_tr_b16 v[252:253], v7 offset:64512
    v_mfma_f32_16x16x32_bf16 v[44:47], v[240:243], v[156:159], v[44:47]
    ds_read_b64_tr_b16 v[254:255], v7 offset:65024
    s_waitcnt lgkmcnt(4)
    v_mfma_f32_16x16x32_bf16 v[32:35], v[244:247], v[152:155], v[32:35]
    ds_read_b64_tr_b16 v[240:241], v7 offset:49152
    v_mfma_f32_16x16x32_bf16 v[36:39], v[244:247], v[156:159], v[36:39]
    ds_read_b64_tr_b16 v[242:243], v7 offset:49664
    s_waitcnt vmcnt(31) lgkmcnt(4)
    v_mfma_f32_16x16x32_bf16 v[88:91], v[248:251], v[160:163], v[88:91]
    ds_read_b64_tr_b16 v[244:245], v7 offset:50176
    v_mfma_f32_16x16x32_bf16 v[92:95], v[248:251], v[164:167], v[92:95]
    ds_read_b64_tr_b16 v[246:247], v7 offset:50688
    s_waitcnt vmcnt(27) lgkmcnt(4)
    v_mfma_f32_16x16x32_bf16 v[88:91], v[252:255], v[168:171], v[88:91]
    ds_read_b64_tr_b16 v[248:249], v7 offset:53248
    v_mfma_f32_16x16x32_bf16 v[92:95], v[252:255], v[172:175], v[92:95]
    ds_read_b64_tr_b16 v[250:251], v7 offset:53760
    s_waitcnt vmcnt(10)
    v_max_u32 v15, v192, v196
    v_max3_u32 v15, v200, v204, v15
    v_max3_u32 v15, v208, v212, v15
    v_cmp_eq_u32 vcc, -2, v15
    s_cbranch_vccnz sequential_preLN__sliding_block__glu_gated_bilinear__prompt_kernel_retry96
sequential_preLN__sliding_block__glu_gated_bilinear__prompt_kernel_ok97:
    s_waitcnt lgkmcnt(4)
    v_mfma_f32_16x16x32_bf16 v[88:91], v[240:243], v[176:179], v[88:91]
    ds_read_b64_tr_b16 v[252:253], v7 offset:57344
    v_mfma_f32_16x16x32_bf16 v[92:95], v[240:243], v[180:183], v[92:95]
pg_d:
    s_cbranch_execz pf_ret
    ds_read_b64_tr_b16 v[254:255], v7 offset:57856
    s_waitcnt lgkmcnt(4)
    v_mfma_f32_16x16x32_bf16 v[88:91], v[244:247], v[184:187], v[88:91]
    ds_read_b64_tr_b16 v[240:241], v7 offset:61440
    v_mfma_f32_16x16x32_bf16 v[92:95], v[244:247], v[188:191], v[92:95]
    ds_read_b64_tr_b16 v[242:243], v7 offset:61952
    s_waitcnt vmcnt(17) lgkmcnt(4)
    v_mfma_f32_16x16x32_bf16 v[88:91], v[248:251], v[192:195], v[88:91]
    ds_read_b64_tr_b16 v[244:245], v7 offset:54272
    v_mfma_f32_16x16x32_bf16 v[92:95], v[248:251], v[196:199], v[92:95]
    ds_read_b64_tr_b16 v[246:247], v7 offset:54784
    s_waitcnt vmcnt(13) lgkmcnt(4)
    v_mfma_f32_16x16x32_bf16 v[88:91], v[252:255], v[200:203], v[88:91]
    ds_read_b64_tr_b16 v[248:249], v7 offset:58368
    v_mfma_f32_16x16x32_bf16 v[92:95], v[252:255], v[204:207], v[92:95]
    ds_read_b64_tr_b16 v[250:251], v7 offset:58880
    s_waitcnt vmcnt(10) lgkmcnt(4)
    v_mfma_f32_16x16x32_bf16 v[88:91], v[240:243], v[208:211], v[88:91]
    ds_read_b64_tr_b16 v[252:253], v7 offset:62464
    v_mfma_f32_16x16x32_bf16 v[92:95], v[240:243], v[212:215], v[92:95]
    ds_read_b64_tr_b16 v[254:255], v7 offset:62976
    s_waitcnt vmcnt(1)
    v_max_u32 v15, v216, v220
    v_max3_u32 v15, v224, v228, v15
    v_max3_u32 v15, v232, v236, v15
    v_cmp_eq_u32 vcc, -2, v15
    s_cbranch_vccnz sequential_preLN__sliding_block__glu_gated_bilinear__prompt_kernel_retry98
sequential_preLN__sliding_block__glu_gated_bilinear__prompt_kernel_ok99:
    s_waitcnt vmcnt(5) lgkmcnt(4)
    v_mfma_f32_16x16x32_bf16 v[88:91], v[244:247], v[216:219], v[88:91]
    ds_read_b64_tr_b16 v[240:241], v4 offset:41472
    v_mfma_f32_16x16x32_bf16 v[92:95], v[244:247], v[220:223], v[92:95]
    ds_read_b64_tr_b16 v[242:243], v4 offset:43520
    v_mov_b32 v1, 3
    s_mov_b64 exec, 1
    buffer_store_dword v1, off, s[12:15], s50 sc1
    s_mov_b64 exec, -1
    s_waitcnt vmcnt(4) lgkmcnt(4)
    v_mfma_f32_16x16x32_bf16 v[88:91], v[248:251], v[224:227], v[88:91]
    ds_read_b64_tr_b16 v[244:245], v4 offset:45568
    v_mfma_f32_16x16x32_bf16 v[92:95], v[248:251], v[228:231], v[92:95]
    ds_read_b64_tr_b16 v[246:247], v4 offset:47616
    s_waitcnt vmcnt(2) lgkmcnt(4)
    v_mfma_f32_16x16x32_bf16 v[88:91], v[252:255], v[232:235], v[88:91]
    ds_read_b64_tr_b16 v[248:249], v4 offset:57856
    v_mfma_f32_16x16x32_bf16 v[92:95], v[252:255], v[236:239], v[92:95]
    ds_read_b64_tr_b16 v[250:251], v4 offset:59904
    s_waitcnt lgkmcnt(4)
    v_mfma_f32_16x16x32_bf16 v[80:83], v[240:243], v[160:163], v[80:83]
    ds_read_b64_tr_b16 v[252:253], v4 offset:61952
    s_waitcnt vmcnt(1)
    v_cmp_gt_i32 vcc, 2, v22
    s_nop 0
    s_and_b32 vcc_lo, vcc_lo, 15
    s_cbranch_scc1 sequential_preLN__sliding_block__glu_gated_bilinear__prompt_kernel_spin100
sequential_preLN__sliding_block__glu_gated_bilinear__prompt_kernel_go101:
    v_mfma_f32_16x16x32_bf16 v[84:87], v[240:243], v[164:167], v[84:87]
    ds_read_b64_tr_b16 v[254:255], v4 offset:64000
    s_waitcnt lgkmcnt(4)
    v_mfma_f32_16x16x32_bf16 v[80:83], v[244:247], v[168:171], v[80:83]
    ds_read_b64_tr_b16 v[240:241], v6 offset:8704
    v_cvt_pk_bf16_f32 v88, v88, v89
    v_mfma_f32_16x16x32_bf16 v[84:87], v[244:247], v[172:175], v[84:87]
    ds_read_b64_tr_b16 v[242:243], v6 offset:10752
    v_cvt_pk_bf16_f32 v89, v90, v91
    s_waitcnt lgkmcnt(4)
    v_mfma_f32_16x16x32_bf16 v[80:83], v[248:251], v[176:179], v[80:83]
    ds_read_b64_tr_b16 v[244:245], v6 offset:25088
    v_cvt_pk_bf16_f32 v90, v92, v93
    v_mfma_f32_16x16x32_bf16 v[84:87], v[248:251], v[180:183], v[84:87]
    ds_read_b64_tr_b16 v[246:247], v6 offset:27136
    v_cvt_pk_bf16_f32 v91, v94, v95
    s_waitcnt lgkmcnt(4)
    v_mfma_f32_16x16x32_bf16 v[80:83], v[252:255], v[184:187], v[80:83]
    ds_read_b64_tr_b16 v[248:249], v6 offset:41472
    v_or_b32 v88, 1, v88
    v_mfma_f32_16x16x32_bf16 v[84:87], v[252:255], v[188:191], v[84:87]
    ds_read_b64_tr_b16 v[250:251], v6 offset:43520
    s_xor_b32 s9, s48, 0x0
    buffer_store_dwordx4 v[88:91], v12, s[12:15], s9 offen sc1
    s_waitcnt lgkmcnt(4)
    v_mfma_f32_16x16x32_bf16 v[80:83], v[240:243], v[192:195], v[80:83]
    ds_read_b64_tr_b16 v[252:253], v6 offset:12800
    v_mfma_f32_16x16x32_bf16 v[84:87], v[240:243], v[196:199], v[84:87]
    ds_read_b64_tr_b16 v[254:255], v6 offset:14848
    s_waitcnt lgkmcnt(4)
    v_mfma_f32_16x16x32_bf16 v[80:83], v[244:247], v[200:203], v[80:83]
    ds_read_b64_tr_b16 v[240:241], v6 offset:29184
    v_mfma_f32_16x16x32_bf16 v[84:87], v[244:247], v[204:207], v[84:87]
    ds_read_b64_tr_b16 v[242:243], v6 offset:31232
    s_waitcnt lgkmcnt(4)
    v_mfma_f32_16x16x32_bf16 v[80:83], v[248:251], v[208:211], v[80:83]
    ds_read_b64_tr_b16 v[244:245], v6 offset:45568
    v_mfma_f32_16x16x32_bf16 v[84:87], v[248:251], v[212:215], v[84:87]
    ds_read_b64_tr_b16 v[246:247], v6 offset:47616
    s_waitcnt lgkmcnt(4)
    v_mfma_f32_16x16x32_bf16 v[80:83], v[252:255], v[216:219], v[80:83]
    ds_read_b64_tr_b16 v[248:249], v3 offset:41472
    v_mfma_f32_16x16x32_bf16 v[84:87], v[252:255], v[220:223], v[84:87]
    ds_read_b64_tr_b16 v[250:251], v3 offset:43520
    s_waitcnt lgkmcnt(4)
    v_mfma_f32_16x16x32_bf16 v[80:83], v[240:243], v[224:227], v[80:83]
    ds_read_b64_tr_b16 v[252:253], v3 offset:45568
    v_mfma_f32_16x16x32_bf16 v[84:87], v[240:243], v[228:231], v[84:87]
    ds_read_b64_tr_b16 v[254:255], v3 offset:47616
    s_waitcnt lgkmcnt(4)
    v_mfma_f32_16x16x32_bf16 v[80:83], v[244:247], v[232:235], v[80:83]
    ds_read_b64_tr_b16 v[240:241], v3 offset:57856
    v_mfma_f32_16x16x32_bf16 v[84:87], v[244:247], v[236:239], v[84:87]
    ds_read_b64_tr_b16 v[242:243], v3 offset:59904
    s_waitcnt lgkmcnt(4)
    v_mfma_f32_16x16x32_bf16 v[72:75], v[248:251], v[160:163], v[72:75]
    ds_read_b64_tr_b16 v[244:245], v3 offset:61952
    v_mfma_f32_16x16x32_bf16 v[76:79], v[248:251], v[164:167], v[76:79]
    ds_read_b64_tr_b16 v[246:247], v3 offset:64000
    s_waitcnt lgkmcnt(4)
    v_mfma_f32_16x16x32_bf16 v[72:75], v[252:255], v[168:171], v[72:75]
    ds_read_b64_tr_b16 v[248:249], v5 offset:8704
    v_cvt_pk_bf16_f32 v80, v80, v81
    v_mfma_f32_16x16x32_bf16 v[76:79], v[252:255], v[172:175], v[76:79]
    ds_read_b64_tr_b16 v[250:251], v5 offset:10752
    v_cvt_pk_bf16_f32 v81, v82, v83
    s_waitcnt lgkmcnt(4)
    v_mfma_f32_16x16x32_bf16 v[72:75], v[240:243], v[176:179], v[72:75]
    ds_read_b64_tr_b16 v[252:253], v5 offset:25088
    v_cvt_pk_bf16_f32 v82, v84, v85
    v_mfma_f32_16x16x32_bf16 v[76:79], v[240:243], v[180:183], v[76:79]
    ds_read_b64_tr_b16 v[254:255], v5 offset:27136
    v_cvt_pk_bf16_f32 v83, v86, v87
    s_waitcnt lgkmcnt(4)
    v_mfma_f32_16x16x32_bf16 v[72:75], v[244:247], v[184:187], v[72:75]
    ds_read_b64_tr_b16 v[240:241], v5 offset:41472
    v_or_b32 v80, 1, v80
    v_mfma_f32_16x16x32_bf16 v[76:79], v[244:247], v[188:191], v[76:79]
    ds_read_b64_tr_b16 v[242:243], v5 offset:43520
    s_xor_b32 s9, s48, 0x2000
    buffer_store_dwordx4 v[80:83], v12, s[12:15], s9 offen sc1
    s_waitcnt lgkmcnt(4)
    v_mfma_f32_16x16x32_bf16 v[72:75], v[248:251], v[192:195], v[72:75]
    ds_read_b64_tr_b16 v[244:245], v5 offset:12800
    v_mfma_f32_16x16x32_bf16 v[76:79], v[248:251], v[196:199], v[76:79]
    ds_read_b64_tr_b16 v[246:247], v5 offset:14848
    s_waitcnt lgkmcnt(4)
    v_mfma_f32_16x16x32_bf16 v[72:75], v[252:255], v[200:203], v[72:75]
    ds_read_b64_tr_b16 v[248:249], v5 offset:29184
    v_mfma_f32_16x16x32_bf16 v[76:79], v[252:255], v[204:207], v[76:79]
    ds_read_b64_tr_b16 v[250:251], v5 offset:31232
    s_waitcnt lgkmcnt(4)
    v_mfma_f32_16x16x32_bf16 v[72:75], v[240:243], v[208:211], v[72:75]
    ds_read_b64_tr_b16 v[252:253], v5 offset:45568
    v_mfma_f32_16x16x32_bf16 v[76:79], v[240:243], v[212:215], v[76:79]
    ds_read_b64_tr_b16 v[254:255], v5 offset:47616
    s_waitcnt lgkmcnt(4)
    v_mfma_f32_16x16x32_bf16 v[72:75], v[244:247], v[216:219], v[72:75]
    ds_read_b64_tr_b16 v[240:241], v4 offset:40960
    v_mfma_f32_16x16x32_bf16 v[76:79], v[244:247], v[220:223], v[76:79]
    ds_read_b64_tr_b16 v[242:243], v4 offset:43008
    s_waitcnt lgkmcnt(4)
    v_mfma_f32_16x16x32_bf16 v[72:75], v[248:251], v[224:227], v[72:75]
    ds_read_b64_tr_b16 v[244:245], v4 offset:45056
    v_mfma_f32_16x16x32_bf16 v[76:79], v[248:251], v[228:231], v[76:79]
    ds_read_b64_tr_b16 v[246:247], v4 offset:47104
    s_waitcnt lgkmcnt(4)
    v_mfma_f32_16x16x32_bf16 v[72:75], v[252:255], v[232:235], v[72:75]
    ds_read_b64_tr_b16 v[248:249], v4 offset:57344
    v_mfma_f32_16x16x32_bf16 v[76:79], v[252:255], v[236:239], v[76:79]
    ds_read_b64_tr_b16 v[250:251], v4 offset:59392
    s_waitcnt lgkmcnt(4)
    v_mfma_f32_16x16x32_bf16 v[64:67], v[240:243], v[160:163], v[64:67]
    ds_read_b64_tr_b16 v[252:253], v4 offset:61440
    buffer_load_dword v22, v14, s[12:15], s49 offen sc1
    v_mfma_f32_16x16x32_bf16 v[68:71], v[240:243], v[164:167], v[68:71]
    ds_read_b64_tr_b16 v[254:255], v4 offset:63488
    s_waitcnt lgkmcnt(4)
    v_mfma_f32_16x16x32_bf16 v[64:67], v[244:247], v[168:171], v[64:67]
    ds_read_b64_tr_b16 v[240:241], v6 offset:8192
    v_cvt_pk_bf16_f32 v72, v72, v73
    v_mfma_f32_16x16x32_bf16 v[68:71], v[244:247], v[172:175], v[68:71]
    ds_read_b64_tr_b16 v[242:243], v6 offset:10240
    v_cvt_pk_bf16_f32 v73, v74, v75
    s_waitcnt lgkmcnt(4)
    v_mfma_f32_16x16x32_bf16 v[64:67], v[248:251], v[176:179], v[64:67]
    ds_read_b64_tr_b16 v[244:245], v6 offset:24576
    v_cvt_pk_bf16_f32 v74, v76, v77
    v_mfma_f32_16x16x32_bf16 v[68:71], v[248:251], v[180:183], v[68:71]
    ds_read_b64_tr_b16 v[246:247], v6 offset:26624
    v_cvt_pk_bf16_f32 v75, v78, v79
    s_waitcnt lgkmcnt(4)
    v_mfma_f32_16x16x32_bf16 v[64:67], v[252:255], v[184:187], v[64:67]
    ds_read_b64_tr_b16 v[248:249], v6 offset:40960
    v_or_b32 v72, 1, v72
    v_mfma_f32_16x16x32_bf16 v[68:71], v[252:255], v[188:191], v[68:71]
    ds_read_b64_tr_b16 v[250:251], v6 offset:43008
    s_xor_b32 s9, s48, 0x4000
    buffer_store_dwordx4 v[72:75], v12, s[12:15], s9 offen sc1
    s_waitcnt lgkmcnt(4)
    v_mfma_f32_16x16x32_bf16 v[64:67], v[240:243], v[192:195], v[64:67]
    ds_read_b64_tr_b16 v[252:253], v6 offset:12288
    v_mfma_f32_16x16x32_bf16 v[68:71], v[240:243], v[196:199], v[68:71]
    ds_read_b64_tr_b16 v[254:255], v6 offset:14336
    s_waitcnt lgkmcnt(4)
    v_mfma_f32_16x16x32_bf16 v[64:67], v[244:247], v[200:203], v[64:67]
    ds_read_b64_tr_b16 v[240:241], v6 offset:28672
    v_mfma_f32_16x16x32_bf16 v[68:71], v[244:247], v[204:207], v[68:71]
    ds_read_b64_tr_b16 v[242:243], v6 offset:30720
    s_waitcnt lgkmcnt(4)
    v_mfma_f32_16x16x32_bf16 v[64:67], v[248:251], v[208:211], v[64:67]
    ds_read_b64_tr_b16 v[244:245], v6 offset:45056
    v_mfma_f32_16x16x32_bf16 v[68:71], v[248:251], v[212:215], v[68:71]
    ds_read_b64_tr_b16 v[246:247], v6 offset:47104
    s_waitcnt lgkmcnt(4)
    v_mfma_f32_16x16x32_bf16 v[64:67], v[252:255], v[216:219], v[64:67]
    ds_read_b64_tr_b16 v[248:249], v3 offset:40960
    v_mfma_f32_16x16x32_bf16 v[68:71], v[252:255], v[220:223], v[68:71]
    ds_read_b64_tr_b16 v[250:251], v3 offset:43008
    s_waitcnt lgkmcnt(4)
    v_mfma_f32_16x16x32_bf16 v[64:67], v[240:243], v[224:227], v[64:67]
    ds_read_b64_tr_b16 v[252:253], v3 offset:45056
    v_mfma_f32_16x16x32_bf16 v[68:71], v[240:243], v[228:231], v[68:71]
    ds_read_b64_tr_b16 v[254:255], v3 offset:47104
    s_waitcnt lgkmcnt(4)
    v_mfma_f32_16x16x32_bf16 v[64:67], v[244:247], v[232:235], v[64:67]
    ds_read_b64_tr_b16 v[240:241], v3 offset:57344
    v_mfma_f32_16x16x32_bf16 v[68:71], v[244:247], v[236:239], v[68:71]
    ds_read_b64_tr_b16 v[242:243], v3 offset:59392
    s_waitcnt lgkmcnt(4)
    v_mfma_f32_16x16x32_bf16 v[56:59], v[248:251], v[160:163], v[56:59]
    ds_read_b64_tr_b16 v[244:245], v3 offset:61440
    v_mfma_f32_16x16x32_bf16 v[60:63], v[248:251], v[164:167], v[60:63]
    ds_read_b64_tr_b16 v[246:247], v3 offset:63488
    s_waitcnt lgkmcnt(4)
    v_mfma_f32_16x16x32_bf16 v[56:59], v[252:255], v[168:171], v[56:59]
    ds_read_b64_tr_b16 v[248:249], v5 offset:8192
    v_cvt_pk_bf16_f32 v64, v64, v65
    v_mfma_f32_16x16x32_bf16 v[60:63], v[252:255], v[172:175], v[60:63]
    ds_read_b64_tr_b16 v[250:251], v5 offset:10240
    v_cvt_pk_bf16_f32 v65, v66, v67
    s_waitcnt lgkmcnt(4)
    v_mfma_f32_16x16x32_bf16 v[56:59], v[240:243], v[176:179], v[56:59]
    ds_read_b64_tr_b16 v[252:253], v5 offset:24576
    v_cvt_pk_bf16_f32 v66, v68, v69
    v_mfma_f32_16x16x32_bf16 v[60:63], v[240:243], v[180:183], v[60:63]
    ds_read_b64_tr_b16 v[254:255], v5 offset:26624
    v_cvt_pk_bf16_f32 v67, v70, v71
    s_waitcnt lgkmcnt(4)
    v_mfma_f32_16x16x32_bf16 v[56:59], v[244:247], v[184:187], v[56:59]
    ds_read_b64_tr_b16 v[240:241], v5 offset:40960
    v_or_b32 v64, 1, v64
    v_mfma_f32_16x16x32_bf16 v[60:63], v[244:247], v[188:191], v[60:63]
    ds_read_b64_tr_b16 v[242:243], v5 offset:43008
    s_xor_b32 s9, s48, 0x6000
    buffer_store_dwordx4 v[64:67], v12, s[12:15], s9 offen sc1
    s_waitcnt lgkmcnt(4)
    v_mfma_f32_16x16x32_bf16 v[56:59], v[248:251], v[192:195], v[56:59]
    ds_read_b64_tr_b16 v[244:245], v5 offset:12288
    v_mfma_f32_16x16x32_bf16 v[60:63], v[248:251], v[196:199], v[60:63]
    ds_read_b64_tr_b16 v[246:247], v5 offset:14336
    s_xor_b32 s9, s48, 0xe02000
    buffer_load_dwordx4 v[84:87], v12, s[12:15], s9 offen sc1
    s_waitcnt lgkmcnt(4)
    v_mfma_f32_16x16x32_bf16 v[56:59], v[252:255], v[200:203], v[56:59]
    ds_read_b64_tr_b16 v[248:249], v5 offset:28672
    v_mfma_f32_16x16x32_bf16 v[60:63], v[252:255], v[204:207], v[60:63]
    ds_read_b64_tr_b16 v[250:251], v5 offset:30720
    s_waitcnt lgkmcnt(4)
    v_mfma_f32_16x16x32_bf16 v[56:59], v[240:243], v[208:211], v[56:59]
    ds_read_b64_tr_b16 v[252:253], v5 offset:45056
    v_mfma_f32_16x16x32_bf16 v[60:63], v[240:243], v[212:215], v[60:63]
    ds_read_b64_tr_b16 v[254:255], v5 offset:47104
    s_waitcnt lgkmcnt(4)
    v_mfma_f32_16x16x32_bf16 v[56:59], v[244:247], v[216:219], v[56:59]
    ds_read_b64_tr_b16 v[240:241], v4 offset:33280
    v_mfma_f32_16x16x32_bf16 v[60:63], v[244:247], v[220:223], v[60:63]
    ds_read_b64_tr_b16 v[242:243], v4 offset:35328
    s_waitcnt lgkmcnt(4)
    v_mfma_f32_16x16x32_bf16 v[56:59], v[248:251], v[224:227], v[56:59]
    ds_read_b64_tr_b16 v[244:245], v4 offset:37376
    v_mfma_f32_16x16x32_bf16 v[60:63], v[248:251], v[228:231], v[60:63]
    ds_read_b64_tr_b16 v[246:247], v4 offset:39424
    s_waitcnt lgkmcnt(4)
    v_mfma_f32_16x16x32_bf16 v[56:59], v[252:255], v[232:235], v[56:59]
    ds_read_b64_tr_b16 v[248:249], v4 offset:49664
    v_mfma_f32_16x16x32_bf16 v[60:63], v[252:255], v[236:239], v[60:63]
    ds_read_b64_tr_b16 v[250:251], v4 offset:51712
    s_waitcnt lgkmcnt(4)
    v_mfma_f32_16x16x32_bf16 v[48:51], v[240:243], v[160:163], v[48:51]
    ds_read_b64_tr_b16 v[252:253], v4 offset:53760
    s_waitcnt vmcnt(3)
    v_cmp_gt_i32 vcc, 3, v22
    s_nop 0
    s_and_b32 vcc_lo, vcc_lo, 15
    s_cbranch_scc1 sequential_preLN__sliding_block__glu_gated_bilinear__prompt_kernel_spin102
sequential_preLN__sliding_block__glu_gated_bilinear__prompt_kernel_go103:
    v_mfma_f32_16x16x32_bf16 v[52:55], v[240:243], v[164:167], v[52:55]
    ds_read_b64_tr_b16 v[254:255], v4 offset:55808
    s_waitcnt lgkmcnt(4)
    v_mfma_f32_16x16x32_bf16 v[48:51], v[244:247], v[168:171], v[48:51]
    ds_read_b64_tr_b16 v[240:241], v6 offset:512
    v_cvt_pk_bf16_f32 v56, v56, v57
    v_mfma_f32_16x16x32_bf16 v[52:55], v[244:247], v[172:175], v[52:55]
    ds_read_b64_tr_b16 v[242:243], v6 offset:2560
    v_cvt_pk_bf16_f32 v57, v58, v59
    s_waitcnt lgkmcnt(4)
    v_mfma_f32_16x16x32_bf16 v[48:51], v[248:251], v[176:179], v[48:51]
    ds_read_b64_tr_b16 v[244:245], v6 offset:16896
    v_cvt_pk_bf16_f32 v58, v60, v61
    v_mfma_f32_16x16x32_bf16 v[52:55], v[248:251], v[180:183], v[52:55]
    ds_read_b64_tr_b16 v[246:247], v6 offset:18944
    v_cvt_pk_bf16_f32 v59, v62, v63
    s_waitcnt lgkmcnt(4)
    v_mfma_f32_16x16x32_bf16 v[48:51], v[252:255], v[184:187], v[48:51]
    ds_read_b64_tr_b16 v[248:249], v6 offset:33280
    v_or_b32 v56, 1, v56
    v_mfma_f32_16x16x32_bf16 v[52:55], v[252:255], v[188:191], v[52:55]
    ds_read_b64_tr_b16 v[250:251], v6 offset:35328
    s_xor_b32 s9, s48, 0x8000
    buffer_store_dwordx4 v[56:59], v12, s[12:15], s9 offen sc1
    s_waitcnt lgkmcnt(4)
    v_mfma_f32_16x16x32_bf16 v[48:51], v[240:243], v[192:195], v[48:51]
    ds_read_b64_tr_b16 v[252:253], v6 offset:4608
    s_waitcnt vmcnt(1)
    v_and_b32 v15, 1, v84
    v_cmp_eq_u32 vcc, 0, v15
    s_cbranch_vccnz sequential_preLN__sliding_block__glu_gated_bilinear__prompt_kernel_retry104
sequential_preLN__sliding_block__glu_gated_bilinear__prompt_kernel_ok105:
    v_mfma_f32_16x16x32_bf16 v[52:55], v[240:243], v[196:199], v[52:55]
    ds_read_b64_tr_b16 v[254:255], v6 offset:6656
    v_lshlrev_b32 v96, 16, v84
    s_xor_b32 s9, s48, 0xc04000
    buffer_load_dwordx4 v[76:79], v12, s[12:15], s9 offen sc1
    s_waitcnt lgkmcnt(4)
    v_mfma_f32_16x16x32_bf16 v[48:51], v[244:247], v[200:203], v[48:51]
    ds_read_b64_tr_b16 v[240:241], v6 offset:20992
    v_and_b32 v97, 0xffff0000, v84
    v_mfma_f32_16x16x32_bf16 v[52:55], v[244:247], v[204:207], v[52:55]
    ds_read_b64_tr_b16 v[242:243], v6 offset:23040
    s_cmp_lg_u32 s36, s37
    s_cbranch_scc1 sequential_preLN__sliding_block__glu_gated_bilinear__prompt_kernel_nr106
    s_add_u32 s9, s38, 32
    s_lshl_b32 s3, s9, 5
    s_add_u32 s3, s3, s46
    s_lshl_b32 s9, s9, 10
    s_add_u32 s9, s9, s46
    s_add_u32 s9, s9, 0xa40000
    buffer_load_dwordx2 v[8:9], v13, s[12:15], s9 offen offset:0 sc1
    buffer_load_dwordx2 v[10:11], v13, s[12:15], s9 offen offset:256 sc1
    s_mov_b32 s6, s3
    s_xor_b32 s9, s48, 0x0
    buffer_load_dwordx4 v[88:91], v12, s[12:15], s9 offen sc1
    s_xor_b32 s9, s48, 0x200000
    buffer_load_dwordx4 v[92:95], v12, s[12:15], s9 offen sc1
    s_xor_b32 s9, s48, 0x400000
    buffer_load_dwordx4 v[80:83], v12, s[12:15], s9 offen sc1
    s_xor_b32 s9, s48, 0x600000
    buffer_load_dwordx4 v[72:75], v12, s[12:15], s9 offen sc1
    s_xor_b32 s9, s48, 0x800000
    buffer_load_dwordx4 v[64:67], v12, s[12:15], s9 offen sc1
    s_xor_b32 s9, s48, 0xa00000
    buffer_load_dwordx4 v[56:59], v12, s[12:15], s9 offen sc1
    s_xor_b32 s9, s48, 0xc00000
    buffer_load_dwordx4 v[104:107], v12, s[12:15], s9 offen sc1
    s_xor_b32 s9, s48, 0xe00000
    buffer_load_dwordx4 v[108:111], v12, s[12:15], s9 offen sc1
sequential_preLN__sliding_block__glu_gated_bilinear__prompt_kernel_nr106:
    buffer_load_dword v23, v14, s[12:15], s49 offen
    s_waitcnt lgkmcnt(4)
    v_mfma_f32_16x16x32_bf16 v[48:51], v[248:251], v[208:211], v[48:51]
    ds_read_b64_tr_b16 v[244:245], v6 offset:37376
    v_lshlrev_b32 v98, 16, v85
    v_mfma_f32_16x16x32_bf16 v[52:55], v[248:251], v[212:215], v[52:55]
    ds_read_b64_tr_b16 v[246:247], v6 offset:39424
    v_and_b32 v99, 0xffff0000, v85
    s_waitcnt lgkmcnt(4)
    v_mfma_f32_16x16x32_bf16 v[48:51], v[252:255], v[216:219], v[48:51]
    ds_read_b64_tr_b16 v[248:249], v3 offset:33280
    v_mfma_f32_16x16x32_bf16 v[52:55], v[252:255], v[220:223], v[52:55]
    ds_read_b64_tr_b16 v[250:251], v3 offset:35328
    v_lshlrev_b32 v100, 16, v86
    s_waitcnt lgkmcnt(4)
    v_mfma_f32_16x16x32_bf16 v[48:51], v[240:243], v[224:227], v[48:51]
    ds_read_b64_tr_b16 v[252:253], v3 offset:37376
    v_and_b32 v101, 0xffff0000, v86
    v_mfma_f32_16x16x32_bf16 v[52:55], v[240:243], v[228:231], v[52:55]
    ds_read_b64_tr_b16 v[254:255], v3 offset:39424
    v_lshlrev_b32 v102, 16, v87
    s_waitcnt lgkmcnt(4)
    v_mfma_f32_16x16x32_bf16 v[48:51], v[244:247], v[232:235], v[48:51]
    ds_read_b64_tr_b16 v[240:241], v3 offset:49664
    v_mfma_f32_16x16x32_bf16 v[52:55], v[244:247], v[236:239], v[52:55]
    ds_read_b64_tr_b16 v[242:243], v3 offset:51712
    v_and_b32 v103, 0xffff0000, v87
    s_waitcnt lgkmcnt(4)
    v_mfma_f32_16x16x32_bf16 v[40:43], v[248:251], v[160:163], v[40:43]
    ds_read_b64_tr_b16 v[244:245], v3 offset:53760
    v_mfma_f32_16x16x32_bf16 v[44:47], v[248:251], v[164:167], v[44:47]
    ds_read_b64_tr_b16 v[246:247], v3 offset:55808
    s_waitcnt lgkmcnt(4)
    v_mfma_f32_16x16x32_bf16 v[40:43], v[252:255], v[168:171], v[40:43]
    ds_read_b64_tr_b16 v[248:249], v5 offset:512
    v_cvt_pk_bf16_f32 v48, v48, v49
    v_mfma_f32_16x16x32_bf16 v[44:47], v[252:255], v[172:175], v[44:47]
    ds_read_b64_tr_b16 v[250:251], v5 offset:2560
    v_cvt_pk_bf16_f32 v49, v50, v51
    s_waitcnt lgkmcnt(4)
    v_mfma_f32_16x16x32_bf16 v[40:43], v[240:243], v[176:179], v[40:43]
    ds_read_b64_tr_b16 v[252:253], v5 offset:16896
    v_cvt_pk_bf16_f32 v50, v52, v53
    v_mfma_f32_16x16x32_bf16 v[44:47], v[240:243], v[180:183], v[44:47]
    ds_read_b64_tr_b16 v[254:255], v5 offset:18944
    v_cvt_pk_bf16_f32 v51, v54, v55
    s_waitcnt lgkmcnt(4)
    v_mfma_f32_16x16x32_bf16 v[40:43], v[244:247], v[184:187], v[40:43]
    ds_read_b64_tr_b16 v[240:241], v5 offset:33280
    v_or_b32 v48, 1, v48
    v_mfma_f32_16x16x32_bf16 v[44:47], v[244:247], v[188:191], v[44:47]
    ds_read_b64_tr_b16 v[242:243], v5 offset:35328
    s_xor_b32 s9, s48, 0xa000
    buffer_store_dwordx4 v[48:51], v12, s[12:15], s9 offen sc1
    s_waitcnt lgkmcnt(4)
    v_mfma_f32_16x16x32_bf16 v[40:43], v[248:251], v[192:195], v[40:43]
    ds_read_b64_tr_b16 v[244:245], v5 offset:4608
    s_waitcnt vmcnt(2)
    v_and_b32 v15, 1, v76
    v_cmp_eq_u32 vcc, 0, v15
    s_cbranch_vccnz sequential_preLN__sliding_block__glu_gated_bilinear__prompt_kernel_retry107
sequential_preLN__sliding_block__glu_gated_bilinear__prompt_kernel_ok108:
    v_mfma_f32_16x16x32_bf16 v[44:47], v[248:251], v[196:199], v[44:47]
    ds_read_b64_tr_b16 v[246:247], v5 offset:6656
    v_lshlrev_b32 v0, 16, v76
    v_and_b32 v76, 0xffff0000, v76
    v_add_f32 v96, v96, v0
    s_xor_b32 s9, s48, 0xa06000
    buffer_load_dwordx4 v[68:71], v12, s[12:15], s9 offen sc1
    s_waitcnt lgkmcnt(4)
    v_mfma_f32_16x16x32_bf16 v[40:43], v[252:255], v[200:203], v[40:43]
    ds_read_b64_tr_b16 v[248:249], v5 offset:20992
    v_mfma_f32_16x16x32_bf16 v[44:47], v[252:255], v[204:207], v[44:47]
    ds_read_b64_tr_b16 v[250:251], v5 offset:23040
    v_add_f32 v97, v97, v76
    s_waitcnt lgkmcnt(4)
    v_mfma_f32_16x16x32_bf16 v[40:43], v[240:243], v[208:211], v[40:43]
    ds_read_b64_tr_b16 v[252:253], v5 offset:37376
    v_lshlrev_b32 v1, 16, v77
    v_and_b32 v77, 0xffff0000, v77
    v_add_f32 v98, v98, v1
    v_mfma_f32_16x16x32_bf16 v[44:47], v[240:243], v[212:215], v[44:47]
    ds_read_b64_tr_b16 v[254:255], v5 offset:39424
    v_add_f32 v99, v99, v77
    s_waitcnt lgkmcnt(4)
    v_mfma_f32_16x16x32_bf16 v[40:43], v[244:247], v[216:219], v[40:43]
    ds_read_b64_tr_b16 v[240:241], v4 offset:32768
    v_mfma_f32_16x16x32_bf16 v[44:47], v[244:247], v[220:223], v[44:47]
    ds_read_b64_tr_b16 v[242:243], v4 offset:34816
    v_lshlrev_b32 v0, 16, v78
    v_and_b32 v78, 0xffff0000, v78
    v_add_f32 v100, v100, v0
    s_waitcnt lgkmcnt(4)
    v_mfma_f32_16x16x32_bf16 v[40:43], v[248:251], v[224:227], v[40:43]
    ds_read_b64_tr_b16 v[244:245], v4 offset:36864
    v_add_f32 v101, v101, v78
    v_mfma_f32_16x16x32_bf16 v[44:47], v[248:251], v[228:231], v[44:47]
    ds_read_b64_tr_b16 v[246:247], v4 offset:38912
    v_lshlrev_b32 v1, 16, v79
    v_and_b32 v79, 0xffff0000, v79
    v_add_f32 v102, v102, v1
    s_waitcnt lgkmcnt(4)
    v_mfma_f32_16x16x32_bf16 v[40:43], v[252:255], v[232:235], v[40:43]
    ds_read_b64_tr_b16 v[248:249], v4 offset:49152
    v_mfma_f32_16x16x32_bf16 v[44:47], v[252:255], v[236:239], v[44:47]
    ds_read_b64_tr_b16 v[250:251], v4 offset:51200
    v_add_f32 v103, v103, v79
    s_waitcnt lgkmcnt(4)
    v_mfma_f32_16x16x32_bf16 v[32:35], v[240:243], v[160:163], v[32:35]
    ds_read_b64_tr_b16 v[252:253], v4 offset:53248
    s_cmp_lg_u32 s36, s37
    s_cbranch_scc1 sequential_preLN__sliding_block__glu_gated_bilinear__prompt_kernel_nr109
    s_waitcnt vmcnt(2)
    v_and_b32 v15, v88, v92
    v_and_b32 v15, v80, v15
    v_and_b32 v15, v72, v15
    v_and_b32 v15, v64, v15
    v_and_b32 v15, v56, v15
    v_and_b32 v15, v104, v15
    v_and_b32 v15, v108, v15
    v_and_b32 v15, 1, v15
    v_cmp_eq_u32 vcc, 0, v15
    s_cbranch_vccnz sequential_preLN__sliding_block__glu_gated_bilinear__prompt_kernel_retry110
sequential_preLN__sliding_block__glu_gated_bilinear__prompt_kernel_ok111:
    v_lshlrev_b32 v20, 16, v88
    v_and_b32 v21, 0xffff0000, v88
    v_lshlrev_b32 v22, 16, v89
    v_and_b32 v23, 0xffff0000, v89
    v_lshlrev_b32 v0, 16, v92
    v_and_b32 v92, 0xffff0000, v92
    v_add_f32 v20, v20, v0
    v_add_f32 v21, v21, v92
    v_lshlrev_b32 v1, 16, v93
    v_and_b32 v93, 0xffff0000, v93
    v_add_f32 v22, v22, v1
    v_add_f32 v23, v23, v93
    v_lshlrev_b32 v0, 16, v80
    v_and_b32 v80, 0xffff0000, v80
    v_add_f32 v20, v20, v0
    v_add_f32 v21, v21, v80
    v_lshlrev_b32 v1, 16, v81
    v_and_b32 v81, 0xffff0000, v81
    v_add_f32 v22, v22, v1
    v_add_f32 v23, v23, v81
    v_lshlrev_b32 v0, 16, v72
    v_and_b32 v72, 0xffff0000, v72
    v_add_f32 v20, v20, v0
    v_add_f32 v21, v21, v72
    v_lshlrev_b32 v1, 16, v73
    v_and_b32 v73, 0xffff0000, v73
    v_add_f32 v22, v22, v1
    v_add_f32 v23, v23, v73
    v_lshlrev_b32 v0, 16, v64
    v_and_b32 v64, 0xffff0000, v64
    v_add_f32 v20, v20, v0
    v_add_f32 v21, v21, v64
    v_lshlrev_b32 v1, 16, v65
    v_and_b32 v65, 0xffff0000, v65
    v_add_f32 v22, v22, v1
    v_add_f32 v23, v23, v65
    v_lshlrev_b32 v0, 16, v56
    v_and_b32 v56, 0xffff0000, v56
    v_add_f32 v20, v20, v0
    v_add_f32 v21, v21, v56
    v_lshlrev_b32 v1, 16, v57
    v_and_b32 v57, 0xffff0000, v57
    v_add_f32 v22, v22, v1
    v_add_f32 v23, v23, v57
    v_lshlrev_b32 v0, 16, v104
    v_and_b32 v104, 0xffff0000, v104
    v_add_f32 v20, v20, v0
    v_add_f32 v21, v21, v104
    v_lshlrev_b32 v1, 16, v105
    v_and_b32 v105, 0xffff0000, v105
    v_add_f32 v22, v22, v1
    v_add_f32 v23, v23, v105
    v_lshlrev_b32 v0, 16, v108
    v_and_b32 v108, 0xffff0000, v108
    v_add_f32 v20, v20, v0
    v_add_f32 v21, v21, v108
    v_lshlrev_b32 v1, 16, v109
    v_and_b32 v109, 0xffff0000, v109
    v_add_f32 v22, v22, v1
    v_add_f32 v23, v23, v109
    v_lshlrev_b32 v0, 16, v8
    v_and_b32 v1, 0xffff0000, v8
    v_fma_f32 v20, v20, v16, v0
    v_fma_f32 v21, v21, v16, v1
    v_cvt_pk_bf16_f32 v8, v20, v21
    v_lshlrev_b32 v0, 16, v9
    v_and_b32 v1, 0xffff0000, v9
    v_fma_f32 v22, v22, v16, v0
    v_fma_f32 v23, v23, v16, v1
    v_cvt_pk_bf16_f32 v9, v22, v23
    buffer_store_dwordx2 v[8:9], v19, s[32:35], s6 offen sc1 nt
    v_lshlrev_b32 v20, 16, v90
    v_and_b32 v21, 0xffff0000, v90
    v_lshlrev_b32 v22, 16, v91
    v_and_b32 v23, 0xffff0000, v91
    v_lshlrev_b32 v0, 16, v94
    v_and_b32 v94, 0xffff0000, v94
    v_add_f32 v20, v20, v0
    v_add_f32 v21, v21, v94
    v_lshlrev_b32 v1, 16, v95
    v_and_b32 v95, 0xffff0000, v95
    v_add_f32 v22, v22, v1
    v_add_f32 v23, v23, v95
    v_lshlrev_b32 v0, 16, v82
    v_and_b32 v82, 0xffff0000, v82
    v_add_f32 v20, v20, v0
    v_add_f32 v21, v21, v82
    v_lshlrev_b32 v1, 16, v83
    v_and_b32 v83, 0xffff0000, v83
    v_add_f32 v22, v22, v1
    v_add_f32 v23, v23, v83
    v_lshlrev_b32 v0, 16, v74
    v_and_b32 v74, 0xffff0000, v74
    v_add_f32 v20, v20, v0
    v_add_f32 v21, v21, v74
    v_lshlrev_b32 v1, 16, v75
    v_and_b32 v75, 0xffff0000, v75
    v_add_f32 v22, v22, v1
    v_add_f32 v23, v23, v75
    v_lshlrev_b32 v0, 16, v66
    v_and_b32 v66, 0xffff0000, v66
    v_add_f32 v20, v20, v0
    v_add_f32 v21, v21, v66
    v_lshlrev_b32 v1, 16, v67
    v_and_b32 v67, 0xffff0000, v67
    v_add_f32 v22, v22, v1
    v_add_f32 v23, v23, v67
    v_lshlrev_b32 v0, 16, v58
    v_and_b32 v58, 0xffff0000, v58
    v_add_f32 v20, v20, v0
    v_add_f32 v21, v21, v58
    v_lshlrev_b32 v1, 16, v59
    v_and_b32 v59, 0xffff0000, v59
    v_add_f32 v22, v22, v1
    v_add_f32 v23, v23, v59
    v_lshlrev_b32 v0, 16, v106
    v_and_b32 v106, 0xffff0000, v106
    v_add_f32 v20, v20, v0
    v_add_f32 v21, v21, v106
    v_lshlrev_b32 v1, 16, v107
    v_and_b32 v107, 0xffff0000, v107
    v_add_f32 v22, v22, v1
    v_add_f32 v23, v23, v107
    v_lshlrev_b32 v0, 16, v110
    v_and_b32 v110, 0xffff0000, v110
    v_add_f32 v20, v20, v0
    v_add_f32 v21, v21, v110
    v_lshlrev_b32 v1, 16, v111
    v_and_b32 v111, 0xffff0000, v111
    v_add_f32 v22, v22, v1
    v_add_f32 v23, v23, v111
    v_lshlrev_b32 v0, 16, v10
    v_and_b32 v1, 0xffff0000, v10
    v_fma_f32 v20, v20, v17, v0
    v_fma_f32 v21, v21, v17, v1
    v_cvt_pk_bf16_f32 v10, v20, v21
    v_lshlrev_b32 v0, 16, v11
    v_and_b32 v1, 0xffff0000, v11
    v_fma_f32 v22, v22, v17, v0
    v_fma_f32 v23, v23, v17, v1
    v_cvt_pk_bf16_f32 v11, v22, v23
    s_add_u32 s6, s6, 18432
    buffer_store_dwordx2 v[10:11], v19, s[32:35], s6 offen sc1 nt
sequential_preLN__sliding_block__glu_gated_bilinear__prompt_kernel_nr109:
    v_mfma_f32_16x16x32_bf16 v[36:39], v[240:243], v[164:167], v[36:39]
    ds_read_b64_tr_b16 v[254:255], v4 offset:55296
    s_waitcnt lgkmcnt(4)
pg_e:
    s_cbranch_execz pf_ret
    v_mfma_f32_16x16x32_bf16 v[32:35], v[244:247], v[168:171], v[32:35]
    ds_read_b64_tr_b16 v[240:241], v6 offset:0
    v_cvt_pk_bf16_f32 v40, v40, v41
    v_mfma_f32_16x16x32_bf16 v[36:39], v[244:247], v[172:175], v[36:39]
    ds_read_b64_tr_b16 v[242:243], v6 offset:2048
    v_cvt_pk_bf16_f32 v41, v42, v43
    s_waitcnt lgkmcnt(4)
    v_mfma_f32_16x16x32_bf16 v[32:35], v[248:251], v[176:179], v[32:35]
    ds_read_b64_tr_b16 v[244:245], v6 offset:16384
    v_cvt_pk_bf16_f32 v42, v44, v45
    v_mfma_f32_16x16x32_bf16 v[36:39], v[248:251], v[180:183], v[36:39]
    ds_read_b64_tr_b16 v[246:247], v6 offset:18432
    v_cvt_pk_bf16_f32 v43, v46, v47
    s_waitcnt lgkmcnt(4)
    v_mfma_f32_16x16x32_bf16 v[32:35], v[252:255], v[184:187], v[32:35]
    ds_read_b64_tr_b16 v[248:249], v6 offset:32768
    v_or_b32 v40, 1, v40
    v_mfma_f32_16x16x32_bf16 v[36:39], v[252:255], v[188:191], v[36:39]
    ds_read_b64_tr_b16 v[250:251], v6 offset:34816
    s_xor_b32 s9, s48, 0xc000
    buffer_store_dwordx4 v[40:43], v12, s[12:15], s9 offen sc1
    s_waitcnt lgkmcnt(4)
    v_mfma_f32_16x16x32_bf16 v[32:35], v[240:243], v[192:195], v[32:35]
    ds_read_b64_tr_b16 v[252:253], v6 offset:4096
    s_waitcnt vmcnt(1)
    v_and_b32 v15, 1, v68
    v_cmp_eq_u32 vcc, 0, v15
    s_cbranch_vccnz sequential_preLN__sliding_block__glu_gated_bilinear__prompt_kernel_retry112
sequential_preLN__sliding_block__glu_gated_bilinear__prompt_kernel_ok113:
    v_mfma_f32_16x16x32_bf16 v[36:39], v[240:243], v[196:199], v[36:39]
    ds_read_b64_tr_b16 v[254:255], v6 offset:6144
    v_lshlrev_b32 v0, 16, v68
    v_and_b32 v68, 0xffff0000, v68
    v_add_f32 v96, v96, v0
    s_xor_b32 s9, s48, 0x808000
    buffer_load_dwordx4 v[60:63], v12, s[12:15], s9 offen sc1
    s_waitcnt lgkmcnt(4)
    v_mfma_f32_16x16x32_bf16 v[32:35], v[244:247], v[200:203], v[32:35]
    ds_read_b64_tr_b16 v[240:241], v6 offset:20480
    v_mfma_f32_16x16x32_bf16 v[36:39], v[244:247], v[204:207], v[36:39]
    ds_read_b64_tr_b16 v[242:243], v6 offset:22528
    v_add_f32 v97, v97, v68
    s_waitcnt lgkmcnt(4)
    v_mfma_f32_16x16x32_bf16 v[32:35], v[248:251], v[208:211], v[32:35]
    ds_read_b64_tr_b16 v[244:245], v6 offset:36864
    v_lshlrev_b32 v1, 16, v69
    v_and_b32 v69, 0xffff0000, v69
    v_add_f32 v98, v98, v1
    v_mfma_f32_16x16x32_bf16 v[36:39], v[248:251], v[212:215], v[36:39]
    ds_read_b64_tr_b16 v[246:247], v6 offset:38912
    v_add_f32 v99, v99, v69
    s_lshl_b32 s9, s38, 3
    s_add_u32 s9, s9, s37
    s_lshl_b32 s3, s9, 5
    s_add_u32 s3, s3, s46
    s_lshl_b32 s9, s9, 10
    s_add_u32 s9, s9, s46
    s_add_u32 s9, s9, 0xa40000
    buffer_load_dwordx2 v[8:9], v13, s[12:15], s9 offen offset:0 sc1
    buffer_load_dwordx2 v[10:11], v13, s[12:15], s9 offen offset:256 sc1
    s_waitcnt lgkmcnt(4)
    v_mfma_f32_16x16x32_bf16 v[32:35], v[252:255], v[216:219], v[32:35]
    ds_read_b64_tr_b16 v[248:249], v5 offset:49152
    v_mfma_f32_16x16x32_bf16 v[36:39], v[252:255], v[220:223], v[36:39]
    ds_read_b64_tr_b16 v[250:251], v5 offset:51200
    v_lshlrev_b32 v0, 16, v70
    v_and_b32 v70, 0xffff0000, v70
    v_add_f32 v100, v100, v0
    s_waitcnt lgkmcnt(4)
    v_mfma_f32_16x16x32_bf16 v[32:35], v[240:243], v[224:227], v[32:35]
    ds_read_b64_tr_b16 v[252:253], v5 offset:53248
    v_add_f32 v101, v101, v70
    v_mfma_f32_16x16x32_bf16 v[36:39], v[240:243], v[228:231], v[36:39]
    ds_read_b64_tr_b16 v[254:255], v5 offset:55296
    v_lshlrev_b32 v1, 16, v71
    v_and_b32 v71, 0xffff0000, v71
    v_add_f32 v102, v102, v1
    s_waitcnt lgkmcnt(4)
    v_mfma_f32_16x16x32_bf16 v[32:35], v[244:247], v[232:235], v[32:35]
    ds_read_b64_tr_b16 v[240:241], v3 offset:0
    v_mfma_f32_16x16x32_bf16 v[36:39], v[244:247], v[236:239], v[36:39]
    ds_read_b64_tr_b16 v[242:243], v3 offset:2048
    v_add_f32 v103, v103, v71
    s_waitcnt lgkmcnt(4)
    v_mfma_f32_16x16x32_bf16 v[24:27], v[248:251], v[112:115], v[24:27]
    ds_read_b64_tr_b16 v[244:245], v3 offset:4096
    v_mfma_f32_16x16x32_bf16 v[28:31], v[248:251], v[116:119], v[28:31]
    ds_read_b64_tr_b16 v[246:247], v3 offset:6144
    s_waitcnt lgkmcnt(4)
    v_mfma_f32_16x16x32_bf16 v[24:27], v[252:255], v[120:123], v[24:27]
    ds_read_b64_tr_b16 v[248:249], v3 offset:16384
    v_cvt_pk_bf16_f32 v32, v32, v33
    v_mfma_f32_16x16x32_bf16 v[28:31], v[252:255], v[124:127], v[28:31]
    ds_read_b64_tr_b16 v[250:251], v3 offset:18432
    v_cvt_pk_bf16_f32 v33, v34, v35
    s_waitcnt lgkmcnt(4)
    v_mfma_f32_16x16x32_bf16 v[24:27], v[240:243], v[128:131], v[24:27]
    ds_read_b64_tr_b16 v[252:253], v3 offset:20480
    v_cvt_pk_bf16_f32 v34, v36, v37
    v_mfma_f32_16x16x32_bf16 v[28:31], v[240:243], v[132:135], v[28:31]
    ds_read_b64_tr_b16 v[254:255], v3 offset:22528
    v_cvt_pk_bf16_f32 v35, v38, v39
    s_waitcnt lgkmcnt(4)
    v_mfma_f32_16x16x32_bf16 v[24:27], v[244:247], v[136:139], v[24:27]
    ds_read_b64_tr_b16 v[240:241], v3 offset:32768
    v_or_b32 v32, 1, v32
    v_mfma_f32_16x16x32_bf16 v[28:31], v[244:247], v[140:143], v[28:31]
    ds_read_b64_tr_b16 v[242:243], v3 offset:34816
    s_xor_b32 s9, s48, 0xe000
    buffer_store_dwordx4 v[32:35], v12, s[12:15], s9 offen sc1
    s_waitcnt lgkmcnt(4)
    v_mfma_f32_16x16x32_bf16 v[24:27], v[248:251], v[144:147], v[24:27]
    ds_read_b64_tr_b16 v[244:245], v3 offset:36864
    s_waitcnt vmcnt(3)
    v_and_b32 v15, 1, v60
    v_cmp_eq_u32 vcc, 0, v15
    s_cbranch_vccnz sequential_preLN__sliding_block__glu_gated_bilinear__prompt_kernel_retry114
sequential_preLN__sliding_block__glu_gated_bilinear__prompt_kernel_ok115:
    v_mfma_f32_16x16x32_bf16 v[28:31], v[248:251], v[148:151], v[28:31]
    ds_read_b64_tr_b16 v[246:247], v3 offset:38912
    v_lshlrev_b32 v0, 16, v60
    v_and_b32 v60, 0xffff0000, v60
    v_add_f32 v96, v96, v0
    s_xor_b32 s9, s48, 0x60a000
    buffer_load_dwordx4 v[52:55], v12, s[12:15], s9 offen sc1
    s_waitcnt lgkmcnt(4)
    v_mfma_f32_16x16x32_bf16 v[24:27], v[252:255], v[152:155], v[24:27]
    ds_read_b64_tr_b16 v[248:249], v3 offset:49152
    v_mfma_f32_16x16x32_bf16 v[28:31], v[252:255], v[156:159], v[28:31]
    ds_read_b64_tr_b16 v[250:251], v3 offset:51200
    v_add_f32 v97, v97, v60
    s_waitcnt lgkmcnt(4)
    v_mfma_f32_16x16x32_bf16 v[24:27], v[240:243], v[160:163], v[24:27]
    ds_read_b64_tr_b16 v[252:253], v3 offset:53248
    v_lshlrev_b32 v1, 16, v61
    v_and_b32 v61, 0xffff0000, v61
    v_add_f32 v98, v98, v1
    v_mfma_f32_16x16x32_bf16 v[28:31], v[240:243], v[164:167], v[28:31]
    ds_read_b64_tr_b16 v[254:255], v3 offset:55296
    v_add_f32 v99, v99, v61
    s_waitcnt lgkmcnt(4)
    v_mfma_f32_16x16x32_bf16 v[24:27], v[244:247], v[168:171], v[24:27]
    ds_read_b64_tr_b16 v[240:241], v5 offset:0
    v_mfma_f32_16x16x32_bf16 v[28:31], v[244:247], v[172:175], v[28:31]
    ds_read_b64_tr_b16 v[242:243], v5 offset:2048
    v_lshlrev_b32 v0, 16, v62
    v_and_b32 v62, 0xffff0000, v62
    v_add_f32 v100, v100, v0
    s_waitcnt lgkmcnt(4)
    v_mfma_f32_16x16x32_bf16 v[24:27], v[248:251], v[176:179], v[24:27]
    ds_read_b64_tr_b16 v[244:245], v5 offset:16384
    v_add_f32 v101, v101, v62
    v_lshlrev_b32 v1, 16, v63
    v_and_b32 v63, 0xffff0000, v63
    v_add_f32 v102, v102, v1
    v_mfma_f32_16x16x32_bf16 v[28:31], v[248:251], v[180:183], v[28:31]
    ds_read_b64_tr_b16 v[246:247], v5 offset:18432
    s_xor_b32 s9, s48, 0x40c000
    buffer_load_dwordx4 v[44:47], v12, s[12:15], s9 offen sc1
    s_xor_b32 s9, s48, 0x20e000
    buffer_load_dwordx4 v[36:39], v12, s[12:15], s9 offen sc1
    s_waitcnt lgkmcnt(4)
    v_mfma_f32_16x16x32_bf16 v[24:27], v[252:255], v[184:187], v[24:27]
    ds_read_b64_tr_b16 v[248:249], v5 offset:32768
    v_mfma_f32_16x16x32_bf16 v[28:31], v[252:255], v[188:191], v[28:31]
    ds_read_b64_tr_b16 v[250:251], v5 offset:34816
    v_add_f32 v103, v103, v63
    s_waitcnt lgkmcnt(4)
    v_mfma_f32_16x16x32_bf16 v[24:27], v[240:243], v[192:195], v[24:27]
    ds_read_b64_tr_b16 v[252:253], v5 offset:4096
    v_mfma_f32_16x16x32_bf16 v[28:31], v[240:243], v[196:199], v[28:31]
    ds_read_b64_tr_b16 v[254:255], v5 offset:6144
    s_waitcnt lgkmcnt(4)
    v_mfma_f32_16x16x32_bf16 v[24:27], v[244:247], v[200:203], v[24:27]
    ds_read_b64_tr_b16 v[240:241], v5 offset:20480
    v_mfma_f32_16x16x32_bf16 v[28:31], v[244:247], v[204:207], v[28:31]
    ds_read_b64_tr_b16 v[242:243], v5 offset:22528
    s_waitcnt lgkmcnt(4)
    v_mfma_f32_16x16x32_bf16 v[24:27], v[248:251], v[208:211], v[24:27]
    ds_read_b64_tr_b16 v[244:245], v5 offset:36864
    v_mfma_f32_16x16x32_bf16 v[28:31], v[248:251], v[212:215], v[28:31]
    ds_read_b64_tr_b16 v[246:247], v5 offset:38912
    s_waitcnt lgkmcnt(4)
    v_mfma_f32_16x16x32_bf16 v[24:27], v[252:255], v[216:219], v[24:27]
    v_mfma_f32_16x16x32_bf16 v[28:31], v[252:255], v[220:223], v[28:31]
    s_waitcnt lgkmcnt(2)
    v_mfma_f32_16x16x32_bf16 v[24:27], v[240:243], v[224:227], v[24:27]
    v_mfma_f32_16x16x32_bf16 v[28:31], v[240:243], v[228:231], v[28:31]
    s_waitcnt lgkmcnt(0)
    v_mfma_f32_16x16x32_bf16 v[24:27], v[244:247], v[232:235], v[24:27]
    v_mfma_f32_16x16x32_bf16 v[28:31], v[244:247], v[236:239], v[28:31]
    s_waitcnt vmcnt(2)
    v_and_b32 v15, 1, v52
    v_cmp_eq_u32 vcc, 0, v15
    s_cbranch_vccnz sequential_preLN__sliding_block__glu_gated_bilinear__prompt_kernel_retry116
sequential_preLN__sliding_block__glu_gated_bilinear__prompt_kernel_ok117:
    v_lshlrev_b32 v0, 16, v52
    v_and_b32 v52, 0xffff0000, v52
    v_add_f32 v96, v96, v0
    v_add_f32 v97, v97, v52
    v_lshlrev_b32 v1, 16, v53
    v_and_b32 v53, 0xffff0000, v53
    v_add_f32 v98, v98, v1
    v_add_f32 v99, v99, v53
    v_lshlrev_b32 v0, 16, v54
    v_and_b32 v54, 0xffff0000, v54
    v_add_f32 v100, v100, v0
    v_add_f32 v101, v101, v54
    v_lshlrev_b32 v1, 16, v55
    v_and_b32 v55, 0xffff0000, v55
    v_add_f32 v102, v102, v1
    v_add_f32 v103, v103, v55
    s_waitcnt vmcnt(1)
    v_and_b32 v15, 1, v44
    v_cmp_eq_u32 vcc, 0, v15
    s_cbranch_vccnz sequential_preLN__sliding_block__glu_gated_bilinear__prompt_kernel_retry118
sequential_preLN__sliding_block__glu_gated_bilinear__prompt_kernel_ok119:
    v_lshlrev_b32 v0, 16, v44
    v_and_b32 v44, 0xffff0000, v44
    v_add_f32 v96, v96, v0
    v_add_f32 v97, v97, v44
    v_lshlrev_b32 v1, 16, v45
    v_and_b32 v45, 0xffff0000, v45
    v_add_f32 v98, v98, v1
    v_add_f32 v99, v99, v45
    v_lshlrev_b32 v0, 16, v46
    v_and_b32 v46, 0xffff0000, v46
    v_add_f32 v100, v100, v0
    v_add_f32 v101, v101, v46
    v_lshlrev_b32 v1, 16, v47
    v_and_b32 v47, 0xffff0000, v47
    v_add_f32 v102, v102, v1
    v_add_f32 v103, v103, v47
    s_waitcnt vmcnt(0)
    v_and_b32 v15, 1, v36
    v_cmp_eq_u32 vcc, 0, v15
    s_cbranch_vccnz sequential_preLN__sliding_block__glu_gated_bilinear__prompt_kernel_retry120
sequential_preLN__sliding_block__glu_gated_bilinear__prompt_kernel_ok121:
    v_lshlrev_b32 v0, 16, v36
    v_and_b32 v36, 0xffff0000, v36
    v_add_f32 v96, v96, v0
    v_add_f32 v97, v97, v36
    v_lshlrev_b32 v1, 16, v37
    v_and_b32 v37, 0xffff0000, v37
    v_add_f32 v98, v98, v1
    v_add_f32 v99, v99, v37
    v_lshlrev_b32 v0, 16, v38
    v_and_b32 v38, 0xffff0000, v38
    v_add_f32 v100, v100, v0
    v_add_f32 v101, v101, v38
    v_lshlrev_b32 v1, 16, v39
    v_and_b32 v39, 0xffff0000, v39
    v_add_f32 v102, v102, v1
    v_add_f32 v103, v103, v39
    s_waitcnt vmcnt(4)
    v_add_f32 v24, v24, v96
    v_add_f32 v25, v25, v97
    v_add_f32 v26, v26, v98
    v_add_f32 v27, v27, v99
    v_lshlrev_b32 v0, 16, v8
    v_and_b32 v1, 0xffff0000, v8
    v_fma_f32 v24, v24, v16, v0
    v_fma_f32 v25, v25, v16, v1
    v_cvt_pk_bf16_f32 v8, v24, v25
    v_lshlrev_b32 v0, 16, v9
    v_and_b32 v1, 0xffff0000, v9
    v_fma_f32 v26, v26, v16, v0
    v_fma_f32 v27, v27, v16, v1
    v_cvt_pk_bf16_f32 v9, v26, v27
    buffer_store_dwordx2 v[8:9], v19, s[32:35], s3 offen sc1 nt
    v_add_f32 v28, v28, v100
    v_add_f32 v29, v29, v101
    v_add_f32 v30, v30, v102
    v_add_f32 v31, v31, v103
    v_lshlrev_b32 v0, 16, v10
    v_and_b32 v1, 0xffff0000, v10
    v_fma_f32 v28, v28, v17, v0
    v_fma_f32 v29, v29, v17, v1
    v_cvt_pk_bf16_f32 v10, v28, v29
    v_lshlrev_b32 v0, 16, v11
    v_and_b32 v1, 0xffff0000, v11
    v_fma_f32 v30, v30, v17, v0
    v_fma_f32 v31, v31, v17, v1
    v_cvt_pk_bf16_f32 v11, v30, v31
    s_add_u32 s3, s3, 18432
    buffer_store_dwordx2 v[10:11], v19, s[32:35], s3 offen sc1 nt
sequential_preLN__sliding_block__glu_gated_bilinear__prompt_kernel_end:
    s_endpgm
sequential_preLN__sliding_block__glu_gated_bilinear__prompt_kernel_spin90:
    s_mov_b32 s7, 4096
sequential_preLN__sliding_block__glu_gated_bilinear__prompt_kernel_lp122:
    s_sleep 1
    buffer_load_dword v15, v14, s[12:15], s49 offen sc1
    s_sub_u32 s7, s7, 1
    s_cbranch_scc1 sequential_preLN__sliding_block__glu_gated_bilinear__prompt_kernel_go91
    s_waitcnt vmcnt(0)
    v_cmp_gt_i32 vcc, 1, v15
    s_nop 0
    s_and_b32 vcc_lo, vcc_lo, 15
    s_cbranch_scc1 sequential_preLN__sliding_block__glu_gated_bilinear__prompt_kernel_lp122
    s_branch sequential_preLN__sliding_block__glu_gated_bilinear__prompt_kernel_go91
sequential_preLN__sliding_block__glu_gated_bilinear__prompt_kernel_spin94:
    s_mov_b32 s7, 4096
sequential_preLN__sliding_block__glu_gated_bilinear__prompt_kernel_lp123:
    s_sleep 1
    buffer_load_dword v22, v14, s[12:15], s56 offen sc1
    s_sub_u32 s7, s7, 1
    s_cbranch_scc1 sequential_preLN__sliding_block__glu_gated_bilinear__prompt_kernel_go95
    s_waitcnt vmcnt(0)
    v_cmp_gt_i32 vcc, 1, v22
    s_nop 0
    s_and_b32 vcc_lo, vcc_lo, 255
    s_cbranch_scc1 sequential_preLN__sliding_block__glu_gated_bilinear__prompt_kernel_lp123
    s_branch sequential_preLN__sliding_block__glu_gated_bilinear__prompt_kernel_go95
sequential_preLN__sliding_block__glu_gated_bilinear__prompt_kernel_spin100:
    s_mov_b32 s7, 4096
sequential_preLN__sliding_block__glu_gated_bilinear__prompt_kernel_lp124:
    s_sleep 1
    buffer_load_dword v22, v14, s[12:15], s49 offen sc1
    s_sub_u32 s7, s7, 1
    s_cbranch_scc1 sequential_preLN__sliding_block__glu_gated_bilinear__prompt_kernel_go101
    s_waitcnt vmcnt(0)
    v_cmp_gt_i32 vcc, 2, v22
    s_nop 0
    s_and_b32 vcc_lo, vcc_lo, 15
    s_cbranch_scc1 sequential_preLN__sliding_block__glu_gated_bilinear__prompt_kernel_lp124
    s_branch sequential_preLN__sliding_block__glu_gated_bilinear__prompt_kernel_go101
sequential_preLN__sliding_block__glu_gated_bilinear__prompt_kernel_spin102:
    s_mov_b32 s7, 4096
sequential_preLN__sliding_block__glu_gated_bilinear__prompt_kernel_lp125:
    s_sleep 1
    buffer_load_dword v22, v14, s[12:15], s49 offen sc1
    s_sub_u32 s7, s7, 1
    s_cbranch_scc1 sequential_preLN__sliding_block__glu_gated_bilinear__prompt_kernel_go103
    s_waitcnt vmcnt(0)
    v_cmp_gt_i32 vcc, 3, v22
    s_nop 0
    s_and_b32 vcc_lo, vcc_lo, 15
    s_cbranch_scc1 sequential_preLN__sliding_block__glu_gated_bilinear__prompt_kernel_lp125
    s_branch sequential_preLN__sliding_block__glu_gated_bilinear__prompt_kernel_go103
sequential_preLN__sliding_block__glu_gated_bilinear__prompt_kernel_retry51:
    s_mov_b32 s7, 4096
sequential_preLN__sliding_block__glu_gated_bilinear__prompt_kernel_lp126:
    s_add_u32 s9, s46, 0xa40000
    buffer_load_dwordx4 v[96:99], v13, s[12:15], s9 offen offset:0 sc1
    s_add_u32 s9, s46, 0xa40000
    buffer_load_dwordx4 v[100:103], v13, s[12:15], s9 offen offset:256 sc1
    s_waitcnt vmcnt(0)
    s_sub_u32 s7, s7, 1
    s_cbranch_scc1 sequential_preLN__sliding_block__glu_gated_bilinear__prompt_kernel_ok52
    v_max_u32 v15, v96, v97
    v_max3_u32 v15, v98, v99, v15
    v_max3_u32 v15, v100, v101, v15
    v_max3_u32 v15, v102, v103, v15
    v_cmp_eq_u32 vcc, -1, v15
    s_cbranch_vccnz sequential_preLN__sliding_block__glu_gated_bilinear__prompt_kernel_lp126
    s_branch sequential_preLN__sliding_block__glu_gated_bilinear__prompt_kernel_ok52
sequential_preLN__sliding_block__glu_gated_bilinear__prompt_kernel_retry53:
    s_mov_b32 s7, 4096
sequential_preLN__sliding_block__glu_gated_bilinear__prompt_kernel_lp127:
    s_add_u32 s9, s46, 0xa40000
    buffer_load_dwordx4 v[104:107], v13, s[12:15], s9 offen offset:2048 sc1
    s_add_u32 s9, s46, 0xa40000
    buffer_load_dwordx4 v[108:111], v13, s[12:15], s9 offen offset:2304 sc1
    s_waitcnt vmcnt(0)
    s_sub_u32 s7, s7, 1
    s_cbranch_scc1 sequential_preLN__sliding_block__glu_gated_bilinear__prompt_kernel_ok54
    v_max_u32 v15, v104, v105
    v_max3_u32 v15, v106, v107, v15
    v_max3_u32 v15, v108, v109, v15
    v_max3_u32 v15, v110, v111, v15
    v_cmp_eq_u32 vcc, -1, v15
    s_cbranch_vccnz sequential_preLN__sliding_block__glu_gated_bilinear__prompt_kernel_lp127
    s_branch sequential_preLN__sliding_block__glu_gated_bilinear__prompt_kernel_ok54
sequential_preLN__sliding_block__glu_gated_bilinear__prompt_kernel_retry55:
    s_mov_b32 s7, 4096
sequential_preLN__sliding_block__glu_gated_bilinear__prompt_kernel_lp128:
    s_add_u32 s9, s46, 0xa41000
    buffer_load_dwordx4 v[112:115], v13, s[12:15], s9 offen offset:0 sc1
    s_add_u32 s9, s46, 0xa41000
    buffer_load_dwordx4 v[116:119], v13, s[12:15], s9 offen offset:256 sc1
    s_waitcnt vmcnt(0)
    s_sub_u32 s7, s7, 1
    s_cbranch_scc1 sequential_preLN__sliding_block__glu_gated_bilinear__prompt_kernel_ok56
    v_max_u32 v15, v112, v113
    v_max3_u32 v15, v114, v115, v15
    v_max3_u32 v15, v116, v117, v15
    v_max3_u32 v15, v118, v119, v15
    v_cmp_eq_u32 vcc, -1, v15
    s_cbranch_vccnz sequential_preLN__sliding_block__glu_gated_bilinear__prompt_kernel_lp128
    s_branch sequential_preLN__sliding_block__glu_gated_bilinear__prompt_kernel_ok56
sequential_preLN__sliding_block__glu_gated_bilinear__prompt_kernel_retry57:
    s_mov_b32 s7, 4096
sequential_preLN__sliding_block__glu_gated_bilinear__prompt_kernel_lp129:
    s_add_u32 s9, s46, 0xa41000
    buffer_load_dwordx4 v[120:123], v13, s[12:15], s9 offen offset:2048 sc1
    s_add_u32 s9, s46, 0xa41000
    buffer_load_dwordx4 v[124:127], v13, s[12:15], s9 offen offset:2304 sc1
    s_waitcnt vmcnt(0)
    s_sub_u32 s7, s7, 1
    s_cbranch_scc1 sequential_preLN__sliding_block__glu_gated_bilinear__prompt_kernel_ok58
    v_max_u32 v15, v120, v121
    v_max3_u32 v15, v122, v123, v15
    v_max3_u32 v15, v124, v125, v15
    v_max3_u32 v15, v126, v127, v15
    v_cmp_eq_u32 vcc, -1, v15
    s_cbranch_vccnz sequential_preLN__sliding_block__glu_gated_bilinear__prompt_kernel_lp129
    s_branch sequential_preLN__sliding_block__glu_gated_bilinear__prompt_kernel_ok58
sequential_preLN__sliding_block__glu_gated_bilinear__prompt_kernel_retry59:
    s_mov_b32 s7, 4096
sequential_preLN__sliding_block__glu_gated_bilinear__prompt_kernel_lp130:
    s_add_u32 s9, s46, 0xa42000
    buffer_load_dwordx4 v[128:131], v13, s[12:15], s9 offen offset:0 sc1
    s_add_u32 s9, s46, 0xa42000
    buffer_load_dwordx4 v[132:135], v13, s[12:15], s9 offen offset:256 sc1
    s_waitcnt vmcnt(0)
    s_sub_u32 s7, s7, 1
    s_cbranch_scc1 sequential_preLN__sliding_block__glu_gated_bilinear__prompt_kernel_ok60
    v_max_u32 v15, v128, v129
    v_max3_u32 v15, v130, v131, v15
    v_max3_u32 v15, v132, v133, v15
    v_max3_u32 v15, v134, v135, v15
    v_cmp_eq_u32 vcc, -1, v15
    s_cbranch_vccnz sequential_preLN__sliding_block__glu_gated_bilinear__prompt_kernel_lp130
    s_branch sequential_preLN__sliding_block__glu_gated_bilinear__prompt_kernel_ok60
sequential_preLN__sliding_block__glu_gated_bilinear__prompt_kernel_retry61:
    s_mov_b32 s7, 4096
sequential_preLN__sliding_block__glu_gated_bilinear__prompt_kernel_lp131:
    s_add_u32 s9, s46, 0xa42000
    buffer_load_dwordx4 v[136:139], v13, s[12:15], s9 offen offset:2048 sc1
    s_add_u32 s9, s46, 0xa42000
    buffer_load_dwordx4 v[140:143], v13, s[12:15], s9 offen offset:2304 sc1
    s_waitcnt vmcnt(0)
    s_sub_u32 s7, s7, 1
    s_cbranch_scc1 sequential_preLN__sliding_block__glu_gated_bilinear__prompt_kernel_ok62
    v_max_u32 v15, v136, v137
    v_max3_u32 v15, v138, v139, v15
    v_max3_u32 v15, v140, v141, v15
    v_max3_u32 v15, v142, v143, v15
    v_cmp_eq_u32 vcc, -1, v15
    s_cbranch_vccnz sequential_preLN__sliding_block__glu_gated_bilinear__prompt_kernel_lp131
    s_branch sequential_preLN__sliding_block__glu_gated_bilinear__prompt_kernel_ok62
sequential_preLN__sliding_block__glu_gated_bilinear__prompt_kernel_retry63:
    s_mov_b32 s7, 4096
sequential_preLN__sliding_block__glu_gated_bilinear__prompt_kernel_lp132:
    s_add_u32 s9, s46, 0xa43000
    buffer_load_dwordx4 v[144:147], v13, s[12:15], s9 offen offset:0 sc1
    s_add_u32 s9, s46, 0xa43000
    buffer_load_dwordx4 v[148:151], v13, s[12:15], s9 offen offset:256 sc1
    s_waitcnt vmcnt(0)
    s_sub_u32 s7, s7, 1
    s_cbranch_scc1 sequential_preLN__sliding_block__glu_gated_bilinear__prompt_kernel_ok64
    v_max_u32 v15, v144, v145
    v_max3_u32 v15, v146, v147, v15
    v_max3_u32 v15, v148, v149, v15
    v_max3_u32 v15, v150, v151, v15
    v_cmp_eq_u32 vcc, -1, v15
    s_cbranch_vccnz sequential_preLN__sliding_block__glu_gated_bilinear__prompt_kernel_lp132
    s_branch sequential_preLN__sliding_block__glu_gated_bilinear__prompt_kernel_ok64
sequential_preLN__sliding_block__glu_gated_bilinear__prompt_kernel_retry66:
    s_mov_b32 s7, 4096
sequential_preLN__sliding_block__glu_gated_bilinear__prompt_kernel_lp133:
    s_add_u32 s9, s46, 0xa43000
    buffer_load_dwordx4 v[152:155], v13, s[12:15], s9 offen offset:2048 sc1
    s_add_u32 s9, s46, 0xa43000
    buffer_load_dwordx4 v[156:159], v13, s[12:15], s9 offen offset:2304 sc1
    s_waitcnt vmcnt(0)
    s_sub_u32 s7, s7, 1
    s_cbranch_scc1 sequential_preLN__sliding_block__glu_gated_bilinear__prompt_kernel_ok67
    v_max_u32 v15, v152, v153
    v_max3_u32 v15, v154, v155, v15
    v_max3_u32 v15, v156, v157, v15
    v_max3_u32 v15, v158, v159, v15
    v_cmp_eq_u32 vcc, -1, v15
    s_cbranch_vccnz sequential_preLN__sliding_block__glu_gated_bilinear__prompt_kernel_lp133
    s_branch sequential_preLN__sliding_block__glu_gated_bilinear__prompt_kernel_ok67
sequential_preLN__sliding_block__glu_gated_bilinear__prompt_kernel_retry68:
    s_mov_b32 s7, 4096
sequential_preLN__sliding_block__glu_gated_bilinear__prompt_kernel_lp134:
    s_add_u32 s9, s46, 0xa44000
    buffer_load_dwordx4 v[160:163], v13, s[12:15], s9 offen offset:0 sc1
    s_add_u32 s9, s46, 0xa44000
    buffer_load_dwordx4 v[164:167], v13, s[12:15], s9 offen offset:256 sc1
    s_waitcnt vmcnt(0)
    s_sub_u32 s7, s7, 1
    s_cbranch_scc1 sequential_preLN__sliding_block__glu_gated_bilinear__prompt_kernel_ok69
    v_max_u32 v15, v160, v161
    v_max3_u32 v15, v162, v163, v15
    v_max3_u32 v15, v164, v165, v15
    v_max3_u32 v15, v166, v167, v15
    v_cmp_eq_u32 vcc, -1, v15
    s_cbranch_vccnz sequential_preLN__sliding_block__glu_gated_bilinear__prompt_kernel_lp134
    s_branch sequential_preLN__sliding_block__glu_gated_bilinear__prompt_kernel_ok69
sequential_preLN__sliding_block__glu_gated_bilinear__prompt_kernel_retry70:
    s_mov_b32 s7, 4096
sequential_preLN__sliding_block__glu_gated_bilinear__prompt_kernel_lp135:
    s_add_u32 s9, s46, 0xa44000
    buffer_load_dwordx4 v[168:171], v13, s[12:15], s9 offen offset:2048 sc1
    s_add_u32 s9, s46, 0xa44000
    buffer_load_dwordx4 v[172:175], v13, s[12:15], s9 offen offset:2304 sc1
    s_waitcnt vmcnt(0)
    s_sub_u32 s7, s7, 1
    s_cbranch_scc1 sequential_preLN__sliding_block__glu_gated_bilinear__prompt_kernel_ok71
    v_max_u32 v15, v168, v169
    v_max3_u32 v15, v170, v171, v15
    v_max3_u32 v15, v172, v173, v15
    v_max3_u32 v15, v174, v175, v15
    v_cmp_eq_u32 vcc, -1, v15
    s_cbranch_vccnz sequential_preLN__sliding_block__glu_gated_bilinear__prompt_kernel_lp135
    s_branch sequential_preLN__sliding_block__glu_gated_bilinear__prompt_kernel_ok71
sequential_preLN__sliding_block__glu_gated_bilinear__prompt_kernel_retry72:
    s_mov_b32 s7, 4096
sequential_preLN__sliding_block__glu_gated_bilinear__prompt_kernel_lp136:
    s_add_u32 s9, s46, 0xa45000
    buffer_load_dwordx4 v[176:179], v13, s[12:15], s9 offen offset:0 sc1
    s_add_u32 s9, s46, 0xa45000
    buffer_load_dwordx4 v[180:183], v13, s[12:15], s9 offen offset:256 sc1
    s_waitcnt vmcnt(0)
    s_sub_u32 s7, s7, 1
    s_cbranch_scc1 sequential_preLN__sliding_block__glu_gated_bilinear__prompt_kernel_ok73
    v_max_u32 v15, v176, v177
    v_max3_u32 v15, v178, v179, v15
    v_max3_u32 v15, v180, v181, v15
    v_max3_u32 v15, v182, v183, v15
    v_cmp_eq_u32 vcc, -1, v15
    s_cbranch_vccnz sequential_preLN__sliding_block__glu_gated_bilinear__prompt_kernel_lp136
    s_branch sequential_preLN__sliding_block__glu_gated_bilinear__prompt_kernel_ok73
sequential_preLN__sliding_block__glu_gated_bilinear__prompt_kernel_retry75:
    s_mov_b32 s7, 4096
sequential_preLN__sliding_block__glu_gated_bilinear__prompt_kernel_lp137:
    s_add_u32 s9, s46, 0xa45000
    buffer_load_dwordx4 v[184:187], v13, s[12:15], s9 offen offset:2048 sc1
    s_add_u32 s9, s46, 0xa45000
    buffer_load_dwordx4 v[188:191], v13, s[12:15], s9 offen offset:2304 sc1
    s_waitcnt vmcnt(0)
    s_sub_u32 s7, s7, 1
    s_cbranch_scc1 sequential_preLN__sliding_block__glu_gated_bilinear__prompt_kernel_ok76
    v_max_u32 v15, v184, v185
    v_max3_u32 v15, v186, v187, v15
    v_max3_u32 v15, v188, v189, v15
    v_max3_u32 v15, v190, v191, v15
    v_cmp_eq_u32 vcc, -1, v15
    s_cbranch_vccnz sequential_preLN__sliding_block__glu_gated_bilinear__prompt_kernel_lp137
    s_branch sequential_preLN__sliding_block__glu_gated_bilinear__prompt_kernel_ok76
sequential_preLN__sliding_block__glu_gated_bilinear__prompt_kernel_retry77:
    s_mov_b32 s7, 4096
sequential_preLN__sliding_block__glu_gated_bilinear__prompt_kernel_lp138:
    s_add_u32 s9, s46, 0xa46000
    buffer_load_dwordx4 v[192:195], v13, s[12:15], s9 offen offset:0 sc1
    s_add_u32 s9, s46, 0xa46000
    buffer_load_dwordx4 v[196:199], v13, s[12:15], s9 offen offset:256 sc1
    s_waitcnt vmcnt(0)
    s_sub_u32 s7, s7, 1
    s_cbranch_scc1 sequential_preLN__sliding_block__glu_gated_bilinear__prompt_kernel_ok78
    v_max_u32 v15, v192, v193
    v_max3_u32 v15, v194, v195, v15
    v_max3_u32 v15, v196, v197, v15
    v_max3_u32 v15, v198, v199, v15
    v_cmp_eq_u32 vcc, -1, v15
    s_cbranch_vccnz sequential_preLN__sliding_block__glu_gated_bilinear__prompt_kernel_lp138
    s_branch sequential_preLN__sliding_block__glu_gated_bilinear__prompt_kernel_ok78
sequential_preLN__sliding_block__glu_gated_bilinear__prompt_kernel_retry79:
    s_mov_b32 s7, 4096
sequential_preLN__sliding_block__glu_gated_bilinear__prompt_kernel_lp139:
    s_add_u32 s9, s46, 0xa46000
    buffer_load_dwordx4 v[200:203], v13, s[12:15], s9 offen offset:2048 sc1
    s_add_u32 s9, s46, 0xa46000
    buffer_load_dwordx4 v[204:207], v13, s[12:15], s9 offen offset:2304 sc1
    s_waitcnt vmcnt(0)
    s_sub_u32 s7, s7, 1
    s_cbranch_scc1 sequential_preLN__sliding_block__glu_gated_bilinear__prompt_kernel_ok80
    v_max_u32 v15, v200, v201
    v_max3_u32 v15, v202, v203, v15
    v_max3_u32 v15, v204, v205, v15
    v_max3_u32 v15, v206, v207, v15
    v_cmp_eq_u32 vcc, -1, v15
    s_cbranch_vccnz sequential_preLN__sliding_block__glu_gated_bilinear__prompt_kernel_lp139
    s_branch sequential_preLN__sliding_block__glu_gated_bilinear__prompt_kernel_ok80
sequential_preLN__sliding_block__glu_gated_bilinear__prompt_kernel_retry81:
    s_mov_b32 s7, 4096
sequential_preLN__sliding_block__glu_gated_bilinear__prompt_kernel_lp140:
    s_add_u32 s9, s46, 0xa47000
    buffer_load_dwordx4 v[208:211], v13, s[12:15], s9 offen offset:0 sc1
    s_add_u32 s9, s46, 0xa47000
    buffer_load_dwordx4 v[212:215], v13, s[12:15], s9 offen offset:256 sc1
    s_waitcnt vmcnt(0)
    s_sub_u32 s7, s7, 1
    s_cbranch_scc1 sequential_preLN__sliding_block__glu_gated_bilinear__prompt_kernel_ok82
    v_max_u32 v15, v208, v209
    v_max3_u32 v15, v210, v211, v15
    v_max3_u32 v15, v212, v213, v15
    v_max3_u32 v15, v214, v215, v15
    v_cmp_eq_u32 vcc, -1, v15
    s_cbranch_vccnz sequential_preLN__sliding_block__glu_gated_bilinear__prompt_kernel_lp140
    s_branch sequential_preLN__sliding_block__glu_gated_bilinear__prompt_kernel_ok82
sequential_preLN__sliding_block__glu_gated_bilinear__prompt_kernel_retry83:
    s_mov_b32 s7, 4096
sequential_preLN__sliding_block__glu_gated_bilinear__prompt_kernel_lp141:
    s_add_u32 s9, s46, 0xa47000
    buffer_load_dwordx4 v[216:219], v13, s[12:15], s9 offen offset:2048 sc1
    s_add_u32 s9, s46, 0xa47000
    buffer_load_dwordx4 v[220:223], v13, s[12:15], s9 offen offset:2304 sc1
    s_waitcnt vmcnt(0)
    s_sub_u32 s7, s7, 1
    s_cbranch_scc1 sequential_preLN__sliding_block__glu_gated_bilinear__prompt_kernel_ok84
    v_max_u32 v15, v216, v217
    v_max3_u32 v15, v218, v219, v15
    v_max3_u32 v15, v220, v221, v15
    v_max3_u32 v15, v222, v223, v15
    v_cmp_eq_u32 vcc, -1, v15
    s_cbranch_vccnz sequential_preLN__sliding_block__glu_gated_bilinear__prompt_kernel_lp141
    s_branch sequential_preLN__sliding_block__glu_gated_bilinear__prompt_kernel_ok84
sequential_preLN__sliding_block__glu_gated_bilinear__prompt_kernel_retry85:
    s_mov_b32 s7, 4096
sequential_preLN__sliding_block__glu_gated_bilinear__prompt_kernel_lp142:
    s_add_u32 s9, s46, 0xa48000
    buffer_load_dwordx4 v[224:227], v13, s[12:15], s9 offen offset:0 sc1
    s_add_u32 s9, s46, 0xa48000
    buffer_load_dwordx4 v[228:231], v13, s[12:15], s9 offen offset:256 sc1
    s_waitcnt vmcnt(0)
    s_sub_u32 s7, s7, 1
    s_cbranch_scc1 sequential_preLN__sliding_block__glu_gated_bilinear__prompt_kernel_ok86
    v_max_u32 v15, v224, v225
    v_max3_u32 v15, v226, v227, v15
    v_max3_u32 v15, v228, v229, v15
    v_max3_u32 v15, v230, v231, v15
    v_cmp_eq_u32 vcc, -1, v15
    s_cbranch_vccnz sequential_preLN__sliding_block__glu_gated_bilinear__prompt_kernel_lp142
    s_branch sequential_preLN__sliding_block__glu_gated_bilinear__prompt_kernel_ok86
sequential_preLN__sliding_block__glu_gated_bilinear__prompt_kernel_retry87:
    s_mov_b32 s7, 4096
sequential_preLN__sliding_block__glu_gated_bilinear__prompt_kernel_lp143:
    s_add_u32 s9, s46, 0xa48000
    buffer_load_dwordx4 v[232:235], v13, s[12:15], s9 offen offset:2048 sc1
    s_add_u32 s9, s46, 0xa48000
    buffer_load_dwordx4 v[236:239], v13, s[12:15], s9 offen offset:2304 sc1
    s_waitcnt vmcnt(0)
    s_sub_u32 s7, s7, 1
    s_cbranch_scc1 sequential_preLN__sliding_block__glu_gated_bilinear__prompt_kernel_ok88
    v_max_u32 v15, v232, v233
    v_max3_u32 v15, v234, v235, v15
    v_max3_u32 v15, v236, v237, v15
    v_max3_u32 v15, v238, v239, v15
    v_cmp_eq_u32 vcc, -1, v15
    s_cbranch_vccnz sequential_preLN__sliding_block__glu_gated_bilinear__prompt_kernel_lp143
    s_branch sequential_preLN__sliding_block__glu_gated_bilinear__prompt_kernel_ok88
sequential_preLN__sliding_block__glu_gated_bilinear__prompt_kernel_retry92:
    s_mov_b32 s7, 4096
sequential_preLN__sliding_block__glu_gated_bilinear__prompt_kernel_lp144:
    s_lshl_b32 s9, s39, 7
    s_add_u32 s9, s9, 0xc80000
    buffer_load_dword v20, v11, s[12:15], s9 offen sc1
    s_lshl_b32 s9, s39, 9
    s_add_u32 s9, s9, 0xc82000
    v_lshlrev_b32 v0, 2, v11
    buffer_load_dwordx4 v[88:91], v0, s[12:15], s9 offen sc1
    s_waitcnt vmcnt(0)
    s_sub_u32 s7, s7, 1
    s_cbranch_scc1 sequential_preLN__sliding_block__glu_gated_bilinear__prompt_kernel_ok93
    v_max_u32 v15, v20, v20
    v_max3_u32 v15, v88, v89, v15
    v_max3_u32 v15, v90, v91, v15
    v_cmp_eq_u32 vcc, -1, v15
    s_cbranch_vccnz sequential_preLN__sliding_block__glu_gated_bilinear__prompt_kernel_lp144
    s_branch sequential_preLN__sliding_block__glu_gated_bilinear__prompt_kernel_ok93
sequential_preLN__sliding_block__glu_gated_bilinear__prompt_kernel_retry96:
    s_mov_b32 s7, 4096
sequential_preLN__sliding_block__glu_gated_bilinear__prompt_kernel_lp145:
    s_xor_b32 s9, s48, 0x18000
    buffer_load_dwordx4 v[192:195], v12, s[12:15], s9 offen sc1
    s_xor_b32 s9, s48, 0x1a000
    buffer_load_dwordx4 v[196:199], v12, s[12:15], s9 offen sc1
    s_xor_b32 s9, s48, 0x28000
    buffer_load_dwordx4 v[200:203], v12, s[12:15], s9 offen sc1
    s_xor_b32 s9, s48, 0x2a000
    buffer_load_dwordx4 v[204:207], v12, s[12:15], s9 offen sc1
    s_xor_b32 s9, s48, 0x38000
    buffer_load_dwordx4 v[208:211], v12, s[12:15], s9 offen sc1
    s_xor_b32 s9, s48, 0x3a000
    buffer_load_dwordx4 v[212:215], v12, s[12:15], s9 offen sc1
    s_waitcnt vmcnt(0)
    s_sub_u32 s7, s7, 1
    s_cbranch_scc1 sequential_preLN__sliding_block__glu_gated_bilinear__prompt_kernel_ok97
    v_max_u32 v15, v192, v196
    v_max3_u32 v15, v200, v204, v15
    v_max3_u32 v15, v208, v212, v15
    v_cmp_eq_u32 vcc, -2, v15
    s_cbranch_vccnz sequential_preLN__sliding_block__glu_gated_bilinear__prompt_kernel_lp145
    s_branch sequential_preLN__sliding_block__glu_gated_bilinear__prompt_kernel_ok97
sequential_preLN__sliding_block__glu_gated_bilinear__prompt_kernel_retry98:
    s_mov_b32 s7, 4096
sequential_preLN__sliding_block__glu_gated_bilinear__prompt_kernel_lp146:
    s_xor_b32 s9, s48, 0x1c000
    buffer_load_dwordx4 v[216:219], v12, s[12:15], s9 offen sc1
    s_xor_b32 s9, s48, 0x1e000
    buffer_load_dwordx4 v[220:223], v12, s[12:15], s9 offen sc1
    s_xor_b32 s9, s48, 0x2c000
    buffer_load_dwordx4 v[224:227], v12, s[12:15], s9 offen sc1
    s_xor_b32 s9, s48, 0x2e000
    buffer_load_dwordx4 v[228:231], v12, s[12:15], s9 offen sc1
    s_xor_b32 s9, s48, 0x3c000
    buffer_load_dwordx4 v[232:235], v12, s[12:15], s9 offen sc1
    s_xor_b32 s9, s48, 0x3e000
    buffer_load_dwordx4 v[236:239], v12, s[12:15], s9 offen sc1
    s_waitcnt vmcnt(0)
    s_sub_u32 s7, s7, 1
    s_cbranch_scc1 sequential_preLN__sliding_block__glu_gated_bilinear__prompt_kernel_ok99
    v_max_u32 v15, v216, v220
    v_max3_u32 v15, v224, v228, v15
    v_max3_u32 v15, v232, v236, v15
    v_cmp_eq_u32 vcc, -2, v15
    s_cbranch_vccnz sequential_preLN__sliding_block__glu_gated_bilinear__prompt_kernel_lp146
    s_branch sequential_preLN__sliding_block__glu_gated_bilinear__prompt_kernel_ok99
sequential_preLN__sliding_block__glu_gated_bilinear__prompt_kernel_retry104:
    s_mov_b32 s7, 4096
sequential_preLN__sliding_block__glu_gated_bilinear__prompt_kernel_lp147:
    s_xor_b32 s9, s48, 0xe02000
    buffer_load_dwordx4 v[84:87], v12, s[12:15], s9 offen sc1
    s_waitcnt vmcnt(0)
    s_sub_u32 s7, s7, 1
    s_cbranch_scc1 sequential_preLN__sliding_block__glu_gated_bilinear__prompt_kernel_ok105
    v_and_b32 v15, 1, v84
    v_cmp_eq_u32 vcc, 0, v15
    s_cbranch_vccnz sequential_preLN__sliding_block__glu_gated_bilinear__prompt_kernel_lp147
    s_branch sequential_preLN__sliding_block__glu_gated_bilinear__prompt_kernel_ok105
sequential_preLN__sliding_block__glu_gated_bilinear__prompt_kernel_retry107:
    s_mov_b32 s7, 4096
sequential_preLN__sliding_block__glu_gated_bilinear__prompt_kernel_lp148:
    s_xor_b32 s9, s48, 0xc04000
    buffer_load_dwordx4 v[76:79], v12, s[12:15], s9 offen sc1
    s_waitcnt vmcnt(0)
    s_sub_u32 s7, s7, 1
    s_cbranch_scc1 sequential_preLN__sliding_block__glu_gated_bilinear__prompt_kernel_ok108
    v_and_b32 v15, 1, v76
    v_cmp_eq_u32 vcc, 0, v15
    s_cbranch_vccnz sequential_preLN__sliding_block__glu_gated_bilinear__prompt_kernel_lp148
    s_branch sequential_preLN__sliding_block__glu_gated_bilinear__prompt_kernel_ok108
sequential_preLN__sliding_block__glu_gated_bilinear__prompt_kernel_retry110:
    s_mov_b32 s7, 4096
sequential_preLN__sliding_block__glu_gated_bilinear__prompt_kernel_lp149:
    s_xor_b32 s9, s48, 0x0
    buffer_load_dwordx4 v[88:91], v12, s[12:15], s9 offen sc1
    s_xor_b32 s9, s48, 0x200000
    buffer_load_dwordx4 v[92:95], v12, s[12:15], s9 offen sc1
    s_xor_b32 s9, s48, 0x400000
    buffer_load_dwordx4 v[80:83], v12, s[12:15], s9 offen sc1
    s_xor_b32 s9, s48, 0x600000
    buffer_load_dwordx4 v[72:75], v12, s[12:15], s9 offen sc1
    s_xor_b32 s9, s48, 0x800000
    buffer_load_dwordx4 v[64:67], v12, s[12:15], s9 offen sc1
    s_xor_b32 s9, s48, 0xa00000
    buffer_load_dwordx4 v[56:59], v12, s[12:15], s9 offen sc1
    s_xor_b32 s9, s48, 0xc00000
    buffer_load_dwordx4 v[104:107], v12, s[12:15], s9 offen sc1
    s_xor_b32 s9, s48, 0xe00000
    buffer_load_dwordx4 v[108:111], v12, s[12:15], s9 offen sc1
    s_waitcnt vmcnt(0)
    s_sub_u32 s7, s7, 1
    s_cbranch_scc1 sequential_preLN__sliding_block__glu_gated_bilinear__prompt_kernel_ok111
    v_and_b32 v15, v88, v92
    v_and_b32 v15, v80, v15
    v_and_b32 v15, v72, v15
    v_and_b32 v15, v64, v15
    v_and_b32 v15, v56, v15
    v_and_b32 v15, v104, v15
    v_and_b32 v15, v108, v15
    v_and_b32 v15, 1, v15
    v_cmp_eq_u32 vcc, 0, v15
    s_cbranch_vccnz sequential_preLN__sliding_block__glu_gated_bilinear__prompt_kernel_lp149
    s_branch sequential_preLN__sliding_block__glu_gated_bilinear__prompt_kernel_ok111
sequential_preLN__sliding_block__glu_gated_bilinear__prompt_kernel_retry112:
    s_mov_b32 s7, 4096
sequential_preLN__sliding_block__glu_gated_bilinear__prompt_kernel_lp150:
    s_xor_b32 s9, s48, 0xa06000
    buffer_load_dwordx4 v[68:71], v12, s[12:15], s9 offen sc1
    s_waitcnt vmcnt(0)
    s_sub_u32 s7, s7, 1
    s_cbranch_scc1 sequential_preLN__sliding_block__glu_gated_bilinear__prompt_kernel_ok113
    v_and_b32 v15, 1, v68
    v_cmp_eq_u32 vcc, 0, v15
    s_cbranch_vccnz sequential_preLN__sliding_block__glu_gated_bilinear__prompt_kernel_lp150
    s_branch sequential_preLN__sliding_block__glu_gated_bilinear__prompt_kernel_ok113
sequential_preLN__sliding_block__glu_gated_bilinear__prompt_kernel_retry114:
    s_mov_b32 s7, 4096
sequential_preLN__sliding_block__glu_gated_bilinear__prompt_kernel_lp151:
    s_xor_b32 s9, s48, 0x808000
    buffer_load_dwordx4 v[60:63], v12, s[12:15], s9 offen sc1
    s_waitcnt vmcnt(0)
    s_sub_u32 s7, s7, 1
    s_cbranch_scc1 sequential_preLN__sliding_block__glu_gated_bilinear__prompt_kernel_ok115
    v_and_b32 v15, 1, v60
    v_cmp_eq_u32 vcc, 0, v15
    s_cbranch_vccnz sequential_preLN__sliding_block__glu_gated_bilinear__prompt_kernel_lp151
    s_branch sequential_preLN__sliding_block__glu_gated_bilinear__prompt_kernel_ok115
sequential_preLN__sliding_block__glu_gated_bilinear__prompt_kernel_retry116:
    s_mov_b32 s7, 4096
sequential_preLN__sliding_block__glu_gated_bilinear__prompt_kernel_lp152:
    s_xor_b32 s9, s48, 0x60a000
    buffer_load_dwordx4 v[52:55], v12, s[12:15], s9 offen sc1
    s_waitcnt vmcnt(0)
    s_sub_u32 s7, s7, 1
    s_cbranch_scc1 sequential_preLN__sliding_block__glu_gated_bilinear__prompt_kernel_ok117
    v_and_b32 v15, 1, v52
    v_cmp_eq_u32 vcc, 0, v15
    s_cbranch_vccnz sequential_preLN__sliding_block__glu_gated_bilinear__prompt_kernel_lp152
    s_branch sequential_preLN__sliding_block__glu_gated_bilinear__prompt_kernel_ok117
sequential_preLN__sliding_block__glu_gated_bilinear__prompt_kernel_retry118:
    s_mov_b32 s7, 4096
sequential_preLN__sliding_block__glu_gated_bilinear__prompt_kernel_lp153:
    s_xor_b32 s9, s48, 0x40c000
    buffer_load_dwordx4 v[44:47], v12, s[12:15], s9 offen sc1
    s_waitcnt vmcnt(0)
    s_sub_u32 s7, s7, 1
    s_cbranch_scc1 sequential_preLN__sliding_block__glu_gated_bilinear__prompt_kernel_ok119
    v_and_b32 v15, 1, v44
    v_cmp_eq_u32 vcc, 0, v15
    s_cbranch_vccnz sequential_preLN__sliding_block__glu_gated_bilinear__prompt_kernel_lp153
    s_branch sequential_preLN__sliding_block__glu_gated_bilinear__prompt_kernel_ok119
sequential_preLN__sliding_block__glu_gated_bilinear__prompt_kernel_retry120:
    s_mov_b32 s7, 4096
sequential_preLN__sliding_block__glu_gated_bilinear__prompt_kernel_lp154:
    s_xor_b32 s9, s48, 0x20e000
    buffer_load_dwordx4 v[36:39], v12, s[12:15], s9 offen sc1
    s_waitcnt vmcnt(0)
    s_sub_u32 s7, s7, 1
    s_cbranch_scc1 sequential_preLN__sliding_block__glu_gated_bilinear__prompt_kernel_ok121
    v_and_b32 v15, 1, v36
    v_cmp_eq_u32 vcc, 0, v15
    s_cbranch_vccnz sequential_preLN__sliding_block__glu_gated_bilinear__prompt_kernel_lp154
    s_branch sequential_preLN__sliding_block__glu_gated_bilinear__prompt_kernel_ok121
sequential_preLN__sliding_block__glu_gated_bilinear__prompt_kernel_neg25:
    v_mov_b32 v80, 0xf149f2ca
    v_mov_b32 v81, 0xf149f2ca
    v_mov_b32 v82, 0xf149f2ca
    v_mov_b32 v83, 0xf149f2ca
    v_mov_b32 v84, 0xf149f2ca
    v_mov_b32 v85, 0xf149f2ca
    v_mov_b32 v86, 0xf149f2ca
    v_mov_b32 v87, 0xf149f2ca
    v_mov_b32 v88, 0xf149f2ca
    v_mov_b32 v89, 0xf149f2ca
    v_mov_b32 v90, 0xf149f2ca
    v_mov_b32 v91, 0xf149f2ca
    v_mov_b32 v92, 0xf149f2ca
    v_mov_b32 v93, 0xf149f2ca
    v_mov_b32 v94, 0xf149f2ca
    v_mov_b32 v95, 0xf149f2ca
    s_branch sequential_preLN__sliding_block__glu_gated_bilinear__prompt_kernel_back26
sequential_preLN__sliding_block__glu_gated_bilinear__prompt_kernel_neg27:
    v_mov_b32 v96, 0xf149f2ca
    v_mov_b32 v97, 0xf149f2ca
    v_mov_b32 v98, 0xf149f2ca
    v_mov_b32 v99, 0xf149f2ca
    v_mov_b32 v100, 0xf149f2ca
    v_mov_b32 v101, 0xf149f2ca
    v_mov_b32 v102, 0xf149f2ca
    v_mov_b32 v103, 0xf149f2ca
    v_mov_b32 v104, 0xf149f2ca
    v_mov_b32 v105, 0xf149f2ca
    v_mov_b32 v106, 0xf149f2ca
    v_mov_b32 v107, 0xf149f2ca
    v_mov_b32 v108, 0xf149f2ca
    v_mov_b32 v109, 0xf149f2ca
    v_mov_b32 v110, 0xf149f2ca
    v_mov_b32 v111, 0xf149f2ca
    s_branch sequential_preLN__sliding_block__glu_gated_bilinear__prompt_kernel_back28
sequential_preLN__sliding_block__glu_gated_bilinear__prompt_kernel_neg29:
    v_mov_b32 v112, 0xf149f2ca
    v_mov_b32 v113, 0xf149f2ca
    v_mov_b32 v114, 0xf149f2ca
    v_mov_b32 v115, 0xf149f2ca
    v_mov_b32 v116, 0xf149f2ca
    v_mov_b32 v117, 0xf149f2ca
    v_mov_b32 v118, 0xf149f2ca
    v_mov_b32 v119, 0xf149f2ca
    v_mov_b32 v120, 0xf149f2ca
    v_mov_b32 v121, 0xf149f2ca
    v_mov_b32 v122, 0xf149f2ca
    v_mov_b32 v123, 0xf149f2ca
    v_mov_b32 v124, 0xf149f2ca
    v_mov_b32 v125, 0xf149f2ca
    v_mov_b32 v126, 0xf149f2ca
    v_mov_b32 v127, 0xf149f2ca
    s_branch sequential_preLN__sliding_block__glu_gated_bilinear__prompt_kernel_back30
sequential_preLN__sliding_block__glu_gated_bilinear__prompt_kernel_neg31:
    v_mov_b32 v128, 0xf149f2ca
    v_mov_b32 v129, 0xf149f2ca
    v_mov_b32 v130, 0xf149f2ca
    v_mov_b32 v131, 0xf149f2ca
    v_mov_b32 v132, 0xf149f2ca
    v_mov_b32 v133, 0xf149f2ca
    v_mov_b32 v134, 0xf149f2ca
    v_mov_b32 v135, 0xf149f2ca
    v_mov_b32 v136, 0xf149f2ca
    v_mov_b32 v137, 0xf149f2ca
    v_mov_b32 v138, 0xf149f2ca
    v_mov_b32 v139, 0xf149f2ca
    v_mov_b32 v140, 0xf149f2ca
    v_mov_b32 v141, 0xf149f2ca
    v_mov_b32 v142, 0xf149f2ca
    v_mov_b32 v143, 0xf149f2ca
    s_branch sequential_preLN__sliding_block__glu_gated_bilinear__prompt_kernel_back32
sequential_preLN__sliding_block__glu_gated_bilinear__prompt_kernel_neg33:
    v_mov_b32 v144, 0xf149f2ca
    v_mov_b32 v145, 0xf149f2ca
    v_mov_b32 v146, 0xf149f2ca
    v_mov_b32 v147, 0xf149f2ca
    v_mov_b32 v148, 0xf149f2ca
    v_mov_b32 v149, 0xf149f2ca
    v_mov_b32 v150, 0xf149f2ca
    v_mov_b32 v151, 0xf149f2ca
    v_mov_b32 v152, 0xf149f2ca
    v_mov_b32 v153, 0xf149f2ca
    v_mov_b32 v154, 0xf149f2ca
    v_mov_b32 v155, 0xf149f2ca
    v_mov_b32 v156, 0xf149f2ca
    v_mov_b32 v157, 0xf149f2ca
    v_mov_b32 v158, 0xf149f2ca
    v_mov_b32 v159, 0xf149f2ca
    s_branch sequential_preLN__sliding_block__glu_gated_bilinear__prompt_kernel_back34
sequential_preLN__sliding_block__glu_gated_bilinear__prompt_kernel_neg35:
    v_mov_b32 v160, 0xf149f2ca
    v_mov_b32 v161, 0xf149f2ca
    v_mov_b32 v162, 0xf149f2ca
    v_mov_b32 v163, 0xf149f2ca
    v_mov_b32 v164, 0xf149f2ca
    v_mov_b32 v165, 0xf149f2ca
    v_mov_b32 v166, 0xf149f2ca
    v_mov_b32 v167, 0xf149f2ca
    v_mov_b32 v168, 0xf149f2ca
    v_mov_b32 v169, 0xf149f2ca
    v_mov_b32 v170, 0xf149f2ca
    v_mov_b32 v171, 0xf149f2ca
    v_mov_b32 v172, 0xf149f2ca
    v_mov_b32 v173, 0xf149f2ca
    v_mov_b32 v174, 0xf149f2ca
    v_mov_b32 v175, 0xf149f2ca
    s_branch sequential_preLN__sliding_block__glu_gated_bilinear__prompt_kernel_back36
sequential_preLN__sliding_block__glu_gated_bilinear__prompt_kernel_neg37:
    v_mov_b32 v176, 0xf149f2ca
    v_mov_b32 v177, 0xf149f2ca
    v_mov_b32 v178, 0xf149f2ca
    v_mov_b32 v179, 0xf149f2ca
    v_mov_b32 v180, 0xf149f2ca
    v_mov_b32 v181, 0xf149f2ca
    v_mov_b32 v182, 0xf149f2ca
    v_mov_b32 v183, 0xf149f2ca
    v_mov_b32 v184, 0xf149f2ca
    v_mov_b32 v185, 0xf149f2ca
    v_mov_b32 v186, 0xf149f2ca
    v_mov_b32 v187, 0xf149f2ca
    v_mov_b32 v188, 0xf149f2ca
    v_mov_b32 v189, 0xf149f2ca
    v_mov_b32 v190, 0xf149f2ca
    v_mov_b32 v191, 0xf149f2ca
    s_branch sequential_preLN__sliding_block__glu_gated_bilinear__prompt_kernel_back38
sequential_preLN__sliding_block__glu_gated_bilinear__prompt_kernel_neg39:
    v_mov_b32 v192, 0xf149f2ca
    v_mov_b32 v193, 0xf149f2ca
    v_mov_b32 v194, 0xf149f2ca
    v_mov_b32 v195, 0xf149f2ca
    v_mov_b32 v196, 0xf149f2ca
    v_mov_b32 v197, 0xf149f2ca
    v_mov_b32 v198, 0xf149f2ca
    v_mov_b32 v199, 0xf149f2ca
    v_mov_b32 v200, 0xf149f2ca
    v_mov_b32 v201, 0xf149f2ca
    v_mov_b32 v202, 0xf149f2ca
    v_mov_b32 v203, 0xf149f2ca
    v_mov_b32 v204, 0xf149f2ca
    v_mov_b32 v205, 0xf149f2ca
    v_mov_b32 v206, 0xf149f2ca
    v_mov_b32 v207, 0xf149f2ca
    s_branch sequential_preLN__sliding_block__glu_gated_bilinear__prompt_kernel_back40
.section .rodata,"a"
.p2align 6
.amdhsa_kernel sequential_preLN__sliding_block__glu_gated_bilinear__prompt_kernel
  .amdhsa_next_free_vgpr 256
  .amdhsa_next_free_sgpr 100
  .amdhsa_accum_offset 256
  .amdhsa_group_segment_fixed_size 0
  .amdhsa_kernarg_size 80
  .amdhsa_user_sgpr_count 2
  .amdhsa_user_sgpr_kernarg_segment_ptr 1
  .amdhsa_system_sgpr_workgroup_id_x 1
  .amdhsa_float_denorm_mode_32 3
.end_amdhsa_kernel
```
